```python
import torch

def _softmax(x, axis=-1):
    return torch.softmax(x, dim=axis)

def _gelu(x):
    return torch.nn.functional.gelu(x, approximate='tanh')

def _silu(x):
    return torch.nn.functional.silu(x)

def _sigmoid(x):
    return torch.sigmoid(x)

def _layernorm(x, axis=-1, eps=1e-05):
    m = x.mean(dim=axis, keepdim=True)
    v = x.var(dim=axis, keepdim=True, unbiased=False)
    return (x - m) / torch.sqrt(v + eps)

def _scatter_add(tgt, idx, src, axis=0):
    return tgt.clone().index_add_(axis, idx, src)

def _segment_sum(src, seg, n):
    out = torch.zeros((n,) + src.shape[1:], dtype=src.dtype)
    return out.index_add_(0, seg, src)

def _pad(x, pw):
    flat = tuple((v for pair in reversed(pw) for v in pair))
    return torch.nn.functional.pad(x, flat)
kernel_name = 'recurrent_scan__memory_aug_recurrent_mem_tr__swiglu_ffn__prompt'

def setup_inputs():

    _w = lambda a: (lambda t: t.to(torch.bfloat16) if t.is_floating_point() else t)(torch.as_tensor(a))

    def _A_setup():
        B, S, Dm = (1, 2048, 512)
        H, Dh = (32, 128)
        M, seg = (8, 32)
        seg = min(seg, S)
        S = S // seg * seg
        return {'x': _w((lambda *s: torch.randn(*s, dtype=torch.bfloat16) * 0.05)(B, S, Dm)), 'mem0': _w((lambda *s: torch.randn(*s, dtype=torch.bfloat16) * 0.2)(B, M, Dm)), 'Wq': _w((lambda *s: torch.randn(*s, dtype=torch.bfloat16) * 0.8)(Dm, H, Dh) * Dm ** (-0.5)), 'Wk': _w((lambda *s: torch.randn(*s, dtype=torch.bfloat16) * 0.8)(Dm, H, Dh) * Dm ** (-0.5)), 'Wv': _w((lambda *s: torch.randn(*s, dtype=torch.bfloat16) * 0.2)(Dm, H, Dh) * Dm ** (-0.5)), 'Wo': _w((lambda *s: torch.randn(*s, dtype=torch.bfloat16) * 0.2)(H, Dh, Dm) * (H * Dh) ** (-0.5)), 'seg_len': seg}
    _A_in = _A_setup()

    def _B_setup():
        B, S, D, F = (1, 2048, 512, 1792)
        return {'x': _w((lambda *s: torch.randn(*s, dtype=torch.bfloat16) * 0.05)(B, S, D)), 'w_gate': _w((lambda *s: torch.randn(*s, dtype=torch.bfloat16) * 0.1)(D, F)), 'w_up': _w((lambda *s: torch.randn(*s, dtype=torch.bfloat16) * 0.1)(D, F)), 'w_down': _w((lambda *s: torch.randn(*s, dtype=torch.bfloat16) * 0.1)(F, D))}
    _B_in = _B_setup()
    return {'A_x': _A_in['x'], 'A_mem0': _A_in['mem0'], 'A_Wq': _A_in['Wq'], 'A_Wk': _A_in['Wk'], 'A_Wv': _A_in['Wv'], 'A_Wo': _A_in['Wo'], 'A_seg_len': _A_in['seg_len'], 'B_x': _B_in['x'], 'B_w_gate': _B_in['w_gate'], 'B_w_up': _B_in['w_up'], 'B_w_down': _B_in['w_down']}

def reference(A_x, A_mem0, A_Wq, A_Wk, A_Wv, A_Wo, A_seg_len, B_x, B_w_gate, B_w_up, B_w_down):

    def _A_ref(x, mem0, Wq, Wk, Wv, Wo, seg_len):
        B, S, Dm = x.shape
        H, Dh = (Wq.shape[1], Wq.shape[2])
        M = mem0.shape[1]
        scale = Dh ** (-0.5)
        n_seg = S // seg_len
        L = M + seg_len
        idx = torch.arange(L)
        mask = (idx[:, None] < M) | (idx[:, None] >= idx[None, :])
        mem = mem0
        outs = []
        for s in range(n_seg):
            xs = x[:, s * seg_len:(s + 1) * seg_len, :].clone()
            h = torch.concatenate([mem, xs], axis=1)
            q = torch.einsum('btd,dhe->bhte', h, Wq)
            k = torch.einsum('btd,dhe->bhte', h, Wk)
            v = torch.einsum('btd,dhe->bhte', h, Wv)
            scores = torch.einsum('bhqe,bhke->bhqk', q, k) * scale
            scores = torch.where(mask[None, None], scores, -1000000000.0)
            p = _softmax(scores, axis=-1)
            o = torch.einsum('bhqk,bhke->bhqe', p, v)
            o = torch.einsum('bhte,hed->btd', o, Wo)
            mem = o[:, :M, :].clone()
            outs.append(o[:, M:, :])
        return torch.concatenate(outs, axis=1)

    def _B_ref(x, w_gate, w_up, w_down):
        g = _silu(x @ w_gate)
        u = x @ w_up
        return g * u @ w_down
    x = A_x
    xn = _layernorm(x, axis=-1)
    s = _A_ref(xn, A_mem0, A_Wq, A_Wk, A_Wv, A_Wo, A_seg_len)
    g = _silu(_B_ref(xn, B_w_gate, B_w_up, B_w_down))
    return x + s * g
```

```asm
; @launch grid=(256,1,1) block=(256,1,1) lds=163840
.amdgcn_target "amdgcn-amd-amdhsa--gfx950"
.text
.globl recurrent_scan__memory_aug_recurrent_mem_tr__swiglu_ffn__prompt_kernel
.p2align 8
.type recurrent_scan__memory_aug_recurrent_mem_tr__swiglu_ffn__prompt_kernel,@function
recurrent_scan__memory_aug_recurrent_mem_tr__swiglu_ffn__prompt_kernel:
    s_cmp_ge_u32 s2, 256
    s_cbranch_scc1 L_exit
    s_load_dwordx16 s[4:19], s[0:1], 0
    s_load_dwordx8 s[20:27], s[0:1], 64
    s_load_dwordx4 s[28:31], s[0:1], 96
    v_lshrrev_b32 v1, 6, v0
    s_nop 0
    v_readfirstlane_b32 s3, v1
    v_and_b32 v1, 63, v0
    s_waitcnt lgkmcnt(0)
    s_mov_b32 s32, s30
    s_and_b32 s33, s31, 0xffff
    s_mov_b32 s34, 268435456
    s_mov_b32 s35, 0x20000
    s_getreg_b32 s95, hwreg(HW_REG_XCC_ID)
    s_and_b32 s95, s95, 7
    s_lshl_b32 s61, s95, 2
    s_cmp_lg_u32 s3, 0
    s_cbranch_scc1 L_tk_1
    v_mov_b32 v8, s61
    v_mov_b32 v9, 1
    v_mov_b32 v11, 162816
    s_mov_b64 exec, 1
    global_atomic_add v10, v8, v9, s[28:29] sc0
    s_waitcnt vmcnt(0)
    ds_write_b32 v11, v10
    s_waitcnt lgkmcnt(0)
    s_mov_b64 exec, -1
L_tk_1:
    s_barrier
    v_mov_b32 v11, 162816
    ds_read_b32 v10, v11
    s_waitcnt lgkmcnt(0)
    v_readfirstlane_b32 s48, v10
    s_barrier
    s_mov_b32 s94, 0
    s_cmp_lt_u32 s48, 32
    s_cbranch_scc0 L_ovf
    s_lshl_b32 s60, s95, 5
    s_add_u32 s48, s48, s60
L_rdone:
    s_cmp_lt_u32 s48, 32
    s_cbranch_scc1 L_chain
    s_sub_u32 s84, s48, 32
    s_lshl_b32 s64, s3, 12
    s_add_u32 s65, s64, 16384
    s_mov_b32 s86, 0
    s_mov_b32 s87, 0
    s_mov_b32 s88, 0
    s_mov_b32 s89, 0
    s_mov_b32 s90, 0
    s_mov_b32 s91, 0
    s_mov_b32 s92, 0
    s_mov_b32 s93, 0
    s_cmp_lg_u32 s84, 223
    s_cbranch_scc1 L_nz_3
    v_mov_b32 v8, 0
    v_mov_b32 v9, 0
    v_mov_b32 v10, 0
    v_mov_b32 v11, 0
    v_lshlrev_b32 v12, 4, v0
    s_mov_b32 s60, 133169152
    buffer_store_dwordx4 v[8:11], v12, s[32:35], s60 offen sc1
    s_mov_b32 s60, 133173248
    buffer_store_dwordx4 v[8:11], v12, s[32:35], s60 offen sc1
    s_mov_b32 s60, 133177344
    buffer_store_dwordx4 v[8:11], v12, s[32:35], s60 offen sc1
    s_mov_b32 s60, 133181440
    buffer_store_dwordx4 v[8:11], v12, s[32:35], s60 offen sc1
    s_mov_b32 s60, 133185536
    buffer_store_dwordx4 v[8:11], v12, s[32:35], s60 offen sc1
    s_mov_b32 s60, 133300224
    buffer_store_dwordx4 v[8:11], v12, s[32:35], s60 offen sc1
    s_mov_b32 s60, 133304320
    buffer_store_dwordx4 v[8:11], v12, s[32:35], s60 offen sc1
    s_mov_b32 s60, 133308416
    buffer_store_dwordx4 v[8:11], v12, s[32:35], s60 offen sc1
    s_mov_b32 s60, 133312512
    buffer_store_dwordx4 v[8:11], v12, s[32:35], s60 offen sc1
    s_mov_b32 s60, 133316608
    buffer_store_dwordx4 v[8:11], v12, s[32:35], s60 offen sc1
    s_mov_b32 s60, 133320704
    buffer_store_dwordx4 v[8:11], v12, s[32:35], s60 offen sc1
    s_mov_b32 s60, 133324800
    buffer_store_dwordx4 v[8:11], v12, s[32:35], s60 offen sc1
    s_mov_b32 s60, 133328896
    buffer_store_dwordx4 v[8:11], v12, s[32:35], s60 offen sc1
    s_mov_b32 s60, 133332992
    buffer_store_dwordx4 v[8:11], v12, s[32:35], s60 offen sc1
    s_mov_b32 s60, 133337088
    buffer_store_dwordx4 v[8:11], v12, s[32:35], s60 offen sc1
    s_mov_b32 s60, 133341184
    buffer_store_dwordx4 v[8:11], v12, s[32:35], s60 offen sc1
    s_mov_b32 s60, 133345280
    buffer_store_dwordx4 v[8:11], v12, s[32:35], s60 offen sc1
    s_mov_b32 s60, 133349376
    buffer_store_dwordx4 v[8:11], v12, s[32:35], s60 offen sc1
    s_mov_b32 s60, 133353472
    buffer_store_dwordx4 v[8:11], v12, s[32:35], s60 offen sc1
    s_mov_b32 s60, 133357568
    buffer_store_dwordx4 v[8:11], v12, s[32:35], s60 offen sc1
    s_mov_b32 s60, 133361664
    buffer_store_dwordx4 v[8:11], v12, s[32:35], s60 offen sc1
    s_mov_b32 s60, 133365760
    buffer_store_dwordx4 v[8:11], v12, s[32:35], s60 offen sc1
    s_mov_b32 s60, 133369856
    buffer_store_dwordx4 v[8:11], v12, s[32:35], s60 offen sc1
    s_mov_b32 s60, 133373952
    buffer_store_dwordx4 v[8:11], v12, s[32:35], s60 offen sc1
    s_mov_b32 s60, 133378048
    buffer_store_dwordx4 v[8:11], v12, s[32:35], s60 offen sc1
    s_mov_b32 s60, 133382144
    buffer_store_dwordx4 v[8:11], v12, s[32:35], s60 offen sc1
    s_mov_b32 s60, 133386240
    buffer_store_dwordx4 v[8:11], v12, s[32:35], s60 offen sc1
    s_waitcnt vmcnt(0)
    s_barrier
    s_cmp_lg_u32 s3, 0
    s_cbranch_scc1 L_nz2_4
    v_mov_b32 v8, 44
    v_mov_b32 v9, 1
    s_mov_b64 exec, 1
    global_atomic_add v8, v9, s[28:29] sc1
    s_mov_b64 exec, -1
L_nz2_4:
L_nz_3:
    s_sub_u32 s48, s84, 64
    s_cmp_ge_u32 s48, 32
    s_cbranch_scc1 L_nri_5
    s_lshl_b32 s57, s3, 11
    s_lshl_b32 s56, s48, 8
    s_lshl_b32 s54, s3, 16
    s_lshl_b32 s66, s48, 6
    s_add_u32 s54, s54, s66
    s_lshl_b32 s55, s48, 13
    s_add_u32 s55, s55, s57
    s_mov_b32 s64, 0x3e0293ee
    s_mov_b32 s65, 0
    v_mov_b32 v8, v1
    v_lshlrev_b32 v1, 4, v8
    v_bfe_u32 v9, v8, 1, 1
    v_cmp_eq_u32 vcc, 1, v9
    v_mov_b32 v10, 0x4444
    v_mov_b32 v11, 0xeeee
    v_cndmask_b32 v0, v10, v11, vcc
    v_and_b32 v10, 15, v8
    v_cmp_le_u32 vcc, 8, v10
    s_nop 0
    s_mov_b64 s[62:63], vcc
    v_lshrrev_b32 v11, 4, v8
    v_lshrrev_b32 v12, 3, v10
    v_lshlrev_b32 v12, 13, v12
    v_lshl_add_u32 v12, v11, 11, v12
    v_and_b32 v13, 7, v10
    v_lshl_add_u32 v2, v13, 3, v12
    s_lshl_b32 s66, s3, 9
    s_add_u32 s66, s66, 155648
    v_lshlrev_b32 v12, 4, v10
    v_lshl_add_u32 v12, v11, 2, v12
    v_add_u32 v3, s66, v12
    s_lshl_b32 s66, s3, 10
    s_add_u32 s66, s66, 147456
    v_lshlrev_b32 v12, 5, v10
    v_lshl_add_u32 v12, v11, 3, v12
    v_add_u32 v4, s66, v12
    v_lshrrev_b32 v12, 5, v8
    v_lshlrev_b32 v12, 4, v12
    v_bfe_u32 v13, v8, 4, 1
    v_lshl_add_u32 v12, v13, 2, v12
    v_bfe_u32 v13, v8, 2, 2
    v_add_u32 v12, v12, v13
    v_and_b32 v13, 1, v8
    v_lshlrev_b32 v13, 3, v13
    v_lshl_add_u32 v13, v12, 4, v13
    v_add_u32 v5, 155648, v13
    v_and_b32 v13, 3, v8
    v_lshlrev_b32 v13, 3, v13
    v_lshl_add_u32 v13, v12, 5, v13
    v_add_u32 v6, 147456, v13
    v_add_u32 v7, s57, v1
    v_and_b32 v12, 7, v10
    v_mul_u32_u24 v12, 272, v12
    v_lshrrev_b32 v13, 3, v10
    v_lshl_add_u32 v12, v13, 5, v12
    v_lshl_add_u32 v12, v11, 2, v12
    s_lshl_b32 s66, s3, 6
    s_add_u32 s66, s66, 151552
    v_add_u32 v16, s66, v12
    v_lshrrev_b32 v12, 2, v10
    v_and_b32 v13, 1, v10
    v_lshl_add_u32 v12, v12, 1, v13
    v_mul_u32_u24 v12, 272, v12
    v_lshl_add_u32 v12, v11, 5, v12
    v_lshl_add_u32 v12, v9, 4, v12
    v_add_u32 v17, 151552, v12
    v_lshrrev_b32 v12, 2, v10
    v_lshlrev_b32 v12, 6, v12
    v_lshl_add_u32 v12, v11, 5, v12
    v_and_b32 v13, 3, v10
    v_lshl_add_u32 v18, v13, 2, v12
    v_lshlrev_b32 v12, 13, v11
    v_lshl_add_u32 v19, v10, 4, v12
    v_lshlrev_b32 v12, 5, v11
    v_bfe_u32 v13, v10, 2, 1
    v_lshl_add_u32 v12, v13, 4, v12
    v_and_b32 v13, 3, v10
    v_lshl_add_u32 v28, v13, 2, v12
    v_lshlrev_b32 v29, 4, v8
    v_bfe_u32 v13, v10, 2, 1
    v_cmp_eq_u32 vcc, 1, v13
    s_nop 0
    s_mov_b64 s[76:77], vcc
    v_and_b32 v12, 1, v10
    v_cmp_eq_u32 vcc, 1, v12
    v_mov_b32 v12, 0x3f80
    v_mov_b32 v13, 0x3f800000
    v_cndmask_b32 v12, v12, v13, vcc
    v_lshrrev_b32 v13, 2, v10
    v_cmp_eq_u32 vcc, 0, v13
    s_nop 1
    v_cndmask_b32 v20, 0, v12, vcc
    v_cmp_eq_u32 vcc, 1, v13
    s_nop 1
    v_cndmask_b32 v21, 0, v12, vcc
    v_cmp_eq_u32 vcc, 0, v13
    s_nop 1
    v_cndmask_b32 v22, 0, v12, vcc
    v_cmp_eq_u32 vcc, 1, v13
    s_nop 1
    v_cndmask_b32 v23, 0, v12, vcc
    v_mov_b32 v24, -1
    v_mov_b32 v25, -1
    v_mov_b32 v26, -1
    v_mov_b32 v27, -1
    s_add_u32 s67, s55, 132120576
    buffer_store_dwordx4 v[24:27], v1, s[32:35], s67 offen sc1
    buffer_store_dwordx4 v[24:27], v1, s[32:35], s67 offen offset:1024 sc1
    s_add_u32 s67, s55, 132382720
    buffer_store_dwordx4 v[24:27], v1, s[32:35], s67 offen sc1
    buffer_store_dwordx4 v[24:27], v1, s[32:35], s67 offen offset:1024 sc1
    s_cmp_lg_u32 s3, 0
    s_cbranch_scc1 L_ri_6
    s_mov_b64 exec, 0xffff
    s_add_u32 s67, s56, 132915200
    buffer_store_dwordx4 v[24:27], v1, s[32:35], s67 offen sc1
    s_add_u32 s67, s56, 132923392
    buffer_store_dwordx4 v[24:27], v1, s[32:35], s67 offen sc1
    s_mov_b64 exec, 0xffffffff
    s_mov_b32 s40, s6
    s_and_b32 s41, s7, 0xffff
    s_mov_b32 s42, 8192
    s_mov_b32 s43, 0x20000
    v_bfe_u32 v12, v8, 2, 2
    v_lshlrev_b32 v12, 11, v12
    v_and_b32 v13, 3, v8
    v_lshl_add_u32 v12, v13, 2, v12
    v_lshrrev_b32 v13, 4, v8
    v_lshl_add_u32 v12, v13, 1, v12
    s_lshr_b32 s67, s48, 1
    s_lshl_b32 s67, s67, 6
    s_and_b32 s68, s48, 1
    s_lshl_b32 s68, s68, 4
    s_add_u32 s67, s67, s68
    buffer_load_ushort v24, v12, s[40:43], s67 offen offset:0
    buffer_load_ushort v25, v12, s[40:43], s67 offen offset:32
    buffer_load_ushort v26, v12, s[40:43], s67 offen offset:1024
    buffer_load_ushort v27, v12, s[40:43], s67 offen offset:1056
    s_waitcnt vmcnt(0)
    v_lshl_or_b32 v24, v25, 16, v24
    v_lshl_or_b32 v25, v27, 16, v26
    s_add_u32 s67, s56, 132907008
    buffer_store_dword v24, v18, s[32:35], s67 offen sc1
    buffer_store_dword v25, v18, s[32:35], s67 offen offset:16 sc1
    s_mov_b64 exec, -1
L_ri_6:
    v_lshrrev_b32 v1, 4, v1
    s_waitcnt vmcnt(0)
    s_barrier
    s_cmp_lg_u32 s3, 0
    s_cbranch_scc1 L_nri2_7
    v_mov_b32 v8, 44
    v_mov_b32 v9, 1
    s_mov_b64 exec, 1
    global_atomic_add v8, v9, s[28:29] sc1
    s_mov_b64 exec, -1
L_nri2_7:
L_nri_5:
    s_lshr_b32 s96, s84, 5
    s_and_b32 s97, s84, 31
    s_mov_b32 s48, s84
    s_cmp_ge_u32 s48, 64
    s_cbranch_scc1 L_b_gate
    s_mov_b32 s40, s4
    s_and_b32 s41, s5, 0xffff
    s_mov_b32 s42, 2097152
    s_mov_b32 s43, 0x20000
    s_lshl_b32 s60, s48, 5
    s_lshl_b32 s61, s3, 3
    s_add_u32 s60, s60, s61
    s_lshl_b32 s60, s60, 10
    v_lshlrev_b32 v2, 4, v1
    s_add_u32 s61, s60, 0
    buffer_load_dwordx4 v[8:11], v2, s[40:43], s61 offen
    s_add_u32 s61, s60, 1024
    buffer_load_dwordx4 v[12:15], v2, s[40:43], s61 offen
    s_add_u32 s61, s60, 2048
    buffer_load_dwordx4 v[16:19], v2, s[40:43], s61 offen
    s_add_u32 s61, s60, 3072
    buffer_load_dwordx4 v[20:23], v2, s[40:43], s61 offen
    s_add_u32 s61, s60, 4096
    buffer_load_dwordx4 v[24:27], v2, s[40:43], s61 offen
    s_add_u32 s61, s60, 5120
    buffer_load_dwordx4 v[28:31], v2, s[40:43], s61 offen
    s_add_u32 s61, s60, 6144
    buffer_load_dwordx4 v[32:35], v2, s[40:43], s61 offen
    s_add_u32 s61, s60, 7168
    buffer_load_dwordx4 v[36:39], v2, s[40:43], s61 offen
    s_mov_b32 s62, 0x3b000000
    s_mov_b32 s63, 0x3727c5ac
    s_waitcnt vmcnt(7)
    v_lshlrev_b32 v40, 16, v8
    v_and_b32 v41, 0xffff0000, v8
    v_lshlrev_b32 v42, 16, v9
    v_and_b32 v43, 0xffff0000, v9
    v_lshlrev_b32 v44, 16, v10
    v_and_b32 v45, 0xffff0000, v10
    v_lshlrev_b32 v46, 16, v11
    v_and_b32 v47, 0xffff0000, v11
    v_add_f32 v48, v40, v41
    v_add_f32 v48, v48, v42
    v_add_f32 v48, v48, v43
    v_add_f32 v48, v48, v44
    v_add_f32 v48, v48, v45
    v_add_f32 v48, v48, v46
    v_add_f32 v48, v48, v47
    s_nop 1
    v_add_f32_dpp v48, v48, v48 row_ror:8 row_mask:0xf bank_mask:0xf
    s_nop 1
    v_add_f32_dpp v48, v48, v48 row_ror:4 row_mask:0xf bank_mask:0xf
    s_nop 1
    v_add_f32_dpp v48, v48, v48 row_ror:2 row_mask:0xf bank_mask:0xf
    s_nop 1
    v_add_f32_dpp v48, v48, v48 row_ror:1 row_mask:0xf bank_mask:0xf
    v_mov_b32 v49, v48
    s_nop 1
    v_permlane16_swap_b32 v48, v49
    v_add_f32 v48, v48, v49
    v_mov_b32 v49, v48
    s_nop 1
    v_permlane32_swap_b32 v48, v49
    v_add_f32 v48, v48, v49
    v_mul_f32 v48, s62, v48
    v_sub_f32 v40, v40, v48
    v_sub_f32 v41, v41, v48
    v_sub_f32 v42, v42, v48
    v_sub_f32 v43, v43, v48
    v_sub_f32 v44, v44, v48
    v_sub_f32 v45, v45, v48
    v_sub_f32 v46, v46, v48
    v_sub_f32 v47, v47, v48
    v_mul_f32 v48, v40, v40
    v_fmac_f32 v48, v41, v41
    v_fmac_f32 v48, v42, v42
    v_fmac_f32 v48, v43, v43
    v_fmac_f32 v48, v44, v44
    v_fmac_f32 v48, v45, v45
    v_fmac_f32 v48, v46, v46
    v_fmac_f32 v48, v47, v47
    s_nop 1
    v_add_f32_dpp v48, v48, v48 row_ror:8 row_mask:0xf bank_mask:0xf
    s_nop 1
    v_add_f32_dpp v48, v48, v48 row_ror:4 row_mask:0xf bank_mask:0xf
    s_nop 1
    v_add_f32_dpp v48, v48, v48 row_ror:2 row_mask:0xf bank_mask:0xf
    s_nop 1
    v_add_f32_dpp v48, v48, v48 row_ror:1 row_mask:0xf bank_mask:0xf
    v_mov_b32 v49, v48
    s_nop 1
    v_permlane16_swap_b32 v48, v49
    v_add_f32 v48, v48, v49
    v_mov_b32 v49, v48
    s_nop 1
    v_permlane32_swap_b32 v48, v49
    v_add_f32 v48, v48, v49
    v_mov_b32 v49, s63
    v_fmac_f32 v49, s62, v48
    v_rsq_f32 v49, v49
    s_nop 0
    v_mul_f32 v40, v40, v49
    v_mul_f32 v41, v41, v49
    v_mul_f32 v42, v42, v49
    v_mul_f32 v43, v43, v49
    v_mul_f32 v44, v44, v49
    v_mul_f32 v45, v45, v49
    v_mul_f32 v46, v46, v49
    v_mul_f32 v47, v47, v49
    v_cvt_pk_bf16_f32 v8, v40, v41
    v_cvt_pk_bf16_f32 v9, v42, v43
    v_cvt_pk_bf16_f32 v10, v44, v45
    v_cvt_pk_bf16_f32 v11, v46, v47
    s_add_u32 s61, s60, 0
    buffer_store_dwordx4 v[8:11], v2, s[32:35], s61 offen sc1
    s_waitcnt vmcnt(6)
    v_lshlrev_b32 v40, 16, v12
    v_and_b32 v41, 0xffff0000, v12
    v_lshlrev_b32 v42, 16, v13
    v_and_b32 v43, 0xffff0000, v13
    v_lshlrev_b32 v44, 16, v14
    v_and_b32 v45, 0xffff0000, v14
    v_lshlrev_b32 v46, 16, v15
    v_and_b32 v47, 0xffff0000, v15
    v_add_f32 v48, v40, v41
    v_add_f32 v48, v48, v42
    v_add_f32 v48, v48, v43
    v_add_f32 v48, v48, v44
    v_add_f32 v48, v48, v45
    v_add_f32 v48, v48, v46
    v_add_f32 v48, v48, v47
    s_nop 1
    v_add_f32_dpp v48, v48, v48 row_ror:8 row_mask:0xf bank_mask:0xf
    s_nop 1
    v_add_f32_dpp v48, v48, v48 row_ror:4 row_mask:0xf bank_mask:0xf
    s_nop 1
    v_add_f32_dpp v48, v48, v48 row_ror:2 row_mask:0xf bank_mask:0xf
    s_nop 1
    v_add_f32_dpp v48, v48, v48 row_ror:1 row_mask:0xf bank_mask:0xf
    v_mov_b32 v49, v48
    s_nop 1
    v_permlane16_swap_b32 v48, v49
    v_add_f32 v48, v48, v49
    v_mov_b32 v49, v48
    s_nop 1
    v_permlane32_swap_b32 v48, v49
    v_add_f32 v48, v48, v49
    v_mul_f32 v48, s62, v48
    v_sub_f32 v40, v40, v48
    v_sub_f32 v41, v41, v48
    v_sub_f32 v42, v42, v48
    v_sub_f32 v43, v43, v48
    v_sub_f32 v44, v44, v48
    v_sub_f32 v45, v45, v48
    v_sub_f32 v46, v46, v48
    v_sub_f32 v47, v47, v48
    v_mul_f32 v48, v40, v40
    v_fmac_f32 v48, v41, v41
    v_fmac_f32 v48, v42, v42
    v_fmac_f32 v48, v43, v43
    v_fmac_f32 v48, v44, v44
    v_fmac_f32 v48, v45, v45
    v_fmac_f32 v48, v46, v46
    v_fmac_f32 v48, v47, v47
    s_nop 1
    v_add_f32_dpp v48, v48, v48 row_ror:8 row_mask:0xf bank_mask:0xf
    s_nop 1
    v_add_f32_dpp v48, v48, v48 row_ror:4 row_mask:0xf bank_mask:0xf
    s_nop 1
    v_add_f32_dpp v48, v48, v48 row_ror:2 row_mask:0xf bank_mask:0xf
    s_nop 1
    v_add_f32_dpp v48, v48, v48 row_ror:1 row_mask:0xf bank_mask:0xf
    v_mov_b32 v49, v48
    s_nop 1
    v_permlane16_swap_b32 v48, v49
    v_add_f32 v48, v48, v49
    v_mov_b32 v49, v48
    s_nop 1
    v_permlane32_swap_b32 v48, v49
    v_add_f32 v48, v48, v49
    v_mov_b32 v49, s63
    v_fmac_f32 v49, s62, v48
    v_rsq_f32 v49, v49
    s_nop 0
    v_mul_f32 v40, v40, v49
    v_mul_f32 v41, v41, v49
    v_mul_f32 v42, v42, v49
    v_mul_f32 v43, v43, v49
    v_mul_f32 v44, v44, v49
    v_mul_f32 v45, v45, v49
    v_mul_f32 v46, v46, v49
    v_mul_f32 v47, v47, v49
    v_cvt_pk_bf16_f32 v12, v40, v41
    v_cvt_pk_bf16_f32 v13, v42, v43
    v_cvt_pk_bf16_f32 v14, v44, v45
    v_cvt_pk_bf16_f32 v15, v46, v47
    s_add_u32 s61, s60, 1024
    buffer_store_dwordx4 v[12:15], v2, s[32:35], s61 offen sc1
    s_waitcnt vmcnt(5)
    v_lshlrev_b32 v40, 16, v16
    v_and_b32 v41, 0xffff0000, v16
    v_lshlrev_b32 v42, 16, v17
    v_and_b32 v43, 0xffff0000, v17
    v_lshlrev_b32 v44, 16, v18
    v_and_b32 v45, 0xffff0000, v18
    v_lshlrev_b32 v46, 16, v19
    v_and_b32 v47, 0xffff0000, v19
    v_add_f32 v48, v40, v41
    v_add_f32 v48, v48, v42
    v_add_f32 v48, v48, v43
    v_add_f32 v48, v48, v44
    v_add_f32 v48, v48, v45
    v_add_f32 v48, v48, v46
    v_add_f32 v48, v48, v47
    s_nop 1
    v_add_f32_dpp v48, v48, v48 row_ror:8 row_mask:0xf bank_mask:0xf
    s_nop 1
    v_add_f32_dpp v48, v48, v48 row_ror:4 row_mask:0xf bank_mask:0xf
    s_nop 1
    v_add_f32_dpp v48, v48, v48 row_ror:2 row_mask:0xf bank_mask:0xf
    s_nop 1
    v_add_f32_dpp v48, v48, v48 row_ror:1 row_mask:0xf bank_mask:0xf
    v_mov_b32 v49, v48
    s_nop 1
    v_permlane16_swap_b32 v48, v49
    v_add_f32 v48, v48, v49
    v_mov_b32 v49, v48
    s_nop 1
    v_permlane32_swap_b32 v48, v49
    v_add_f32 v48, v48, v49
    v_mul_f32 v48, s62, v48
    v_sub_f32 v40, v40, v48
    v_sub_f32 v41, v41, v48
    v_sub_f32 v42, v42, v48
    v_sub_f32 v43, v43, v48
    v_sub_f32 v44, v44, v48
    v_sub_f32 v45, v45, v48
    v_sub_f32 v46, v46, v48
    v_sub_f32 v47, v47, v48
    v_mul_f32 v48, v40, v40
    v_fmac_f32 v48, v41, v41
    v_fmac_f32 v48, v42, v42
    v_fmac_f32 v48, v43, v43
    v_fmac_f32 v48, v44, v44
    v_fmac_f32 v48, v45, v45
    v_fmac_f32 v48, v46, v46
    v_fmac_f32 v48, v47, v47
    s_nop 1
    v_add_f32_dpp v48, v48, v48 row_ror:8 row_mask:0xf bank_mask:0xf
    s_nop 1
    v_add_f32_dpp v48, v48, v48 row_ror:4 row_mask:0xf bank_mask:0xf
    s_nop 1
    v_add_f32_dpp v48, v48, v48 row_ror:2 row_mask:0xf bank_mask:0xf
    s_nop 1
    v_add_f32_dpp v48, v48, v48 row_ror:1 row_mask:0xf bank_mask:0xf
    v_mov_b32 v49, v48
    s_nop 1
    v_permlane16_swap_b32 v48, v49
    v_add_f32 v48, v48, v49
    v_mov_b32 v49, v48
    s_nop 1
    v_permlane32_swap_b32 v48, v49
    v_add_f32 v48, v48, v49
    v_mov_b32 v49, s63
    v_fmac_f32 v49, s62, v48
    v_rsq_f32 v49, v49
    s_nop 0
    v_mul_f32 v40, v40, v49
    v_mul_f32 v41, v41, v49
    v_mul_f32 v42, v42, v49
    v_mul_f32 v43, v43, v49
    v_mul_f32 v44, v44, v49
    v_mul_f32 v45, v45, v49
    v_mul_f32 v46, v46, v49
    v_mul_f32 v47, v47, v49
    v_cvt_pk_bf16_f32 v16, v40, v41
    v_cvt_pk_bf16_f32 v17, v42, v43
    v_cvt_pk_bf16_f32 v18, v44, v45
    v_cvt_pk_bf16_f32 v19, v46, v47
    s_add_u32 s61, s60, 2048
    buffer_store_dwordx4 v[16:19], v2, s[32:35], s61 offen sc1
    s_waitcnt vmcnt(4)
    v_lshlrev_b32 v40, 16, v20
    v_and_b32 v41, 0xffff0000, v20
    v_lshlrev_b32 v42, 16, v21
    v_and_b32 v43, 0xffff0000, v21
    v_lshlrev_b32 v44, 16, v22
    v_and_b32 v45, 0xffff0000, v22
    v_lshlrev_b32 v46, 16, v23
    v_and_b32 v47, 0xffff0000, v23
    v_add_f32 v48, v40, v41
    v_add_f32 v48, v48, v42
    v_add_f32 v48, v48, v43
    v_add_f32 v48, v48, v44
    v_add_f32 v48, v48, v45
    v_add_f32 v48, v48, v46
    v_add_f32 v48, v48, v47
    s_nop 1
    v_add_f32_dpp v48, v48, v48 row_ror:8 row_mask:0xf bank_mask:0xf
    s_nop 1
    v_add_f32_dpp v48, v48, v48 row_ror:4 row_mask:0xf bank_mask:0xf
    s_nop 1
    v_add_f32_dpp v48, v48, v48 row_ror:2 row_mask:0xf bank_mask:0xf
    s_nop 1
    v_add_f32_dpp v48, v48, v48 row_ror:1 row_mask:0xf bank_mask:0xf
    v_mov_b32 v49, v48
    s_nop 1
    v_permlane16_swap_b32 v48, v49
    v_add_f32 v48, v48, v49
    v_mov_b32 v49, v48
    s_nop 1
    v_permlane32_swap_b32 v48, v49
    v_add_f32 v48, v48, v49
    v_mul_f32 v48, s62, v48
    v_sub_f32 v40, v40, v48
    v_sub_f32 v41, v41, v48
    v_sub_f32 v42, v42, v48
    v_sub_f32 v43, v43, v48
    v_sub_f32 v44, v44, v48
    v_sub_f32 v45, v45, v48
    v_sub_f32 v46, v46, v48
    v_sub_f32 v47, v47, v48
    v_mul_f32 v48, v40, v40
    v_fmac_f32 v48, v41, v41
    v_fmac_f32 v48, v42, v42
    v_fmac_f32 v48, v43, v43
    v_fmac_f32 v48, v44, v44
    v_fmac_f32 v48, v45, v45
    v_fmac_f32 v48, v46, v46
    v_fmac_f32 v48, v47, v47
    s_nop 1
    v_add_f32_dpp v48, v48, v48 row_ror:8 row_mask:0xf bank_mask:0xf
    s_nop 1
    v_add_f32_dpp v48, v48, v48 row_ror:4 row_mask:0xf bank_mask:0xf
    s_nop 1
    v_add_f32_dpp v48, v48, v48 row_ror:2 row_mask:0xf bank_mask:0xf
    s_nop 1
    v_add_f32_dpp v48, v48, v48 row_ror:1 row_mask:0xf bank_mask:0xf
    v_mov_b32 v49, v48
    s_nop 1
    v_permlane16_swap_b32 v48, v49
    v_add_f32 v48, v48, v49
    v_mov_b32 v49, v48
    s_nop 1
    v_permlane32_swap_b32 v48, v49
    v_add_f32 v48, v48, v49
    v_mov_b32 v49, s63
    v_fmac_f32 v49, s62, v48
    v_rsq_f32 v49, v49
    s_nop 0
    v_mul_f32 v40, v40, v49
    v_mul_f32 v41, v41, v49
    v_mul_f32 v42, v42, v49
    v_mul_f32 v43, v43, v49
    v_mul_f32 v44, v44, v49
    v_mul_f32 v45, v45, v49
    v_mul_f32 v46, v46, v49
    v_mul_f32 v47, v47, v49
    v_cvt_pk_bf16_f32 v20, v40, v41
    v_cvt_pk_bf16_f32 v21, v42, v43
    v_cvt_pk_bf16_f32 v22, v44, v45
    v_cvt_pk_bf16_f32 v23, v46, v47
    s_add_u32 s61, s60, 3072
    buffer_store_dwordx4 v[20:23], v2, s[32:35], s61 offen sc1
    s_waitcnt vmcnt(3)
    v_lshlrev_b32 v40, 16, v24
    v_and_b32 v41, 0xffff0000, v24
    v_lshlrev_b32 v42, 16, v25
    v_and_b32 v43, 0xffff0000, v25
    v_lshlrev_b32 v44, 16, v26
    v_and_b32 v45, 0xffff0000, v26
    v_lshlrev_b32 v46, 16, v27
    v_and_b32 v47, 0xffff0000, v27
    v_add_f32 v48, v40, v41
    v_add_f32 v48, v48, v42
    v_add_f32 v48, v48, v43
    v_add_f32 v48, v48, v44
    v_add_f32 v48, v48, v45
    v_add_f32 v48, v48, v46
    v_add_f32 v48, v48, v47
    s_nop 1
    v_add_f32_dpp v48, v48, v48 row_ror:8 row_mask:0xf bank_mask:0xf
    s_nop 1
    v_add_f32_dpp v48, v48, v48 row_ror:4 row_mask:0xf bank_mask:0xf
    s_nop 1
    v_add_f32_dpp v48, v48, v48 row_ror:2 row_mask:0xf bank_mask:0xf
    s_nop 1
    v_add_f32_dpp v48, v48, v48 row_ror:1 row_mask:0xf bank_mask:0xf
    v_mov_b32 v49, v48
    s_nop 1
    v_permlane16_swap_b32 v48, v49
    v_add_f32 v48, v48, v49
    v_mov_b32 v49, v48
    s_nop 1
    v_permlane32_swap_b32 v48, v49
    v_add_f32 v48, v48, v49
    v_mul_f32 v48, s62, v48
    v_sub_f32 v40, v40, v48
    v_sub_f32 v41, v41, v48
    v_sub_f32 v42, v42, v48
    v_sub_f32 v43, v43, v48
    v_sub_f32 v44, v44, v48
    v_sub_f32 v45, v45, v48
    v_sub_f32 v46, v46, v48
    v_sub_f32 v47, v47, v48
    v_mul_f32 v48, v40, v40
    v_fmac_f32 v48, v41, v41
    v_fmac_f32 v48, v42, v42
    v_fmac_f32 v48, v43, v43
    v_fmac_f32 v48, v44, v44
    v_fmac_f32 v48, v45, v45
    v_fmac_f32 v48, v46, v46
    v_fmac_f32 v48, v47, v47
    s_nop 1
    v_add_f32_dpp v48, v48, v48 row_ror:8 row_mask:0xf bank_mask:0xf
    s_nop 1
    v_add_f32_dpp v48, v48, v48 row_ror:4 row_mask:0xf bank_mask:0xf
    s_nop 1
    v_add_f32_dpp v48, v48, v48 row_ror:2 row_mask:0xf bank_mask:0xf
    s_nop 1
    v_add_f32_dpp v48, v48, v48 row_ror:1 row_mask:0xf bank_mask:0xf
    v_mov_b32 v49, v48
    s_nop 1
    v_permlane16_swap_b32 v48, v49
    v_add_f32 v48, v48, v49
    v_mov_b32 v49, v48
    s_nop 1
    v_permlane32_swap_b32 v48, v49
    v_add_f32 v48, v48, v49
    v_mov_b32 v49, s63
    v_fmac_f32 v49, s62, v48
    v_rsq_f32 v49, v49
    s_nop 0
    v_mul_f32 v40, v40, v49
    v_mul_f32 v41, v41, v49
    v_mul_f32 v42, v42, v49
    v_mul_f32 v43, v43, v49
    v_mul_f32 v44, v44, v49
    v_mul_f32 v45, v45, v49
    v_mul_f32 v46, v46, v49
    v_mul_f32 v47, v47, v49
    v_cvt_pk_bf16_f32 v24, v40, v41
    v_cvt_pk_bf16_f32 v25, v42, v43
    v_cvt_pk_bf16_f32 v26, v44, v45
    v_cvt_pk_bf16_f32 v27, v46, v47
    s_add_u32 s61, s60, 4096
    buffer_store_dwordx4 v[24:27], v2, s[32:35], s61 offen sc1
    s_waitcnt vmcnt(2)
    v_lshlrev_b32 v40, 16, v28
    v_and_b32 v41, 0xffff0000, v28
    v_lshlrev_b32 v42, 16, v29
    v_and_b32 v43, 0xffff0000, v29
    v_lshlrev_b32 v44, 16, v30
    v_and_b32 v45, 0xffff0000, v30
    v_lshlrev_b32 v46, 16, v31
    v_and_b32 v47, 0xffff0000, v31
    v_add_f32 v48, v40, v41
    v_add_f32 v48, v48, v42
    v_add_f32 v48, v48, v43
    v_add_f32 v48, v48, v44
    v_add_f32 v48, v48, v45
    v_add_f32 v48, v48, v46
    v_add_f32 v48, v48, v47
    s_nop 1
    v_add_f32_dpp v48, v48, v48 row_ror:8 row_mask:0xf bank_mask:0xf
    s_nop 1
    v_add_f32_dpp v48, v48, v48 row_ror:4 row_mask:0xf bank_mask:0xf
    s_nop 1
    v_add_f32_dpp v48, v48, v48 row_ror:2 row_mask:0xf bank_mask:0xf
    s_nop 1
    v_add_f32_dpp v48, v48, v48 row_ror:1 row_mask:0xf bank_mask:0xf
    v_mov_b32 v49, v48
    s_nop 1
    v_permlane16_swap_b32 v48, v49
    v_add_f32 v48, v48, v49
    v_mov_b32 v49, v48
    s_nop 1
    v_permlane32_swap_b32 v48, v49
    v_add_f32 v48, v48, v49
    v_mul_f32 v48, s62, v48
    v_sub_f32 v40, v40, v48
    v_sub_f32 v41, v41, v48
    v_sub_f32 v42, v42, v48
    v_sub_f32 v43, v43, v48
    v_sub_f32 v44, v44, v48
    v_sub_f32 v45, v45, v48
    v_sub_f32 v46, v46, v48
    v_sub_f32 v47, v47, v48
    v_mul_f32 v48, v40, v40
    v_fmac_f32 v48, v41, v41
    v_fmac_f32 v48, v42, v42
    v_fmac_f32 v48, v43, v43
    v_fmac_f32 v48, v44, v44
    v_fmac_f32 v48, v45, v45
    v_fmac_f32 v48, v46, v46
    v_fmac_f32 v48, v47, v47
    s_nop 1
    v_add_f32_dpp v48, v48, v48 row_ror:8 row_mask:0xf bank_mask:0xf
    s_nop 1
    v_add_f32_dpp v48, v48, v48 row_ror:4 row_mask:0xf bank_mask:0xf
    s_nop 1
    v_add_f32_dpp v48, v48, v48 row_ror:2 row_mask:0xf bank_mask:0xf
    s_nop 1
    v_add_f32_dpp v48, v48, v48 row_ror:1 row_mask:0xf bank_mask:0xf
    v_mov_b32 v49, v48
    s_nop 1
    v_permlane16_swap_b32 v48, v49
    v_add_f32 v48, v48, v49
    v_mov_b32 v49, v48
    s_nop 1
    v_permlane32_swap_b32 v48, v49
    v_add_f32 v48, v48, v49
    v_mov_b32 v49, s63
    v_fmac_f32 v49, s62, v48
    v_rsq_f32 v49, v49
    s_nop 0
    v_mul_f32 v40, v40, v49
    v_mul_f32 v41, v41, v49
    v_mul_f32 v42, v42, v49
    v_mul_f32 v43, v43, v49
    v_mul_f32 v44, v44, v49
    v_mul_f32 v45, v45, v49
    v_mul_f32 v46, v46, v49
    v_mul_f32 v47, v47, v49
    v_cvt_pk_bf16_f32 v28, v40, v41
    v_cvt_pk_bf16_f32 v29, v42, v43
    v_cvt_pk_bf16_f32 v30, v44, v45
    v_cvt_pk_bf16_f32 v31, v46, v47
    s_add_u32 s61, s60, 5120
    buffer_store_dwordx4 v[28:31], v2, s[32:35], s61 offen sc1
    s_waitcnt vmcnt(1)
    v_lshlrev_b32 v40, 16, v32
    v_and_b32 v41, 0xffff0000, v32
    v_lshlrev_b32 v42, 16, v33
    v_and_b32 v43, 0xffff0000, v33
    v_lshlrev_b32 v44, 16, v34
    v_and_b32 v45, 0xffff0000, v34
    v_lshlrev_b32 v46, 16, v35
    v_and_b32 v47, 0xffff0000, v35
    v_add_f32 v48, v40, v41
    v_add_f32 v48, v48, v42
    v_add_f32 v48, v48, v43
    v_add_f32 v48, v48, v44
    v_add_f32 v48, v48, v45
    v_add_f32 v48, v48, v46
    v_add_f32 v48, v48, v47
    s_nop 1
    v_add_f32_dpp v48, v48, v48 row_ror:8 row_mask:0xf bank_mask:0xf
    s_nop 1
    v_add_f32_dpp v48, v48, v48 row_ror:4 row_mask:0xf bank_mask:0xf
    s_nop 1
    v_add_f32_dpp v48, v48, v48 row_ror:2 row_mask:0xf bank_mask:0xf
    s_nop 1
    v_add_f32_dpp v48, v48, v48 row_ror:1 row_mask:0xf bank_mask:0xf
    v_mov_b32 v49, v48
    s_nop 1
    v_permlane16_swap_b32 v48, v49
    v_add_f32 v48, v48, v49
    v_mov_b32 v49, v48
    s_nop 1
    v_permlane32_swap_b32 v48, v49
    v_add_f32 v48, v48, v49
    v_mul_f32 v48, s62, v48
    v_sub_f32 v40, v40, v48
    v_sub_f32 v41, v41, v48
    v_sub_f32 v42, v42, v48
    v_sub_f32 v43, v43, v48
    v_sub_f32 v44, v44, v48
    v_sub_f32 v45, v45, v48
    v_sub_f32 v46, v46, v48
    v_sub_f32 v47, v47, v48
    v_mul_f32 v48, v40, v40
    v_fmac_f32 v48, v41, v41
    v_fmac_f32 v48, v42, v42
    v_fmac_f32 v48, v43, v43
    v_fmac_f32 v48, v44, v44
    v_fmac_f32 v48, v45, v45
    v_fmac_f32 v48, v46, v46
    v_fmac_f32 v48, v47, v47
    s_nop 1
    v_add_f32_dpp v48, v48, v48 row_ror:8 row_mask:0xf bank_mask:0xf
    s_nop 1
    v_add_f32_dpp v48, v48, v48 row_ror:4 row_mask:0xf bank_mask:0xf
    s_nop 1
    v_add_f32_dpp v48, v48, v48 row_ror:2 row_mask:0xf bank_mask:0xf
    s_nop 1
    v_add_f32_dpp v48, v48, v48 row_ror:1 row_mask:0xf bank_mask:0xf
    v_mov_b32 v49, v48
    s_nop 1
    v_permlane16_swap_b32 v48, v49
    v_add_f32 v48, v48, v49
    v_mov_b32 v49, v48
    s_nop 1
    v_permlane32_swap_b32 v48, v49
    v_add_f32 v48, v48, v49
    v_mov_b32 v49, s63
    v_fmac_f32 v49, s62, v48
    v_rsq_f32 v49, v49
    s_nop 0
    v_mul_f32 v40, v40, v49
    v_mul_f32 v41, v41, v49
    v_mul_f32 v42, v42, v49
    v_mul_f32 v43, v43, v49
    v_mul_f32 v44, v44, v49
    v_mul_f32 v45, v45, v49
    v_mul_f32 v46, v46, v49
    v_mul_f32 v47, v47, v49
    v_cvt_pk_bf16_f32 v32, v40, v41
    v_cvt_pk_bf16_f32 v33, v42, v43
    v_cvt_pk_bf16_f32 v34, v44, v45
    v_cvt_pk_bf16_f32 v35, v46, v47
    s_add_u32 s61, s60, 6144
    buffer_store_dwordx4 v[32:35], v2, s[32:35], s61 offen sc1
    s_waitcnt vmcnt(0)
    v_lshlrev_b32 v40, 16, v36
    v_and_b32 v41, 0xffff0000, v36
    v_lshlrev_b32 v42, 16, v37
    v_and_b32 v43, 0xffff0000, v37
    v_lshlrev_b32 v44, 16, v38
    v_and_b32 v45, 0xffff0000, v38
    v_lshlrev_b32 v46, 16, v39
    v_and_b32 v47, 0xffff0000, v39
    v_add_f32 v48, v40, v41
    v_add_f32 v48, v48, v42
    v_add_f32 v48, v48, v43
    v_add_f32 v48, v48, v44
    v_add_f32 v48, v48, v45
    v_add_f32 v48, v48, v46
    v_add_f32 v48, v48, v47
    s_nop 1
    v_add_f32_dpp v48, v48, v48 row_ror:8 row_mask:0xf bank_mask:0xf
    s_nop 1
    v_add_f32_dpp v48, v48, v48 row_ror:4 row_mask:0xf bank_mask:0xf
    s_nop 1
    v_add_f32_dpp v48, v48, v48 row_ror:2 row_mask:0xf bank_mask:0xf
    s_nop 1
    v_add_f32_dpp v48, v48, v48 row_ror:1 row_mask:0xf bank_mask:0xf
    v_mov_b32 v49, v48
    s_nop 1
    v_permlane16_swap_b32 v48, v49
    v_add_f32 v48, v48, v49
    v_mov_b32 v49, v48
    s_nop 1
    v_permlane32_swap_b32 v48, v49
    v_add_f32 v48, v48, v49
    v_mul_f32 v48, s62, v48
    v_sub_f32 v40, v40, v48
    v_sub_f32 v41, v41, v48
    v_sub_f32 v42, v42, v48
    v_sub_f32 v43, v43, v48
    v_sub_f32 v44, v44, v48
    v_sub_f32 v45, v45, v48
    v_sub_f32 v46, v46, v48
    v_sub_f32 v47, v47, v48
    v_mul_f32 v48, v40, v40
    v_fmac_f32 v48, v41, v41
    v_fmac_f32 v48, v42, v42
    v_fmac_f32 v48, v43, v43
    v_fmac_f32 v48, v44, v44
    v_fmac_f32 v48, v45, v45
    v_fmac_f32 v48, v46, v46
    v_fmac_f32 v48, v47, v47
    s_nop 1
    v_add_f32_dpp v48, v48, v48 row_ror:8 row_mask:0xf bank_mask:0xf
    s_nop 1
    v_add_f32_dpp v48, v48, v48 row_ror:4 row_mask:0xf bank_mask:0xf
    s_nop 1
    v_add_f32_dpp v48, v48, v48 row_ror:2 row_mask:0xf bank_mask:0xf
    s_nop 1
    v_add_f32_dpp v48, v48, v48 row_ror:1 row_mask:0xf bank_mask:0xf
    v_mov_b32 v49, v48
    s_nop 1
    v_permlane16_swap_b32 v48, v49
    v_add_f32 v48, v48, v49
    v_mov_b32 v49, v48
    s_nop 1
    v_permlane32_swap_b32 v48, v49
    v_add_f32 v48, v48, v49
    v_mov_b32 v49, s63
    v_fmac_f32 v49, s62, v48
    v_rsq_f32 v49, v49
    s_nop 0
    v_mul_f32 v40, v40, v49
    v_mul_f32 v41, v41, v49
    v_mul_f32 v42, v42, v49
    v_mul_f32 v43, v43, v49
    v_mul_f32 v44, v44, v49
    v_mul_f32 v45, v45, v49
    v_mul_f32 v46, v46, v49
    v_mul_f32 v47, v47, v49
    v_cvt_pk_bf16_f32 v36, v40, v41
    v_cvt_pk_bf16_f32 v37, v42, v43
    v_cvt_pk_bf16_f32 v38, v44, v45
    v_cvt_pk_bf16_f32 v39, v46, v47
    s_add_u32 s61, s60, 7168
    buffer_store_dwordx4 v[36:39], v2, s[32:35], s61 offen sc1
    v_mov_b32 v8, 44
L_gate_8:
    global_load_dword v9, v8, s[28:29] sc1
    s_waitcnt vmcnt(0)
    v_readfirstlane_b32 s60, v9
    s_add_u32 s94, s94, 1
    s_cmp_gt_u32 s94, 3000000
    s_cbranch_scc1 L_exit
    s_cmp_lt_u32 s60, 33
    s_cbranch_scc1 L_gate_8
    s_lshr_b32 s55, s48, 2
    s_waitcnt vmcnt(0)
    s_barrier
    s_cmp_lg_u32 s3, 0
    s_cbranch_scc1 L_sg_9
    s_lshl_b32 s60, s55, 7
    s_add_u32 s60, s60, 133169152
    v_mov_b32 v8, 1
    s_mov_b64 exec, 1
    buffer_atomic_add v8, off, s[32:35], s60 sc1
    s_mov_b64 exec, -1
L_sg_9:
    s_branch L_b_kv0
L_b_gate:
    v_mov_b32 v8, 44
L_gate_10:
    global_load_dword v9, v8, s[28:29] sc1
    s_waitcnt vmcnt(0)
    v_readfirstlane_b32 s60, v9
    s_add_u32 s94, s94, 1
    s_cmp_gt_u32 s94, 3000000
    s_cbranch_scc1 L_exit
    s_cmp_lt_u32 s60, 33
    s_cbranch_scc1 L_gate_10
L_b_kv0:
    s_cmp_lt_u32 s96, 1
    s_cselect_b32 s98, 10, 9
    s_mov_b32 s60, 6554
    s_mov_b32 s61, 7282
    s_cselect_b32 s99, s60, s61
    s_mov_b32 s48, s97
L_kv_loop:
    s_lshl_b32 s60, s98, 4
    s_cmp_ge_u32 s48, s60
    s_cbranch_scc1 L_kv_done
    s_mul_i32 s55, s48, s99
    s_lshr_b32 s55, s55, 16
    s_mul_i32 s60, s55, s98
    s_sub_u32 s60, s48, s60
    s_mul_i32 s60, s60, 7
    s_add_u32 s58, s60, s96
    s_and_b32 s56, s58, 31
    s_bitcmp1_b32 s86, s55
    s_cbranch_scc1 L_wf_11
    v_lshlrev_b32 v8, 7, v1
    s_mov_b32 s60, 133169152
L_wfl_12:
    s_mov_b64 exec, 0xffff
    buffer_load_dword v9, v8, s[32:35], s60 offen sc1
    s_waitcnt vmcnt(0)
    v_cmp_le_u32 vcc, 4, v9
    s_mov_b64 exec, -1
    s_mov_b32 s86, vcc_lo
    s_add_u32 s94, s94, 1
    s_cmp_gt_u32 s94, 3000000
    s_cbranch_scc1 L_exit
    s_bitcmp1_b32 s86, s55
    s_cbranch_scc1 L_wf_11
    s_sleep 8
    s_branch L_wfl_12
L_wf_11:
    s_bitcmp1_b32 s58, 5
    s_cbranch_scc1 L_b_v
    s_mov_b32 s36, s10
    s_and_b32 s37, s11, 0xffff
    s_mov_b32 s38, 4194304
    s_mov_b32 s39, 0x20000
    s_lshr_b32 s60, s3, 1
    s_and_b32 s61, s3, 1
    v_and_b32 v24, 31, v1
    s_lshl_b32 s62, s60, 6
    v_add_u32 v24, s62, v24
    v_bfe_u32 v25, v24, 1, 3
    v_lshrrev_b32 v26, 5, v1
    v_lshlrev_b32 v24, 7, v24
    v_add_u32 v27, 0, v26
    v_xor_b32 v27, v27, v25
    v_lshl_add_u32 v8, v27, 4, v24
    v_add_u32 v27, 2, v26
    v_xor_b32 v27, v27, v25
    v_lshl_add_u32 v9, v27, 4, v24
    v_add_u32 v27, 4, v26
    v_xor_b32 v27, v27, v25
    v_lshl_add_u32 v10, v27, 4, v24
    v_add_u32 v27, 6, v26
    v_xor_b32 v27, v27, v25
    v_lshl_add_u32 v11, v27, 4, v24
    v_bfe_u32 v24, v1, 2, 2
    v_lshrrev_b32 v25, 5, v1
    v_mul_u32_u24 v25, 8, v25
    v_add_u32 v25, v25, v24
    v_lshlrev_b32 v25, 7, v25
    v_lshrrev_b32 v24, 1, v24
    v_lshlrev_b32 v24, 2, v24
    v_bfe_u32 v26, v1, 4, 1
    v_lshlrev_b32 v26, 1, v26
    v_bfe_u32 v27, v1, 1, 1
    v_add_u32 v26, v26, v27
    v_and_b32 v27, 1, v1
    v_lshlrev_b32 v27, 3, v27
    v_add_u32 v25, v25, v27
    v_add_u32 v28, 0, v26
    v_xor_b32 v28, v28, v24
    v_lshl_add_u32 v28, v28, 4, v25
    s_lshl_b32 s62, s61, 13
    s_add_u32 s62, s62, 16384
    v_add_u32 v12, s62, v28
    v_add_u32 v28, 4, v26
    v_xor_b32 v28, v28, v24
    v_lshl_add_u32 v28, v28, 4, v25
    s_lshl_b32 s62, s61, 13
    s_add_u32 s62, s62, 16384
    v_add_u32 v13, s62, v28
    v_lshrrev_b32 v24, 3, v1
    v_and_b32 v25, 7, v1
    v_lshrrev_b32 v26, 4, v1
    s_mov_b32 s62, 1024
    v_mul_lo_u32 v27, s62, v24
    v_xor_b32 v28, v25, v26
    v_lshl_add_u32 v20, v28, 4, v27
    v_add_u32 v28, 4, v26
    v_xor_b32 v28, v25, v28
    v_lshl_add_u32 v21, v28, 4, v27
    s_mov_b32 s62, 8192
    v_mul_lo_u32 v27, s62, v24
    v_bfe_u32 v26, v1, 4, 1
    v_lshlrev_b32 v26, 2, v26
    v_xor_b32 v25, v25, v26
    v_lshl_add_u32 v22, v25, 4, v27
    s_lshl_b32 s49, s55, 17
    s_lshl_b32 s60, s3, 15
    s_add_u32 s49, s49, s60
    s_lshl_b32 s50, s56, 8
    s_lshr_b32 s60, s3, 1
    s_lshl_b32 s60, s60, 7
    s_add_u32 s50, s50, s60
    s_and_b32 s60, s3, 1
    s_lshl_b32 s60, s60, 18
    s_add_u32 s50, s50, s60
    s_mov_b32 s51, 8
    s_lshl_b32 s64, s3, 12
    s_add_u32 s65, s64, 16384
    s_mov_b32 s53, 0
    s_mov_b32 s52, 0
    s_mov_b32 s54, s51
    s_add_u32 s60, s49, 0
    s_add_u32 s61, s53, s64
    s_add_u32 m0, s61, 0
    s_nop 0
    buffer_load_dwordx4 v20, s[32:35], s60 offen sc1 lds
    s_add_u32 s60, s49, 8192
    s_add_u32 s61, s53, s64
    s_add_u32 m0, s61, 1024
    s_nop 0
    buffer_load_dwordx4 v21, s[32:35], s60 offen sc1 lds
    s_add_u32 s60, s49, 16384
    s_add_u32 s61, s53, s64
    s_add_u32 m0, s61, 2048
    s_nop 0
    buffer_load_dwordx4 v20, s[32:35], s60 offen sc1 lds
    s_add_u32 s60, s49, 24576
    s_add_u32 s61, s53, s64
    s_add_u32 m0, s61, 3072
    s_nop 0
    buffer_load_dwordx4 v21, s[32:35], s60 offen sc1 lds
    s_add_u32 s60, s50, 0
    s_add_u32 s61, s53, s65
    s_add_u32 m0, s61, 0
    s_nop 0
    buffer_load_dwordx4 v22, s[36:39], s60 offen lds
    s_add_u32 s60, s50, 65536
    s_add_u32 s61, s53, s65
    s_add_u32 m0, s61, 1024
    s_nop 0
    buffer_load_dwordx4 v22, s[36:39], s60 offen lds
    s_add_u32 s60, s50, 131072
    s_add_u32 s61, s53, s65
    s_add_u32 m0, s61, 2048
    s_nop 0
    buffer_load_dwordx4 v22, s[36:39], s60 offen lds
    s_add_u32 s60, s50, 196608
    s_add_u32 s61, s53, s65
    s_add_u32 m0, s61, 3072
    s_nop 0
    buffer_load_dwordx4 v22, s[36:39], s60 offen lds
    s_add_u32 s49, s49, 128
    s_add_u32 s50, s50, 524288
    s_add_u32 s53, s53, 32768
    s_and_b32 s53, s53, 0x1ffff
    s_sub_u32 s54, s54, 1
    s_add_u32 s60, s49, 0
    s_add_u32 s61, s53, s64
    s_add_u32 m0, s61, 0
    s_nop 0
    buffer_load_dwordx4 v20, s[32:35], s60 offen sc1 lds
    s_add_u32 s60, s49, 8192
    s_add_u32 s61, s53, s64
    s_add_u32 m0, s61, 1024
    s_nop 0
    buffer_load_dwordx4 v21, s[32:35], s60 offen sc1 lds
    s_add_u32 s60, s49, 16384
    s_add_u32 s61, s53, s64
    s_add_u32 m0, s61, 2048
    s_nop 0
    buffer_load_dwordx4 v20, s[32:35], s60 offen sc1 lds
    s_add_u32 s60, s49, 24576
    s_add_u32 s61, s53, s64
    s_add_u32 m0, s61, 3072
    s_nop 0
    buffer_load_dwordx4 v21, s[32:35], s60 offen sc1 lds
    s_add_u32 s60, s50, 0
    s_add_u32 s61, s53, s65
    s_add_u32 m0, s61, 0
    s_nop 0
    buffer_load_dwordx4 v22, s[36:39], s60 offen lds
    s_add_u32 s60, s50, 65536
    s_add_u32 s61, s53, s65
    s_add_u32 m0, s61, 1024
    s_nop 0
    buffer_load_dwordx4 v22, s[36:39], s60 offen lds
    s_add_u32 s60, s50, 131072
    s_add_u32 s61, s53, s65
    s_add_u32 m0, s61, 2048
    s_nop 0
    buffer_load_dwordx4 v22, s[36:39], s60 offen lds
    s_add_u32 s60, s50, 196608
    s_add_u32 s61, s53, s65
    s_add_u32 m0, s61, 3072
    s_nop 0
    buffer_load_dwordx4 v22, s[36:39], s60 offen lds
    s_add_u32 s49, s49, 128
    s_add_u32 s50, s50, 524288
    s_add_u32 s53, s53, 32768
    s_and_b32 s53, s53, 0x1ffff
    s_sub_u32 s54, s54, 1
    s_add_u32 s60, s49, 0
    s_add_u32 s61, s53, s64
    s_add_u32 m0, s61, 0
    s_nop 0
    buffer_load_dwordx4 v20, s[32:35], s60 offen sc1 lds
    s_add_u32 s60, s49, 8192
    s_add_u32 s61, s53, s64
    s_add_u32 m0, s61, 1024
    s_nop 0
    buffer_load_dwordx4 v21, s[32:35], s60 offen sc1 lds
    s_add_u32 s60, s49, 16384
    s_add_u32 s61, s53, s64
    s_add_u32 m0, s61, 2048
    s_nop 0
    buffer_load_dwordx4 v20, s[32:35], s60 offen sc1 lds
    s_add_u32 s60, s49, 24576
    s_add_u32 s61, s53, s64
    s_add_u32 m0, s61, 3072
    s_nop 0
    buffer_load_dwordx4 v21, s[32:35], s60 offen sc1 lds
    s_add_u32 s60, s50, 0
    s_add_u32 s61, s53, s65
    s_add_u32 m0, s61, 0
    s_nop 0
    buffer_load_dwordx4 v22, s[36:39], s60 offen lds
    s_add_u32 s60, s50, 65536
    s_add_u32 s61, s53, s65
    s_add_u32 m0, s61, 1024
    s_nop 0
    buffer_load_dwordx4 v22, s[36:39], s60 offen lds
    s_add_u32 s60, s50, 131072
    s_add_u32 s61, s53, s65
    s_add_u32 m0, s61, 2048
    s_nop 0
    buffer_load_dwordx4 v22, s[36:39], s60 offen lds
    s_add_u32 s60, s50, 196608
    s_add_u32 s61, s53, s65
    s_add_u32 m0, s61, 3072
    s_nop 0
    buffer_load_dwordx4 v22, s[36:39], s60 offen lds
    s_add_u32 s49, s49, 128
    s_add_u32 s50, s50, 524288
    s_add_u32 s53, s53, 32768
    s_and_b32 s53, s53, 0x1ffff
    s_sub_u32 s54, s54, 1
    v_mov_b32 v128, 0
    v_mov_b32 v129, 0
    v_mov_b32 v130, 0
    v_mov_b32 v131, 0
    v_mov_b32 v132, 0
    v_mov_b32 v133, 0
    v_mov_b32 v134, 0
    v_mov_b32 v135, 0
    v_mov_b32 v136, 0
    v_mov_b32 v137, 0
    v_mov_b32 v138, 0
    v_mov_b32 v139, 0
    v_mov_b32 v140, 0
    v_mov_b32 v141, 0
    v_mov_b32 v142, 0
    v_mov_b32 v143, 0
    v_mov_b32 v144, 0
    v_mov_b32 v145, 0
    v_mov_b32 v146, 0
    v_mov_b32 v147, 0
    v_mov_b32 v148, 0
    v_mov_b32 v149, 0
    v_mov_b32 v150, 0
    v_mov_b32 v151, 0
    v_mov_b32 v152, 0
    v_mov_b32 v153, 0
    v_mov_b32 v154, 0
    v_mov_b32 v155, 0
    v_mov_b32 v156, 0
    v_mov_b32 v157, 0
    v_mov_b32 v158, 0
    v_mov_b32 v159, 0
    v_mov_b32 v160, 0
    v_mov_b32 v161, 0
    v_mov_b32 v162, 0
    v_mov_b32 v163, 0
    v_mov_b32 v164, 0
    v_mov_b32 v165, 0
    v_mov_b32 v166, 0
    v_mov_b32 v167, 0
    v_mov_b32 v168, 0
    v_mov_b32 v169, 0
    v_mov_b32 v170, 0
    v_mov_b32 v171, 0
    v_mov_b32 v172, 0
    v_mov_b32 v173, 0
    v_mov_b32 v174, 0
    v_mov_b32 v175, 0
    v_mov_b32 v176, 0
    v_mov_b32 v177, 0
    v_mov_b32 v178, 0
    v_mov_b32 v179, 0
    v_mov_b32 v180, 0
    v_mov_b32 v181, 0
    v_mov_b32 v182, 0
    v_mov_b32 v183, 0
    v_mov_b32 v184, 0
    v_mov_b32 v185, 0
    v_mov_b32 v186, 0
    v_mov_b32 v187, 0
    v_mov_b32 v188, 0
    v_mov_b32 v189, 0
    v_mov_b32 v190, 0
    v_mov_b32 v191, 0
    v_add_u32 v14, s52, v8
    v_add_u32 v15, s52, v9
    v_add_u32 v16, s52, v10
    v_add_u32 v17, s52, v11
    v_add_u32 v18, s52, v12
    v_add_u32 v19, s52, v13
    s_waitcnt vmcnt(16)
    s_barrier
    ds_read_b128 v[64:67], v14 offset:0
    ds_read_b128 v[68:71], v14 offset:4096
    ds_read_b64_tr_b16 v[72:73], v18 offset:0
    ds_read_b64_tr_b16 v[74:75], v18 offset:512
    ds_read_b64_tr_b16 v[76:77], v19 offset:0
    ds_read_b64_tr_b16 v[78:79], v19 offset:512
    ds_read_b128 v[80:83], v15 offset:0
    ds_read_b128 v[84:87], v15 offset:4096
    ds_read_b64_tr_b16 v[88:89], v18 offset:2048
    ds_read_b64_tr_b16 v[90:91], v18 offset:2560
    ds_read_b64_tr_b16 v[92:93], v19 offset:2048
    ds_read_b64_tr_b16 v[94:95], v19 offset:2560
L_gk_13:
    s_waitcnt lgkmcnt(6)
    v_mfma_f32_32x32x16_bf16 v[128:143], v[72:75], v[64:67], v[128:143]
    ds_read_b128 v[96:99], v16 offset:0
    ds_read_b128 v[100:103], v16 offset:4096
    v_mfma_f32_32x32x16_bf16 v[144:159], v[76:79], v[64:67], v[144:159]
    ds_read_b64_tr_b16 v[104:105], v18 offset:4096
    ds_read_b64_tr_b16 v[106:107], v18 offset:4608
    v_mfma_f32_32x32x16_bf16 v[160:175], v[72:75], v[68:71], v[160:175]
    ds_read_b64_tr_b16 v[108:109], v19 offset:4096
    ds_read_b64_tr_b16 v[110:111], v19 offset:4608
    v_mfma_f32_32x32x16_bf16 v[176:191], v[76:79], v[68:71], v[176:191]
    s_waitcnt lgkmcnt(6)
    v_mfma_f32_32x32x16_bf16 v[128:143], v[88:91], v[80:83], v[128:143]
    ds_read_b128 v[112:115], v17 offset:0
    ds_read_b128 v[116:119], v17 offset:4096
    v_mfma_f32_32x32x16_bf16 v[144:159], v[92:95], v[80:83], v[144:159]
    ds_read_b64_tr_b16 v[120:121], v18 offset:6144
    ds_read_b64_tr_b16 v[122:123], v18 offset:6656
    v_mfma_f32_32x32x16_bf16 v[160:175], v[88:91], v[84:87], v[160:175]
    ds_read_b64_tr_b16 v[124:125], v19 offset:6144
    ds_read_b64_tr_b16 v[126:127], v19 offset:6656
    v_mfma_f32_32x32x16_bf16 v[176:191], v[92:95], v[84:87], v[176:191]
    s_add_u32 s52, s52, 32768
    s_and_b32 s52, s52, 0x1ffff
    s_cmp_ge_u32 s51, 3
    s_cbranch_scc1 L_gw_14
    s_waitcnt vmcnt(0)
    s_branch L_gw_15
L_gw_14:
    s_waitcnt vmcnt(8)
L_gw_15:
    s_waitcnt lgkmcnt(6)
    s_barrier
    v_add_u32 v14, s52, v8
    v_add_u32 v15, s52, v9
    v_add_u32 v16, s52, v10
    v_add_u32 v17, s52, v11
    v_add_u32 v18, s52, v12
    v_add_u32 v19, s52, v13
    v_mfma_f32_32x32x16_bf16 v[128:143], v[104:107], v[96:99], v[128:143]
    ds_read_b128 v[64:67], v14 offset:0
    ds_read_b128 v[68:71], v14 offset:4096
    v_mfma_f32_32x32x16_bf16 v[144:159], v[108:111], v[96:99], v[144:159]
    ds_read_b64_tr_b16 v[72:73], v18 offset:0
    ds_read_b64_tr_b16 v[74:75], v18 offset:512
    v_mfma_f32_32x32x16_bf16 v[160:175], v[104:107], v[100:103], v[160:175]
    ds_read_b64_tr_b16 v[76:77], v19 offset:0
    ds_read_b64_tr_b16 v[78:79], v19 offset:512
    v_mfma_f32_32x32x16_bf16 v[176:191], v[108:111], v[100:103], v[176:191]
    s_waitcnt lgkmcnt(6)
    s_cmp_eq_u32 s54, 0
    s_cbranch_scc1 L_gnd_16
    v_mfma_f32_32x32x16_bf16 v[128:143], v[120:123], v[112:115], v[128:143]
    ds_read_b128 v[80:83], v15 offset:0
    ds_read_b128 v[84:87], v15 offset:4096
    s_add_u32 s60, s49, 0
    s_add_u32 s61, s53, s64
    s_add_u32 m0, s61, 0
    s_nop 0
    buffer_load_dwordx4 v20, s[32:35], s60 offen sc1 lds
    s_add_u32 s60, s49, 8192
    s_add_u32 s61, s53, s64
    s_add_u32 m0, s61, 1024
    s_nop 0
    buffer_load_dwordx4 v21, s[32:35], s60 offen sc1 lds
    v_mfma_f32_32x32x16_bf16 v[144:159], v[124:127], v[112:115], v[144:159]
    ds_read_b64_tr_b16 v[88:89], v18 offset:2048
    ds_read_b64_tr_b16 v[90:91], v18 offset:2560
    s_add_u32 s60, s49, 16384
    s_add_u32 s61, s53, s64
    s_add_u32 m0, s61, 2048
    s_nop 0
    buffer_load_dwordx4 v20, s[32:35], s60 offen sc1 lds
    s_add_u32 s60, s49, 24576
    s_add_u32 s61, s53, s64
    s_add_u32 m0, s61, 3072
    s_nop 0
    buffer_load_dwordx4 v21, s[32:35], s60 offen sc1 lds
    v_mfma_f32_32x32x16_bf16 v[160:175], v[120:123], v[116:119], v[160:175]
    ds_read_b64_tr_b16 v[92:93], v19 offset:2048
    ds_read_b64_tr_b16 v[94:95], v19 offset:2560
    s_add_u32 s60, s50, 0
    s_add_u32 s61, s53, s65
    s_add_u32 m0, s61, 0
    s_nop 0
    buffer_load_dwordx4 v22, s[36:39], s60 offen lds
    s_add_u32 s60, s50, 65536
    s_add_u32 s61, s53, s65
    s_add_u32 m0, s61, 1024
    s_nop 0
    buffer_load_dwordx4 v22, s[36:39], s60 offen lds
    v_mfma_f32_32x32x16_bf16 v[176:191], v[124:127], v[116:119], v[176:191]
    s_add_u32 s60, s50, 131072
    s_add_u32 s61, s53, s65
    s_add_u32 m0, s61, 2048
    s_nop 0
    buffer_load_dwordx4 v22, s[36:39], s60 offen lds
    s_add_u32 s60, s50, 196608
    s_add_u32 s61, s53, s65
    s_add_u32 m0, s61, 3072
    s_nop 0
    buffer_load_dwordx4 v22, s[36:39], s60 offen lds
    s_add_u32 s49, s49, 128
    s_add_u32 s50, s50, 524288
    s_add_u32 s53, s53, 32768
    s_and_b32 s53, s53, 0x1ffff
    s_sub_u32 s54, s54, 1
    s_branch L_gj_17
L_gnd_16:
    v_mfma_f32_32x32x16_bf16 v[128:143], v[120:123], v[112:115], v[128:143]
    ds_read_b128 v[80:83], v15 offset:0
    ds_read_b128 v[84:87], v15 offset:4096
    v_mfma_f32_32x32x16_bf16 v[144:159], v[124:127], v[112:115], v[144:159]
    ds_read_b64_tr_b16 v[88:89], v18 offset:2048
    ds_read_b64_tr_b16 v[90:91], v18 offset:2560
    v_mfma_f32_32x32x16_bf16 v[160:175], v[120:123], v[116:119], v[160:175]
    ds_read_b64_tr_b16 v[92:93], v19 offset:2048
    ds_read_b64_tr_b16 v[94:95], v19 offset:2560
    v_mfma_f32_32x32x16_bf16 v[176:191], v[124:127], v[116:119], v[176:191]
L_gj_17:
    s_sub_u32 s51, s51, 1
    s_cmp_gt_u32 s51, 0
    s_cbranch_scc1 L_gk_13
    s_waitcnt lgkmcnt(0)
    s_nop 15
    s_barrier
    s_mov_b32 s67, 2097152
    v_bfe_u32 v24, v1, 4, 1
    v_lshlrev_b32 v24, 12, v24
    v_lshrrev_b32 v25, 5, v1
    v_lshl_add_u32 v24, v25, 8, v24
    v_and_b32 v25, 15, v1
    v_lshl_add_u32 v24, v25, 4, v24
    s_lshr_b32 s60, s3, 1
    s_lshl_b32 s60, s60, 1
    s_lshl_b32 s61, s55, 2
    s_add_u32 s60, s60, s61
    s_lshl_b32 s60, s60, 5
    s_add_u32 s60, s60, s56
    s_lshl_b32 s60, s60, 13
    s_and_b32 s61, s3, 1
    s_lshl_b32 s61, s61, 11
    s_add_u32 s60, s60, s61
    s_add_u32 s60, s60, s67
    v_cvt_pk_bf16_f32 v28, v128, v129
    v_cvt_pk_bf16_f32 v29, v130, v131
    v_cvt_pk_bf16_f32 v30, v132, v133
    v_cvt_pk_bf16_f32 v31, v134, v135
    s_add_u32 s61, s60, 0
    buffer_store_dwordx4 v[28:31], v24, s[32:35], s61 offen sc1
    v_cvt_pk_bf16_f32 v32, v136, v137
    v_cvt_pk_bf16_f32 v33, v138, v139
    v_cvt_pk_bf16_f32 v34, v140, v141
    v_cvt_pk_bf16_f32 v35, v142, v143
    s_add_u32 s61, s60, 512
    buffer_store_dwordx4 v[32:35], v24, s[32:35], s61 offen sc1
    v_cvt_pk_bf16_f32 v36, v144, v145
    v_cvt_pk_bf16_f32 v37, v146, v147
    v_cvt_pk_bf16_f32 v38, v148, v149
    v_cvt_pk_bf16_f32 v39, v150, v151
    s_add_u32 s61, s60, 1024
    buffer_store_dwordx4 v[36:39], v24, s[32:35], s61 offen sc1
    v_cvt_pk_bf16_f32 v40, v152, v153
    v_cvt_pk_bf16_f32 v41, v154, v155
    v_cvt_pk_bf16_f32 v42, v156, v157
    v_cvt_pk_bf16_f32 v43, v158, v159
    s_add_u32 s61, s60, 1536
    buffer_store_dwordx4 v[40:43], v24, s[32:35], s61 offen sc1
    v_cvt_pk_bf16_f32 v28, v160, v161
    v_cvt_pk_bf16_f32 v29, v162, v163
    v_cvt_pk_bf16_f32 v30, v164, v165
    v_cvt_pk_bf16_f32 v31, v166, v167
    s_add_u32 s61, s60, 262144
    buffer_store_dwordx4 v[28:31], v24, s[32:35], s61 offen sc1
    v_cvt_pk_bf16_f32 v32, v168, v169
    v_cvt_pk_bf16_f32 v33, v170, v171
    v_cvt_pk_bf16_f32 v34, v172, v173
    v_cvt_pk_bf16_f32 v35, v174, v175
    s_add_u32 s61, s60, 262656
    buffer_store_dwordx4 v[32:35], v24, s[32:35], s61 offen sc1
    v_cvt_pk_bf16_f32 v36, v176, v177
    v_cvt_pk_bf16_f32 v37, v178, v179
    v_cvt_pk_bf16_f32 v38, v180, v181
    v_cvt_pk_bf16_f32 v39, v182, v183
    s_add_u32 s61, s60, 263168
    buffer_store_dwordx4 v[36:39], v24, s[32:35], s61 offen sc1
    v_cvt_pk_bf16_f32 v40, v184, v185
    v_cvt_pk_bf16_f32 v41, v186, v187
    v_cvt_pk_bf16_f32 v42, v188, v189
    v_cvt_pk_bf16_f32 v43, v190, v191
    s_add_u32 s61, s60, 263680
    buffer_store_dwordx4 v[40:43], v24, s[32:35], s61 offen sc1
    s_branch L_b_kvsig
L_b_v:
    s_mov_b32 s36, s12
    s_and_b32 s37, s13, 0xffff
    s_mov_b32 s38, 4194304
    s_mov_b32 s39, 0x20000
    s_lshr_b32 s60, s3, 1
    s_and_b32 s61, s3, 1
    v_and_b32 v24, 31, v1
    s_lshl_b32 s62, s60, 6
    v_add_u32 v24, s62, v24
    v_bfe_u32 v25, v24, 1, 3
    v_lshrrev_b32 v26, 5, v1
    v_lshlrev_b32 v24, 7, v24
    v_add_u32 v27, 0, v26
    v_xor_b32 v27, v27, v25
    v_lshl_add_u32 v8, v27, 4, v24
    v_add_u32 v27, 2, v26
    v_xor_b32 v27, v27, v25
    v_lshl_add_u32 v9, v27, 4, v24
    v_add_u32 v27, 4, v26
    v_xor_b32 v27, v27, v25
    v_lshl_add_u32 v10, v27, 4, v24
    v_add_u32 v27, 6, v26
    v_xor_b32 v27, v27, v25
    v_lshl_add_u32 v11, v27, 4, v24
    v_bfe_u32 v24, v1, 2, 2
    v_lshrrev_b32 v25, 5, v1
    v_mul_u32_u24 v25, 8, v25
    v_add_u32 v25, v25, v24
    v_lshlrev_b32 v25, 7, v25
    v_lshrrev_b32 v24, 1, v24
    v_lshlrev_b32 v24, 2, v24
    v_bfe_u32 v26, v1, 4, 1
    v_lshlrev_b32 v26, 1, v26
    v_bfe_u32 v27, v1, 1, 1
    v_add_u32 v26, v26, v27
    v_and_b32 v27, 1, v1
    v_lshlrev_b32 v27, 3, v27
    v_add_u32 v25, v25, v27
    v_add_u32 v28, 0, v26
    v_xor_b32 v28, v28, v24
    v_lshl_add_u32 v28, v28, 4, v25
    s_lshl_b32 s62, s61, 13
    s_add_u32 s62, s62, 16384
    v_add_u32 v12, s62, v28
    v_add_u32 v28, 4, v26
    v_xor_b32 v28, v28, v24
    v_lshl_add_u32 v28, v28, 4, v25
    s_lshl_b32 s62, s61, 13
    s_add_u32 s62, s62, 16384
    v_add_u32 v13, s62, v28
    v_lshrrev_b32 v24, 3, v1
    v_and_b32 v25, 7, v1
    v_lshrrev_b32 v26, 4, v1
    s_mov_b32 s62, 1024
    v_mul_lo_u32 v27, s62, v24
    v_xor_b32 v28, v25, v26
    v_lshl_add_u32 v20, v28, 4, v27
    v_add_u32 v28, 4, v26
    v_xor_b32 v28, v25, v28
    v_lshl_add_u32 v21, v28, 4, v27
    s_mov_b32 s62, 8192
    v_mul_lo_u32 v27, s62, v24
    v_bfe_u32 v26, v1, 4, 1
    v_lshlrev_b32 v26, 2, v26
    v_xor_b32 v25, v25, v26
    v_lshl_add_u32 v22, v25, 4, v27
    s_lshl_b32 s49, s55, 17
    s_lshl_b32 s60, s3, 15
    s_add_u32 s49, s49, s60
    s_lshl_b32 s50, s56, 8
    s_lshr_b32 s60, s3, 1
    s_lshl_b32 s60, s60, 7
    s_add_u32 s50, s50, s60
    s_and_b32 s60, s3, 1
    s_lshl_b32 s60, s60, 18
    s_add_u32 s50, s50, s60
    s_mov_b32 s51, 8
    s_lshl_b32 s64, s3, 12
    s_add_u32 s65, s64, 16384
    s_mov_b32 s53, 0
    s_mov_b32 s52, 0
    s_mov_b32 s54, s51
    s_add_u32 s60, s49, 0
    s_add_u32 s61, s53, s64
    s_add_u32 m0, s61, 0
    s_nop 0
    buffer_load_dwordx4 v20, s[32:35], s60 offen sc1 lds
    s_add_u32 s60, s49, 8192
    s_add_u32 s61, s53, s64
    s_add_u32 m0, s61, 1024
    s_nop 0
    buffer_load_dwordx4 v21, s[32:35], s60 offen sc1 lds
    s_add_u32 s60, s49, 16384
    s_add_u32 s61, s53, s64
    s_add_u32 m0, s61, 2048
    s_nop 0
    buffer_load_dwordx4 v20, s[32:35], s60 offen sc1 lds
    s_add_u32 s60, s49, 24576
    s_add_u32 s61, s53, s64
    s_add_u32 m0, s61, 3072
    s_nop 0
    buffer_load_dwordx4 v21, s[32:35], s60 offen sc1 lds
    s_add_u32 s60, s50, 0
    s_add_u32 s61, s53, s65
    s_add_u32 m0, s61, 0
    s_nop 0
    buffer_load_dwordx4 v22, s[36:39], s60 offen lds
    s_add_u32 s60, s50, 65536
    s_add_u32 s61, s53, s65
    s_add_u32 m0, s61, 1024
    s_nop 0
    buffer_load_dwordx4 v22, s[36:39], s60 offen lds
    s_add_u32 s60, s50, 131072
    s_add_u32 s61, s53, s65
    s_add_u32 m0, s61, 2048
    s_nop 0
    buffer_load_dwordx4 v22, s[36:39], s60 offen lds
    s_add_u32 s60, s50, 196608
    s_add_u32 s61, s53, s65
    s_add_u32 m0, s61, 3072
    s_nop 0
    buffer_load_dwordx4 v22, s[36:39], s60 offen lds
    s_add_u32 s49, s49, 128
    s_add_u32 s50, s50, 524288
    s_add_u32 s53, s53, 32768
    s_and_b32 s53, s53, 0x1ffff
    s_sub_u32 s54, s54, 1
    s_add_u32 s60, s49, 0
    s_add_u32 s61, s53, s64
    s_add_u32 m0, s61, 0
    s_nop 0
    buffer_load_dwordx4 v20, s[32:35], s60 offen sc1 lds
    s_add_u32 s60, s49, 8192
    s_add_u32 s61, s53, s64
    s_add_u32 m0, s61, 1024
    s_nop 0
    buffer_load_dwordx4 v21, s[32:35], s60 offen sc1 lds
    s_add_u32 s60, s49, 16384
    s_add_u32 s61, s53, s64
    s_add_u32 m0, s61, 2048
    s_nop 0
    buffer_load_dwordx4 v20, s[32:35], s60 offen sc1 lds
    s_add_u32 s60, s49, 24576
    s_add_u32 s61, s53, s64
    s_add_u32 m0, s61, 3072
    s_nop 0
    buffer_load_dwordx4 v21, s[32:35], s60 offen sc1 lds
    s_add_u32 s60, s50, 0
    s_add_u32 s61, s53, s65
    s_add_u32 m0, s61, 0
    s_nop 0
    buffer_load_dwordx4 v22, s[36:39], s60 offen lds
    s_add_u32 s60, s50, 65536
    s_add_u32 s61, s53, s65
    s_add_u32 m0, s61, 1024
    s_nop 0
    buffer_load_dwordx4 v22, s[36:39], s60 offen lds
    s_add_u32 s60, s50, 131072
    s_add_u32 s61, s53, s65
    s_add_u32 m0, s61, 2048
    s_nop 0
    buffer_load_dwordx4 v22, s[36:39], s60 offen lds
    s_add_u32 s60, s50, 196608
    s_add_u32 s61, s53, s65
    s_add_u32 m0, s61, 3072
    s_nop 0
    buffer_load_dwordx4 v22, s[36:39], s60 offen lds
    s_add_u32 s49, s49, 128
    s_add_u32 s50, s50, 524288
    s_add_u32 s53, s53, 32768
    s_and_b32 s53, s53, 0x1ffff
    s_sub_u32 s54, s54, 1
    s_add_u32 s60, s49, 0
    s_add_u32 s61, s53, s64
    s_add_u32 m0, s61, 0
    s_nop 0
    buffer_load_dwordx4 v20, s[32:35], s60 offen sc1 lds
    s_add_u32 s60, s49, 8192
    s_add_u32 s61, s53, s64
    s_add_u32 m0, s61, 1024
    s_nop 0
    buffer_load_dwordx4 v21, s[32:35], s60 offen sc1 lds
    s_add_u32 s60, s49, 16384
    s_add_u32 s61, s53, s64
    s_add_u32 m0, s61, 2048
    s_nop 0
    buffer_load_dwordx4 v20, s[32:35], s60 offen sc1 lds
    s_add_u32 s60, s49, 24576
    s_add_u32 s61, s53, s64
    s_add_u32 m0, s61, 3072
    s_nop 0
    buffer_load_dwordx4 v21, s[32:35], s60 offen sc1 lds
    s_add_u32 s60, s50, 0
    s_add_u32 s61, s53, s65
    s_add_u32 m0, s61, 0
    s_nop 0
    buffer_load_dwordx4 v22, s[36:39], s60 offen lds
    s_add_u32 s60, s50, 65536
    s_add_u32 s61, s53, s65
    s_add_u32 m0, s61, 1024
    s_nop 0
    buffer_load_dwordx4 v22, s[36:39], s60 offen lds
    s_add_u32 s60, s50, 131072
    s_add_u32 s61, s53, s65
    s_add_u32 m0, s61, 2048
    s_nop 0
    buffer_load_dwordx4 v22, s[36:39], s60 offen lds
    s_add_u32 s60, s50, 196608
    s_add_u32 s61, s53, s65
    s_add_u32 m0, s61, 3072
    s_nop 0
    buffer_load_dwordx4 v22, s[36:39], s60 offen lds
    s_add_u32 s49, s49, 128
    s_add_u32 s50, s50, 524288
    s_add_u32 s53, s53, 32768
    s_and_b32 s53, s53, 0x1ffff
    s_sub_u32 s54, s54, 1
    v_mov_b32 v128, 0
    v_mov_b32 v129, 0
    v_mov_b32 v130, 0
    v_mov_b32 v131, 0
    v_mov_b32 v132, 0
    v_mov_b32 v133, 0
    v_mov_b32 v134, 0
    v_mov_b32 v135, 0
    v_mov_b32 v136, 0
    v_mov_b32 v137, 0
    v_mov_b32 v138, 0
    v_mov_b32 v139, 0
    v_mov_b32 v140, 0
    v_mov_b32 v141, 0
    v_mov_b32 v142, 0
    v_mov_b32 v143, 0
    v_mov_b32 v144, 0
    v_mov_b32 v145, 0
    v_mov_b32 v146, 0
    v_mov_b32 v147, 0
    v_mov_b32 v148, 0
    v_mov_b32 v149, 0
    v_mov_b32 v150, 0
    v_mov_b32 v151, 0
    v_mov_b32 v152, 0
    v_mov_b32 v153, 0
    v_mov_b32 v154, 0
    v_mov_b32 v155, 0
    v_mov_b32 v156, 0
    v_mov_b32 v157, 0
    v_mov_b32 v158, 0
    v_mov_b32 v159, 0
    v_mov_b32 v160, 0
    v_mov_b32 v161, 0
    v_mov_b32 v162, 0
    v_mov_b32 v163, 0
    v_mov_b32 v164, 0
    v_mov_b32 v165, 0
    v_mov_b32 v166, 0
    v_mov_b32 v167, 0
    v_mov_b32 v168, 0
    v_mov_b32 v169, 0
    v_mov_b32 v170, 0
    v_mov_b32 v171, 0
    v_mov_b32 v172, 0
    v_mov_b32 v173, 0
    v_mov_b32 v174, 0
    v_mov_b32 v175, 0
    v_mov_b32 v176, 0
    v_mov_b32 v177, 0
    v_mov_b32 v178, 0
    v_mov_b32 v179, 0
    v_mov_b32 v180, 0
    v_mov_b32 v181, 0
    v_mov_b32 v182, 0
    v_mov_b32 v183, 0
    v_mov_b32 v184, 0
    v_mov_b32 v185, 0
    v_mov_b32 v186, 0
    v_mov_b32 v187, 0
    v_mov_b32 v188, 0
    v_mov_b32 v189, 0
    v_mov_b32 v190, 0
    v_mov_b32 v191, 0
    v_add_u32 v14, s52, v8
    v_add_u32 v15, s52, v9
    v_add_u32 v16, s52, v10
    v_add_u32 v17, s52, v11
    v_add_u32 v18, s52, v12
    v_add_u32 v19, s52, v13
    s_waitcnt vmcnt(16)
    s_barrier
    ds_read_b128 v[64:67], v14 offset:0
    ds_read_b128 v[68:71], v14 offset:4096
    ds_read_b64_tr_b16 v[72:73], v18 offset:0
    ds_read_b64_tr_b16 v[74:75], v18 offset:512
    ds_read_b64_tr_b16 v[76:77], v19 offset:0
    ds_read_b64_tr_b16 v[78:79], v19 offset:512
    ds_read_b128 v[80:83], v15 offset:0
    ds_read_b128 v[84:87], v15 offset:4096
    ds_read_b64_tr_b16 v[88:89], v18 offset:2048
    ds_read_b64_tr_b16 v[90:91], v18 offset:2560
    ds_read_b64_tr_b16 v[92:93], v19 offset:2048
    ds_read_b64_tr_b16 v[94:95], v19 offset:2560
L_gk_18:
    s_waitcnt lgkmcnt(6)
    v_mfma_f32_32x32x16_bf16 v[128:143], v[64:67], v[72:75], v[128:143]
    ds_read_b128 v[96:99], v16 offset:0
    ds_read_b128 v[100:103], v16 offset:4096
    v_mfma_f32_32x32x16_bf16 v[144:159], v[64:67], v[76:79], v[144:159]
    ds_read_b64_tr_b16 v[104:105], v18 offset:4096
    ds_read_b64_tr_b16 v[106:107], v18 offset:4608
    v_mfma_f32_32x32x16_bf16 v[160:175], v[68:71], v[72:75], v[160:175]
    ds_read_b64_tr_b16 v[108:109], v19 offset:4096
    ds_read_b64_tr_b16 v[110:111], v19 offset:4608
    v_mfma_f32_32x32x16_bf16 v[176:191], v[68:71], v[76:79], v[176:191]
    s_waitcnt lgkmcnt(6)
    v_mfma_f32_32x32x16_bf16 v[128:143], v[80:83], v[88:91], v[128:143]
    ds_read_b128 v[112:115], v17 offset:0
    ds_read_b128 v[116:119], v17 offset:4096
    v_mfma_f32_32x32x16_bf16 v[144:159], v[80:83], v[92:95], v[144:159]
    ds_read_b64_tr_b16 v[120:121], v18 offset:6144
    ds_read_b64_tr_b16 v[122:123], v18 offset:6656
    v_mfma_f32_32x32x16_bf16 v[160:175], v[84:87], v[88:91], v[160:175]
    ds_read_b64_tr_b16 v[124:125], v19 offset:6144
    ds_read_b64_tr_b16 v[126:127], v19 offset:6656
    v_mfma_f32_32x32x16_bf16 v[176:191], v[84:87], v[92:95], v[176:191]
    s_add_u32 s52, s52, 32768
    s_and_b32 s52, s52, 0x1ffff
    s_cmp_ge_u32 s51, 3
    s_cbranch_scc1 L_gw_19
    s_waitcnt vmcnt(0)
    s_branch L_gw_20
L_gw_19:
    s_waitcnt vmcnt(8)
L_gw_20:
    s_waitcnt lgkmcnt(6)
    s_barrier
    v_add_u32 v14, s52, v8
    v_add_u32 v15, s52, v9
    v_add_u32 v16, s52, v10
    v_add_u32 v17, s52, v11
    v_add_u32 v18, s52, v12
    v_add_u32 v19, s52, v13
    v_mfma_f32_32x32x16_bf16 v[128:143], v[96:99], v[104:107], v[128:143]
    ds_read_b128 v[64:67], v14 offset:0
    ds_read_b128 v[68:71], v14 offset:4096
    v_mfma_f32_32x32x16_bf16 v[144:159], v[96:99], v[108:111], v[144:159]
    ds_read_b64_tr_b16 v[72:73], v18 offset:0
    ds_read_b64_tr_b16 v[74:75], v18 offset:512
    v_mfma_f32_32x32x16_bf16 v[160:175], v[100:103], v[104:107], v[160:175]
    ds_read_b64_tr_b16 v[76:77], v19 offset:0
    ds_read_b64_tr_b16 v[78:79], v19 offset:512
    v_mfma_f32_32x32x16_bf16 v[176:191], v[100:103], v[108:111], v[176:191]
    s_waitcnt lgkmcnt(6)
    s_cmp_eq_u32 s54, 0
    s_cbranch_scc1 L_gnd_21
    v_mfma_f32_32x32x16_bf16 v[128:143], v[112:115], v[120:123], v[128:143]
    ds_read_b128 v[80:83], v15 offset:0
    ds_read_b128 v[84:87], v15 offset:4096
    s_add_u32 s60, s49, 0
    s_add_u32 s61, s53, s64
    s_add_u32 m0, s61, 0
    s_nop 0
    buffer_load_dwordx4 v20, s[32:35], s60 offen sc1 lds
    s_add_u32 s60, s49, 8192
    s_add_u32 s61, s53, s64
    s_add_u32 m0, s61, 1024
    s_nop 0
    buffer_load_dwordx4 v21, s[32:35], s60 offen sc1 lds
    v_mfma_f32_32x32x16_bf16 v[144:159], v[112:115], v[124:127], v[144:159]
    ds_read_b64_tr_b16 v[88:89], v18 offset:2048
    ds_read_b64_tr_b16 v[90:91], v18 offset:2560
    s_add_u32 s60, s49, 16384
    s_add_u32 s61, s53, s64
    s_add_u32 m0, s61, 2048
    s_nop 0
    buffer_load_dwordx4 v20, s[32:35], s60 offen sc1 lds
    s_add_u32 s60, s49, 24576
    s_add_u32 s61, s53, s64
    s_add_u32 m0, s61, 3072
    s_nop 0
    buffer_load_dwordx4 v21, s[32:35], s60 offen sc1 lds
    v_mfma_f32_32x32x16_bf16 v[160:175], v[116:119], v[120:123], v[160:175]
    ds_read_b64_tr_b16 v[92:93], v19 offset:2048
    ds_read_b64_tr_b16 v[94:95], v19 offset:2560
    s_add_u32 s60, s50, 0
    s_add_u32 s61, s53, s65
    s_add_u32 m0, s61, 0
    s_nop 0
    buffer_load_dwordx4 v22, s[36:39], s60 offen lds
    s_add_u32 s60, s50, 65536
    s_add_u32 s61, s53, s65
    s_add_u32 m0, s61, 1024
    s_nop 0
    buffer_load_dwordx4 v22, s[36:39], s60 offen lds
    v_mfma_f32_32x32x16_bf16 v[176:191], v[116:119], v[124:127], v[176:191]
    s_add_u32 s60, s50, 131072
    s_add_u32 s61, s53, s65
    s_add_u32 m0, s61, 2048
    s_nop 0
    buffer_load_dwordx4 v22, s[36:39], s60 offen lds
    s_add_u32 s60, s50, 196608
    s_add_u32 s61, s53, s65
    s_add_u32 m0, s61, 3072
    s_nop 0
    buffer_load_dwordx4 v22, s[36:39], s60 offen lds
    s_add_u32 s49, s49, 128
    s_add_u32 s50, s50, 524288
    s_add_u32 s53, s53, 32768
    s_and_b32 s53, s53, 0x1ffff
    s_sub_u32 s54, s54, 1
    s_branch L_gj_22
L_gnd_21:
    v_mfma_f32_32x32x16_bf16 v[128:143], v[112:115], v[120:123], v[128:143]
    ds_read_b128 v[80:83], v15 offset:0
    ds_read_b128 v[84:87], v15 offset:4096
    v_mfma_f32_32x32x16_bf16 v[144:159], v[112:115], v[124:127], v[144:159]
    ds_read_b64_tr_b16 v[88:89], v18 offset:2048
    ds_read_b64_tr_b16 v[90:91], v18 offset:2560
    v_mfma_f32_32x32x16_bf16 v[160:175], v[116:119], v[120:123], v[160:175]
    ds_read_b64_tr_b16 v[92:93], v19 offset:2048
    ds_read_b64_tr_b16 v[94:95], v19 offset:2560
    v_mfma_f32_32x32x16_bf16 v[176:191], v[116:119], v[124:127], v[176:191]
L_gj_22:
    s_sub_u32 s51, s51, 1
    s_cmp_gt_u32 s51, 0
    s_cbranch_scc1 L_gk_18
    s_waitcnt lgkmcnt(0)
    s_nop 15
    s_barrier
    v_bfe_u32 v24, v1, 4, 1
    v_lshlrev_b32 v24, 10, v24
    v_lshrrev_b32 v25, 5, v1
    v_lshl_add_u32 v24, v25, 8, v24
    v_and_b32 v25, 15, v1
    v_lshl_add_u32 v24, v25, 4, v24
    s_lshr_b32 s60, s3, 1
    s_lshl_b32 s60, s60, 1
    s_lshl_b32 s61, s55, 2
    s_add_u32 s60, s60, s61
    s_lshl_b32 s60, s60, 5
    s_add_u32 s60, s60, s56
    s_lshl_b32 s60, s60, 13
    s_and_b32 s61, s3, 1
    s_lshl_b32 s61, s61, 12
    s_add_u32 s60, s60, s61
    s_add_u32 s60, s60, 35651584
    v_cvt_pk_bf16_f32 v28, v128, v129
    v_cvt_pk_bf16_f32 v29, v130, v131
    v_cvt_pk_bf16_f32 v30, v136, v137
    v_cvt_pk_bf16_f32 v31, v138, v139
    s_add_u32 s61, s60, 0
    buffer_store_dwordx4 v[28:31], v24, s[32:35], s61 offen sc1
    v_cvt_pk_bf16_f32 v32, v132, v133
    v_cvt_pk_bf16_f32 v33, v134, v135
    v_cvt_pk_bf16_f32 v34, v140, v141
    v_cvt_pk_bf16_f32 v35, v142, v143
    s_add_u32 s61, s60, 512
    buffer_store_dwordx4 v[32:35], v24, s[32:35], s61 offen sc1
    v_cvt_pk_bf16_f32 v36, v144, v145
    v_cvt_pk_bf16_f32 v37, v146, v147
    v_cvt_pk_bf16_f32 v38, v152, v153
    v_cvt_pk_bf16_f32 v39, v154, v155
    s_add_u32 s61, s60, 2048
    buffer_store_dwordx4 v[36:39], v24, s[32:35], s61 offen sc1
    v_cvt_pk_bf16_f32 v40, v148, v149
    v_cvt_pk_bf16_f32 v41, v150, v151
    v_cvt_pk_bf16_f32 v42, v156, v157
    v_cvt_pk_bf16_f32 v43, v158, v159
    s_add_u32 s61, s60, 2560
    buffer_store_dwordx4 v[40:43], v24, s[32:35], s61 offen sc1
    v_cvt_pk_bf16_f32 v28, v160, v161
    v_cvt_pk_bf16_f32 v29, v162, v163
    v_cvt_pk_bf16_f32 v30, v168, v169
    v_cvt_pk_bf16_f32 v31, v170, v171
    s_add_u32 s61, s60, 262144
    buffer_store_dwordx4 v[28:31], v24, s[32:35], s61 offen sc1
    v_cvt_pk_bf16_f32 v32, v164, v165
    v_cvt_pk_bf16_f32 v33, v166, v167
    v_cvt_pk_bf16_f32 v34, v172, v173
    v_cvt_pk_bf16_f32 v35, v174, v175
    s_add_u32 s61, s60, 262656
    buffer_store_dwordx4 v[32:35], v24, s[32:35], s61 offen sc1
    v_cvt_pk_bf16_f32 v36, v176, v177
    v_cvt_pk_bf16_f32 v37, v178, v179
    v_cvt_pk_bf16_f32 v38, v184, v185
    v_cvt_pk_bf16_f32 v39, v186, v187
    s_add_u32 s61, s60, 264192
    buffer_store_dwordx4 v[36:39], v24, s[32:35], s61 offen sc1
    v_cvt_pk_bf16_f32 v40, v180, v181
    v_cvt_pk_bf16_f32 v41, v182, v183
    v_cvt_pk_bf16_f32 v42, v188, v189
    v_cvt_pk_bf16_f32 v43, v190, v191
    s_add_u32 s61, s60, 264704
    buffer_store_dwordx4 v[40:43], v24, s[32:35], s61 offen sc1
L_b_kvsig:
    s_waitcnt vmcnt(0)
    s_barrier
    s_cmp_lg_u32 s3, 0
    s_cbranch_scc1 L_sg_23
    s_lshl_b32 s60, s55, 7
    s_add_u32 s60, s60, 133171200
    v_mov_b32 v8, 1
    s_mov_b64 exec, 1
    buffer_atomic_add v8, off, s[32:35], s60 sc1
    s_mov_b64 exec, -1
L_sg_23:
    s_add_u32 s48, s48, 32
    s_branch L_kv_loop
L_kv_done:
    s_cmp_lt_u32 s96, 4
    s_cselect_b32 s98, 5, 4
    s_mov_b32 s60, 13108
    s_mov_b32 s61, 16384
    s_cselect_b32 s99, s60, s61
    s_mov_b32 s48, s97
L_q_loop:
    s_lshl_b32 s60, s98, 4
    s_cmp_ge_u32 s48, s60
    s_cbranch_scc1 L_q_done
    s_mul_i32 s55, s48, s99
    s_lshr_b32 s55, s55, 16
    s_mul_i32 s60, s55, s98
    s_sub_u32 s60, s48, s60
    s_mul_i32 s60, s60, 7
    s_add_u32 s58, s60, s96
    s_mov_b32 s56, s58
    s_bitcmp1_b32 s86, s55
    s_cbranch_scc1 L_wf_24
    v_lshlrev_b32 v8, 7, v1
    s_mov_b32 s60, 133169152
L_wfl_25:
    s_mov_b64 exec, 0xffff
    buffer_load_dword v9, v8, s[32:35], s60 offen sc1
    s_waitcnt vmcnt(0)
    v_cmp_le_u32 vcc, 4, v9
    s_mov_b64 exec, -1
    s_mov_b32 s86, vcc_lo
    s_add_u32 s94, s94, 1
    s_cmp_gt_u32 s94, 3000000
    s_cbranch_scc1 L_exit
    s_bitcmp1_b32 s86, s55
    s_cbranch_scc1 L_wf_24
    s_sleep 8
    s_branch L_wfl_25
L_wf_24:
    s_mov_b32 s36, s8
    s_and_b32 s37, s9, 0xffff
    s_mov_b32 s38, 4194304
    s_mov_b32 s39, 0x20000
    s_lshr_b32 s60, s3, 1
    s_and_b32 s61, s3, 1
    v_and_b32 v24, 31, v1
    s_lshl_b32 s62, s60, 6
    v_add_u32 v24, s62, v24
    v_bfe_u32 v25, v24, 1, 3
    v_lshrrev_b32 v26, 5, v1
    v_lshlrev_b32 v24, 7, v24
    v_add_u32 v27, 0, v26
    v_xor_b32 v27, v27, v25
    v_lshl_add_u32 v8, v27, 4, v24
    v_add_u32 v27, 2, v26
    v_xor_b32 v27, v27, v25
    v_lshl_add_u32 v9, v27, 4, v24
    v_add_u32 v27, 4, v26
    v_xor_b32 v27, v27, v25
    v_lshl_add_u32 v10, v27, 4, v24
    v_add_u32 v27, 6, v26
    v_xor_b32 v27, v27, v25
    v_lshl_add_u32 v11, v27, 4, v24
    v_bfe_u32 v24, v1, 2, 2
    v_lshrrev_b32 v25, 5, v1
    v_mul_u32_u24 v25, 8, v25
    v_add_u32 v25, v25, v24
    v_lshlrev_b32 v25, 7, v25
    v_lshrrev_b32 v24, 1, v24
    v_lshlrev_b32 v24, 2, v24
    v_bfe_u32 v26, v1, 4, 1
    v_lshlrev_b32 v26, 1, v26
    v_bfe_u32 v27, v1, 1, 1
    v_add_u32 v26, v26, v27
    v_and_b32 v27, 1, v1
    v_lshlrev_b32 v27, 3, v27
    v_add_u32 v25, v25, v27
    v_add_u32 v28, 0, v26
    v_xor_b32 v28, v28, v24
    v_lshl_add_u32 v28, v28, 4, v25
    s_lshl_b32 s62, s61, 13
    s_add_u32 s62, s62, 16384
    v_add_u32 v12, s62, v28
    v_add_u32 v28, 4, v26
    v_xor_b32 v28, v28, v24
    v_lshl_add_u32 v28, v28, 4, v25
    s_lshl_b32 s62, s61, 13
    s_add_u32 s62, s62, 16384
    v_add_u32 v13, s62, v28
    v_lshrrev_b32 v24, 3, v1
    v_and_b32 v25, 7, v1
    v_lshrrev_b32 v26, 4, v1
    s_mov_b32 s62, 1024
    v_mul_lo_u32 v27, s62, v24
    v_xor_b32 v28, v25, v26
    v_lshl_add_u32 v20, v28, 4, v27
    v_add_u32 v28, 4, v26
    v_xor_b32 v28, v25, v28
    v_lshl_add_u32 v21, v28, 4, v27
    s_mov_b32 s62, 8192
    v_mul_lo_u32 v27, s62, v24
    v_bfe_u32 v26, v1, 4, 1
    v_lshlrev_b32 v26, 2, v26
    v_xor_b32 v25, v25, v26
    v_lshl_add_u32 v22, v25, 4, v27
    s_lshl_b32 s49, s55, 17
    s_lshl_b32 s60, s3, 15
    s_add_u32 s49, s49, s60
    s_lshl_b32 s50, s56, 8
    s_lshr_b32 s60, s3, 1
    s_lshl_b32 s60, s60, 7
    s_add_u32 s50, s50, s60
    s_and_b32 s60, s3, 1
    s_lshl_b32 s60, s60, 18
    s_add_u32 s50, s50, s60
    s_mov_b32 s51, 8
    s_lshl_b32 s64, s3, 12
    s_add_u32 s65, s64, 16384
    s_mov_b32 s53, 0
    s_mov_b32 s52, 0
    s_mov_b32 s54, s51
    s_add_u32 s60, s49, 0
    s_add_u32 s61, s53, s64
    s_add_u32 m0, s61, 0
    s_nop 0
    buffer_load_dwordx4 v20, s[32:35], s60 offen sc1 lds
    s_add_u32 s60, s49, 8192
    s_add_u32 s61, s53, s64
    s_add_u32 m0, s61, 1024
    s_nop 0
    buffer_load_dwordx4 v21, s[32:35], s60 offen sc1 lds
    s_add_u32 s60, s49, 16384
    s_add_u32 s61, s53, s64
    s_add_u32 m0, s61, 2048
    s_nop 0
    buffer_load_dwordx4 v20, s[32:35], s60 offen sc1 lds
    s_add_u32 s60, s49, 24576
    s_add_u32 s61, s53, s64
    s_add_u32 m0, s61, 3072
    s_nop 0
    buffer_load_dwordx4 v21, s[32:35], s60 offen sc1 lds
    s_add_u32 s60, s50, 0
    s_add_u32 s61, s53, s65
    s_add_u32 m0, s61, 0
    s_nop 0
    buffer_load_dwordx4 v22, s[36:39], s60 offen lds
    s_add_u32 s60, s50, 65536
    s_add_u32 s61, s53, s65
    s_add_u32 m0, s61, 1024
    s_nop 0
    buffer_load_dwordx4 v22, s[36:39], s60 offen lds
    s_add_u32 s60, s50, 131072
    s_add_u32 s61, s53, s65
    s_add_u32 m0, s61, 2048
    s_nop 0
    buffer_load_dwordx4 v22, s[36:39], s60 offen lds
    s_add_u32 s60, s50, 196608
    s_add_u32 s61, s53, s65
    s_add_u32 m0, s61, 3072
    s_nop 0
    buffer_load_dwordx4 v22, s[36:39], s60 offen lds
    s_add_u32 s49, s49, 128
    s_add_u32 s50, s50, 524288
    s_add_u32 s53, s53, 32768
    s_and_b32 s53, s53, 0x1ffff
    s_sub_u32 s54, s54, 1
    s_add_u32 s60, s49, 0
    s_add_u32 s61, s53, s64
    s_add_u32 m0, s61, 0
    s_nop 0
    buffer_load_dwordx4 v20, s[32:35], s60 offen sc1 lds
    s_add_u32 s60, s49, 8192
    s_add_u32 s61, s53, s64
    s_add_u32 m0, s61, 1024
    s_nop 0
    buffer_load_dwordx4 v21, s[32:35], s60 offen sc1 lds
    s_add_u32 s60, s49, 16384
    s_add_u32 s61, s53, s64
    s_add_u32 m0, s61, 2048
    s_nop 0
    buffer_load_dwordx4 v20, s[32:35], s60 offen sc1 lds
    s_add_u32 s60, s49, 24576
    s_add_u32 s61, s53, s64
    s_add_u32 m0, s61, 3072
    s_nop 0
    buffer_load_dwordx4 v21, s[32:35], s60 offen sc1 lds
    s_add_u32 s60, s50, 0
    s_add_u32 s61, s53, s65
    s_add_u32 m0, s61, 0
    s_nop 0
    buffer_load_dwordx4 v22, s[36:39], s60 offen lds
    s_add_u32 s60, s50, 65536
    s_add_u32 s61, s53, s65
    s_add_u32 m0, s61, 1024
    s_nop 0
    buffer_load_dwordx4 v22, s[36:39], s60 offen lds
    s_add_u32 s60, s50, 131072
    s_add_u32 s61, s53, s65
    s_add_u32 m0, s61, 2048
    s_nop 0
    buffer_load_dwordx4 v22, s[36:39], s60 offen lds
    s_add_u32 s60, s50, 196608
    s_add_u32 s61, s53, s65
    s_add_u32 m0, s61, 3072
    s_nop 0
    buffer_load_dwordx4 v22, s[36:39], s60 offen lds
    s_add_u32 s49, s49, 128
    s_add_u32 s50, s50, 524288
    s_add_u32 s53, s53, 32768
    s_and_b32 s53, s53, 0x1ffff
    s_sub_u32 s54, s54, 1
    s_add_u32 s60, s49, 0
    s_add_u32 s61, s53, s64
    s_add_u32 m0, s61, 0
    s_nop 0
    buffer_load_dwordx4 v20, s[32:35], s60 offen sc1 lds
    s_add_u32 s60, s49, 8192
    s_add_u32 s61, s53, s64
    s_add_u32 m0, s61, 1024
    s_nop 0
    buffer_load_dwordx4 v21, s[32:35], s60 offen sc1 lds
    s_add_u32 s60, s49, 16384
    s_add_u32 s61, s53, s64
    s_add_u32 m0, s61, 2048
    s_nop 0
    buffer_load_dwordx4 v20, s[32:35], s60 offen sc1 lds
    s_add_u32 s60, s49, 24576
    s_add_u32 s61, s53, s64
    s_add_u32 m0, s61, 3072
    s_nop 0
    buffer_load_dwordx4 v21, s[32:35], s60 offen sc1 lds
    s_add_u32 s60, s50, 0
    s_add_u32 s61, s53, s65
    s_add_u32 m0, s61, 0
    s_nop 0
    buffer_load_dwordx4 v22, s[36:39], s60 offen lds
    s_add_u32 s60, s50, 65536
    s_add_u32 s61, s53, s65
    s_add_u32 m0, s61, 1024
    s_nop 0
    buffer_load_dwordx4 v22, s[36:39], s60 offen lds
    s_add_u32 s60, s50, 131072
    s_add_u32 s61, s53, s65
    s_add_u32 m0, s61, 2048
    s_nop 0
    buffer_load_dwordx4 v22, s[36:39], s60 offen lds
    s_add_u32 s60, s50, 196608
    s_add_u32 s61, s53, s65
    s_add_u32 m0, s61, 3072
    s_nop 0
    buffer_load_dwordx4 v22, s[36:39], s60 offen lds
    s_add_u32 s49, s49, 128
    s_add_u32 s50, s50, 524288
    s_add_u32 s53, s53, 32768
    s_and_b32 s53, s53, 0x1ffff
    s_sub_u32 s54, s54, 1
    v_mov_b32 v128, 0
    v_mov_b32 v129, 0
    v_mov_b32 v130, 0
    v_mov_b32 v131, 0
    v_mov_b32 v132, 0
    v_mov_b32 v133, 0
    v_mov_b32 v134, 0
    v_mov_b32 v135, 0
    v_mov_b32 v136, 0
    v_mov_b32 v137, 0
    v_mov_b32 v138, 0
    v_mov_b32 v139, 0
    v_mov_b32 v140, 0
    v_mov_b32 v141, 0
    v_mov_b32 v142, 0
    v_mov_b32 v143, 0
    v_mov_b32 v144, 0
    v_mov_b32 v145, 0
    v_mov_b32 v146, 0
    v_mov_b32 v147, 0
    v_mov_b32 v148, 0
    v_mov_b32 v149, 0
    v_mov_b32 v150, 0
    v_mov_b32 v151, 0
    v_mov_b32 v152, 0
    v_mov_b32 v153, 0
    v_mov_b32 v154, 0
    v_mov_b32 v155, 0
    v_mov_b32 v156, 0
    v_mov_b32 v157, 0
    v_mov_b32 v158, 0
    v_mov_b32 v159, 0
    v_mov_b32 v160, 0
    v_mov_b32 v161, 0
    v_mov_b32 v162, 0
    v_mov_b32 v163, 0
    v_mov_b32 v164, 0
    v_mov_b32 v165, 0
    v_mov_b32 v166, 0
    v_mov_b32 v167, 0
    v_mov_b32 v168, 0
    v_mov_b32 v169, 0
    v_mov_b32 v170, 0
    v_mov_b32 v171, 0
    v_mov_b32 v172, 0
    v_mov_b32 v173, 0
    v_mov_b32 v174, 0
    v_mov_b32 v175, 0
    v_mov_b32 v176, 0
    v_mov_b32 v177, 0
    v_mov_b32 v178, 0
    v_mov_b32 v179, 0
    v_mov_b32 v180, 0
    v_mov_b32 v181, 0
    v_mov_b32 v182, 0
    v_mov_b32 v183, 0
    v_mov_b32 v184, 0
    v_mov_b32 v185, 0
    v_mov_b32 v186, 0
    v_mov_b32 v187, 0
    v_mov_b32 v188, 0
    v_mov_b32 v189, 0
    v_mov_b32 v190, 0
    v_mov_b32 v191, 0
    v_add_u32 v14, s52, v8
    v_add_u32 v15, s52, v9
    v_add_u32 v16, s52, v10
    v_add_u32 v17, s52, v11
    v_add_u32 v18, s52, v12
    v_add_u32 v19, s52, v13
    s_waitcnt vmcnt(16)
    s_barrier
    ds_read_b128 v[64:67], v14 offset:0
    ds_read_b128 v[68:71], v14 offset:4096
    ds_read_b64_tr_b16 v[72:73], v18 offset:0
    ds_read_b64_tr_b16 v[74:75], v18 offset:512
    ds_read_b64_tr_b16 v[76:77], v19 offset:0
    ds_read_b64_tr_b16 v[78:79], v19 offset:512
    ds_read_b128 v[80:83], v15 offset:0
    ds_read_b128 v[84:87], v15 offset:4096
    ds_read_b64_tr_b16 v[88:89], v18 offset:2048
    ds_read_b64_tr_b16 v[90:91], v18 offset:2560
    ds_read_b64_tr_b16 v[92:93], v19 offset:2048
    ds_read_b64_tr_b16 v[94:95], v19 offset:2560
L_gk_26:
    s_waitcnt lgkmcnt(6)
    v_mfma_f32_32x32x16_bf16 v[128:143], v[72:75], v[64:67], v[128:143]
    ds_read_b128 v[96:99], v16 offset:0
    ds_read_b128 v[100:103], v16 offset:4096
    v_mfma_f32_32x32x16_bf16 v[144:159], v[76:79], v[64:67], v[144:159]
    ds_read_b64_tr_b16 v[104:105], v18 offset:4096
    ds_read_b64_tr_b16 v[106:107], v18 offset:4608
    v_mfma_f32_32x32x16_bf16 v[160:175], v[72:75], v[68:71], v[160:175]
    ds_read_b64_tr_b16 v[108:109], v19 offset:4096
    ds_read_b64_tr_b16 v[110:111], v19 offset:4608
    v_mfma_f32_32x32x16_bf16 v[176:191], v[76:79], v[68:71], v[176:191]
    s_waitcnt lgkmcnt(6)
    v_mfma_f32_32x32x16_bf16 v[128:143], v[88:91], v[80:83], v[128:143]
    ds_read_b128 v[112:115], v17 offset:0
    ds_read_b128 v[116:119], v17 offset:4096
    v_mfma_f32_32x32x16_bf16 v[144:159], v[92:95], v[80:83], v[144:159]
    ds_read_b64_tr_b16 v[120:121], v18 offset:6144
    ds_read_b64_tr_b16 v[122:123], v18 offset:6656
    v_mfma_f32_32x32x16_bf16 v[160:175], v[88:91], v[84:87], v[160:175]
    ds_read_b64_tr_b16 v[124:125], v19 offset:6144
    ds_read_b64_tr_b16 v[126:127], v19 offset:6656
    v_mfma_f32_32x32x16_bf16 v[176:191], v[92:95], v[84:87], v[176:191]
    s_add_u32 s52, s52, 32768
    s_and_b32 s52, s52, 0x1ffff
    s_cmp_ge_u32 s51, 3
    s_cbranch_scc1 L_gw_27
    s_waitcnt vmcnt(0)
    s_branch L_gw_28
L_gw_27:
    s_waitcnt vmcnt(8)
L_gw_28:
    s_waitcnt lgkmcnt(6)
    s_barrier
    v_add_u32 v14, s52, v8
    v_add_u32 v15, s52, v9
    v_add_u32 v16, s52, v10
    v_add_u32 v17, s52, v11
    v_add_u32 v18, s52, v12
    v_add_u32 v19, s52, v13
    v_mfma_f32_32x32x16_bf16 v[128:143], v[104:107], v[96:99], v[128:143]
    ds_read_b128 v[64:67], v14 offset:0
    ds_read_b128 v[68:71], v14 offset:4096
    v_mfma_f32_32x32x16_bf16 v[144:159], v[108:111], v[96:99], v[144:159]
    ds_read_b64_tr_b16 v[72:73], v18 offset:0
    ds_read_b64_tr_b16 v[74:75], v18 offset:512
    v_mfma_f32_32x32x16_bf16 v[160:175], v[104:107], v[100:103], v[160:175]
    ds_read_b64_tr_b16 v[76:77], v19 offset:0
    ds_read_b64_tr_b16 v[78:79], v19 offset:512
    v_mfma_f32_32x32x16_bf16 v[176:191], v[108:111], v[100:103], v[176:191]
    s_waitcnt lgkmcnt(6)
    s_cmp_eq_u32 s54, 0
    s_cbranch_scc1 L_gnd_29
    v_mfma_f32_32x32x16_bf16 v[128:143], v[120:123], v[112:115], v[128:143]
    ds_read_b128 v[80:83], v15 offset:0
    ds_read_b128 v[84:87], v15 offset:4096
    s_add_u32 s60, s49, 0
    s_add_u32 s61, s53, s64
    s_add_u32 m0, s61, 0
    s_nop 0
    buffer_load_dwordx4 v20, s[32:35], s60 offen sc1 lds
    s_add_u32 s60, s49, 8192
    s_add_u32 s61, s53, s64
    s_add_u32 m0, s61, 1024
    s_nop 0
    buffer_load_dwordx4 v21, s[32:35], s60 offen sc1 lds
    v_mfma_f32_32x32x16_bf16 v[144:159], v[124:127], v[112:115], v[144:159]
    ds_read_b64_tr_b16 v[88:89], v18 offset:2048
    ds_read_b64_tr_b16 v[90:91], v18 offset:2560
    s_add_u32 s60, s49, 16384
    s_add_u32 s61, s53, s64
    s_add_u32 m0, s61, 2048
    s_nop 0
    buffer_load_dwordx4 v20, s[32:35], s60 offen sc1 lds
    s_add_u32 s60, s49, 24576
    s_add_u32 s61, s53, s64
    s_add_u32 m0, s61, 3072
    s_nop 0
    buffer_load_dwordx4 v21, s[32:35], s60 offen sc1 lds
    v_mfma_f32_32x32x16_bf16 v[160:175], v[120:123], v[116:119], v[160:175]
    ds_read_b64_tr_b16 v[92:93], v19 offset:2048
    ds_read_b64_tr_b16 v[94:95], v19 offset:2560
    s_add_u32 s60, s50, 0
    s_add_u32 s61, s53, s65
    s_add_u32 m0, s61, 0
    s_nop 0
    buffer_load_dwordx4 v22, s[36:39], s60 offen lds
    s_add_u32 s60, s50, 65536
    s_add_u32 s61, s53, s65
    s_add_u32 m0, s61, 1024
    s_nop 0
    buffer_load_dwordx4 v22, s[36:39], s60 offen lds
    v_mfma_f32_32x32x16_bf16 v[176:191], v[124:127], v[116:119], v[176:191]
    s_add_u32 s60, s50, 131072
    s_add_u32 s61, s53, s65
    s_add_u32 m0, s61, 2048
    s_nop 0
    buffer_load_dwordx4 v22, s[36:39], s60 offen lds
    s_add_u32 s60, s50, 196608
    s_add_u32 s61, s53, s65
    s_add_u32 m0, s61, 3072
    s_nop 0
    buffer_load_dwordx4 v22, s[36:39], s60 offen lds
    s_add_u32 s49, s49, 128
    s_add_u32 s50, s50, 524288
    s_add_u32 s53, s53, 32768
    s_and_b32 s53, s53, 0x1ffff
    s_sub_u32 s54, s54, 1
    s_branch L_gj_30
L_gnd_29:
    v_mfma_f32_32x32x16_bf16 v[128:143], v[120:123], v[112:115], v[128:143]
    ds_read_b128 v[80:83], v15 offset:0
    ds_read_b128 v[84:87], v15 offset:4096
    v_mfma_f32_32x32x16_bf16 v[144:159], v[124:127], v[112:115], v[144:159]
    ds_read_b64_tr_b16 v[88:89], v18 offset:2048
    ds_read_b64_tr_b16 v[90:91], v18 offset:2560
    v_mfma_f32_32x32x16_bf16 v[160:175], v[120:123], v[116:119], v[160:175]
    ds_read_b64_tr_b16 v[92:93], v19 offset:2048
    ds_read_b64_tr_b16 v[94:95], v19 offset:2560
    v_mfma_f32_32x32x16_bf16 v[176:191], v[124:127], v[116:119], v[176:191]
L_gj_30:
    s_sub_u32 s51, s51, 1
    s_cmp_gt_u32 s51, 0
    s_cbranch_scc1 L_gk_26
    s_waitcnt lgkmcnt(0)
    s_nop 15
    s_barrier
    s_mov_b32 s67, 18874368
    v_bfe_u32 v24, v1, 4, 1
    v_lshlrev_b32 v24, 12, v24
    v_lshrrev_b32 v25, 5, v1
    v_lshl_add_u32 v24, v25, 8, v24
    v_and_b32 v25, 15, v1
    v_lshl_add_u32 v24, v25, 4, v24
    s_lshr_b32 s60, s3, 1
    s_lshl_b32 s60, s60, 1
    s_lshl_b32 s61, s55, 2
    s_add_u32 s60, s60, s61
    s_lshl_b32 s60, s60, 5
    s_add_u32 s60, s60, s56
    s_lshl_b32 s60, s60, 13
    s_and_b32 s61, s3, 1
    s_lshl_b32 s61, s61, 11
    s_add_u32 s60, s60, s61
    s_add_u32 s60, s60, s67
    v_cvt_pk_bf16_f32 v28, v128, v129
    v_cvt_pk_bf16_f32 v29, v130, v131
    v_cvt_pk_bf16_f32 v30, v132, v133
    v_cvt_pk_bf16_f32 v31, v134, v135
    s_add_u32 s61, s60, 0
    buffer_store_dwordx4 v[28:31], v24, s[32:35], s61 offen sc1
    v_cvt_pk_bf16_f32 v32, v136, v137
    v_cvt_pk_bf16_f32 v33, v138, v139
    v_cvt_pk_bf16_f32 v34, v140, v141
    v_cvt_pk_bf16_f32 v35, v142, v143
    s_add_u32 s61, s60, 512
    buffer_store_dwordx4 v[32:35], v24, s[32:35], s61 offen sc1
    v_cvt_pk_bf16_f32 v36, v144, v145
    v_cvt_pk_bf16_f32 v37, v146, v147
    v_cvt_pk_bf16_f32 v38, v148, v149
    v_cvt_pk_bf16_f32 v39, v150, v151
    s_add_u32 s61, s60, 1024
    buffer_store_dwordx4 v[36:39], v24, s[32:35], s61 offen sc1
    v_cvt_pk_bf16_f32 v40, v152, v153
    v_cvt_pk_bf16_f32 v41, v154, v155
    v_cvt_pk_bf16_f32 v42, v156, v157
    v_cvt_pk_bf16_f32 v43, v158, v159
    s_add_u32 s61, s60, 1536
    buffer_store_dwordx4 v[40:43], v24, s[32:35], s61 offen sc1
    v_cvt_pk_bf16_f32 v28, v160, v161
    v_cvt_pk_bf16_f32 v29, v162, v163
    v_cvt_pk_bf16_f32 v30, v164, v165
    v_cvt_pk_bf16_f32 v31, v166, v167
    s_add_u32 s61, s60, 262144
    buffer_store_dwordx4 v[28:31], v24, s[32:35], s61 offen sc1
    v_cvt_pk_bf16_f32 v32, v168, v169
    v_cvt_pk_bf16_f32 v33, v170, v171
    v_cvt_pk_bf16_f32 v34, v172, v173
    v_cvt_pk_bf16_f32 v35, v174, v175
    s_add_u32 s61, s60, 262656
    buffer_store_dwordx4 v[32:35], v24, s[32:35], s61 offen sc1
    v_cvt_pk_bf16_f32 v36, v176, v177
    v_cvt_pk_bf16_f32 v37, v178, v179
    v_cvt_pk_bf16_f32 v38, v180, v181
    v_cvt_pk_bf16_f32 v39, v182, v183
    s_add_u32 s61, s60, 263168
    buffer_store_dwordx4 v[36:39], v24, s[32:35], s61 offen sc1
    v_cvt_pk_bf16_f32 v40, v184, v185
    v_cvt_pk_bf16_f32 v41, v186, v187
    v_cvt_pk_bf16_f32 v42, v188, v189
    v_cvt_pk_bf16_f32 v43, v190, v191
    s_add_u32 s61, s60, 263680
    buffer_store_dwordx4 v[40:43], v24, s[32:35], s61 offen sc1
    s_waitcnt vmcnt(0)
    s_barrier
    s_cmp_lg_u32 s3, 0
    s_cbranch_scc1 L_sg_31
    s_lshl_b32 s60, s55, 7
    s_add_u32 s60, s60, 133173248
    v_mov_b32 v8, 1
    s_mov_b64 exec, 1
    buffer_atomic_add v8, off, s[32:35], s60 sc1
    s_mov_b64 exec, -1
L_sg_31:
    s_add_u32 s48, s48, 32
    s_branch L_q_loop
L_q_done:
    s_cmp_lt_u32 s96, 0
    s_cselect_b32 s98, 4, 4
    s_mov_b32 s99, 16384
    s_mov_b32 s48, s97
L_u_loop:
    s_lshl_b32 s60, s98, 4
    s_cmp_ge_u32 s48, s60
    s_cbranch_scc1 L_u_done
    s_mul_i32 s55, s48, s99
    s_lshr_b32 s55, s55, 16
    s_mul_i32 s60, s55, s98
    s_sub_u32 s60, s48, s60
    s_mul_i32 s60, s60, 7
    s_add_u32 s58, s60, s96
    s_mov_b32 s56, s58
    s_bitcmp1_b32 s86, s55
    s_cbranch_scc1 L_wf_32
    v_lshlrev_b32 v8, 7, v1
    s_mov_b32 s60, 133169152
L_wfl_33:
    s_mov_b64 exec, 0xffff
    buffer_load_dword v9, v8, s[32:35], s60 offen sc1
    s_waitcnt vmcnt(0)
    v_cmp_le_u32 vcc, 4, v9
    s_mov_b64 exec, -1
    s_mov_b32 s86, vcc_lo
    s_add_u32 s94, s94, 1
    s_cmp_gt_u32 s94, 3000000
    s_cbranch_scc1 L_exit
    s_bitcmp1_b32 s86, s55
    s_cbranch_scc1 L_wf_32
    s_sleep 8
    s_branch L_wfl_33
L_wf_32:
    s_cmp_ge_u32 s3, 2
    s_cselect_b32 s60, s22, s20
    s_cselect_b32 s61, s23, s21
    s_mov_b32 s36, s60
    s_and_b32 s37, s61, 0xffff
    s_mov_b32 s38, 1835008
    s_mov_b32 s39, 0x20000
    s_lshr_b32 s60, s3, 1
    s_and_b32 s61, s3, 1
    v_and_b32 v24, 31, v1
    s_lshl_b32 s62, s60, 6
    v_add_u32 v24, s62, v24
    v_bfe_u32 v25, v24, 1, 3
    v_lshrrev_b32 v26, 5, v1
    v_lshlrev_b32 v24, 7, v24
    v_add_u32 v27, 0, v26
    v_xor_b32 v27, v27, v25
    v_lshl_add_u32 v8, v27, 4, v24
    v_add_u32 v27, 2, v26
    v_xor_b32 v27, v27, v25
    v_lshl_add_u32 v9, v27, 4, v24
    v_add_u32 v27, 4, v26
    v_xor_b32 v27, v27, v25
    v_lshl_add_u32 v10, v27, 4, v24
    v_add_u32 v27, 6, v26
    v_xor_b32 v27, v27, v25
    v_lshl_add_u32 v11, v27, 4, v24
    v_bfe_u32 v24, v1, 2, 2
    v_lshrrev_b32 v25, 5, v1
    v_mul_u32_u24 v25, 8, v25
    v_add_u32 v25, v25, v24
    v_lshlrev_b32 v25, 7, v25
    v_lshrrev_b32 v24, 1, v24
    v_lshlrev_b32 v24, 2, v24
    v_bfe_u32 v26, v1, 4, 1
    v_lshlrev_b32 v26, 1, v26
    v_bfe_u32 v27, v1, 1, 1
    v_add_u32 v26, v26, v27
    v_and_b32 v27, 1, v1
    v_lshlrev_b32 v27, 3, v27
    v_add_u32 v25, v25, v27
    s_lshl_b32 s62, s61, 2
    v_add_u32 v28, s62, v26
    v_xor_b32 v28, v28, v24
    v_lshl_add_u32 v28, v28, 4, v25
    v_add_u32 v12, 16384, v28
    s_lshl_b32 s62, s61, 2
    v_add_u32 v28, s62, v26
    v_xor_b32 v28, v28, v24
    v_lshl_add_u32 v28, v28, 4, v25
    v_add_u32 v13, 24576, v28
    v_lshrrev_b32 v24, 3, v1
    v_and_b32 v25, 7, v1
    v_lshrrev_b32 v26, 4, v1
    s_mov_b32 s62, 1024
    v_mul_lo_u32 v27, s62, v24
    v_xor_b32 v28, v25, v26
    v_lshl_add_u32 v20, v28, 4, v27
    v_add_u32 v28, 4, v26
    v_xor_b32 v28, v25, v28
    v_lshl_add_u32 v21, v28, 4, v27
    s_mov_b32 s62, 3584
    v_mul_lo_u32 v27, s62, v24
    v_bfe_u32 v26, v1, 4, 1
    v_lshlrev_b32 v26, 2, v26
    v_xor_b32 v25, v25, v26
    v_lshl_add_u32 v22, v25, 4, v27
    s_lshl_b32 s49, s55, 17
    s_lshl_b32 s60, s3, 15
    s_add_u32 s49, s49, s60
    s_lshl_b32 s50, s56, 7
    s_and_b32 s60, s3, 1
    s_mul_i32 s60, s60, 114688
    s_add_u32 s50, s50, s60
    s_mov_b32 s51, 8
    s_lshl_b32 s64, s3, 12
    s_add_u32 s65, s64, 16384
    s_mov_b32 s53, 0
    s_mov_b32 s52, 0
    s_mov_b32 s54, s51
    s_add_u32 s60, s49, 0
    s_add_u32 s61, s53, s64
    s_add_u32 m0, s61, 0
    s_nop 0
    buffer_load_dwordx4 v20, s[32:35], s60 offen sc1 lds
    s_add_u32 s60, s49, 8192
    s_add_u32 s61, s53, s64
    s_add_u32 m0, s61, 1024
    s_nop 0
    buffer_load_dwordx4 v21, s[32:35], s60 offen sc1 lds
    s_add_u32 s60, s49, 16384
    s_add_u32 s61, s53, s64
    s_add_u32 m0, s61, 2048
    s_nop 0
    buffer_load_dwordx4 v20, s[32:35], s60 offen sc1 lds
    s_add_u32 s60, s49, 24576
    s_add_u32 s61, s53, s64
    s_add_u32 m0, s61, 3072
    s_nop 0
    buffer_load_dwordx4 v21, s[32:35], s60 offen sc1 lds
    s_add_u32 s60, s50, 0
    s_add_u32 s61, s53, s65
    s_add_u32 m0, s61, 0
    s_nop 0
    buffer_load_dwordx4 v22, s[36:39], s60 offen lds
    s_add_u32 s60, s50, 28672
    s_add_u32 s61, s53, s65
    s_add_u32 m0, s61, 1024
    s_nop 0
    buffer_load_dwordx4 v22, s[36:39], s60 offen lds
    s_add_u32 s60, s50, 57344
    s_add_u32 s61, s53, s65
    s_add_u32 m0, s61, 2048
    s_nop 0
    buffer_load_dwordx4 v22, s[36:39], s60 offen lds
    s_add_u32 s60, s50, 86016
    s_add_u32 s61, s53, s65
    s_add_u32 m0, s61, 3072
    s_nop 0
    buffer_load_dwordx4 v22, s[36:39], s60 offen lds
    s_add_u32 s49, s49, 128
    s_add_u32 s50, s50, 229376
    s_add_u32 s53, s53, 32768
    s_and_b32 s53, s53, 0x1ffff
    s_sub_u32 s54, s54, 1
    s_add_u32 s60, s49, 0
    s_add_u32 s61, s53, s64
    s_add_u32 m0, s61, 0
    s_nop 0
    buffer_load_dwordx4 v20, s[32:35], s60 offen sc1 lds
    s_add_u32 s60, s49, 8192
    s_add_u32 s61, s53, s64
    s_add_u32 m0, s61, 1024
    s_nop 0
    buffer_load_dwordx4 v21, s[32:35], s60 offen sc1 lds
    s_add_u32 s60, s49, 16384
    s_add_u32 s61, s53, s64
    s_add_u32 m0, s61, 2048
    s_nop 0
    buffer_load_dwordx4 v20, s[32:35], s60 offen sc1 lds
    s_add_u32 s60, s49, 24576
    s_add_u32 s61, s53, s64
    s_add_u32 m0, s61, 3072
    s_nop 0
    buffer_load_dwordx4 v21, s[32:35], s60 offen sc1 lds
    s_add_u32 s60, s50, 0
    s_add_u32 s61, s53, s65
    s_add_u32 m0, s61, 0
    s_nop 0
    buffer_load_dwordx4 v22, s[36:39], s60 offen lds
    s_add_u32 s60, s50, 28672
    s_add_u32 s61, s53, s65
    s_add_u32 m0, s61, 1024
    s_nop 0
    buffer_load_dwordx4 v22, s[36:39], s60 offen lds
    s_add_u32 s60, s50, 57344
    s_add_u32 s61, s53, s65
    s_add_u32 m0, s61, 2048
    s_nop 0
    buffer_load_dwordx4 v22, s[36:39], s60 offen lds
    s_add_u32 s60, s50, 86016
    s_add_u32 s61, s53, s65
    s_add_u32 m0, s61, 3072
    s_nop 0
    buffer_load_dwordx4 v22, s[36:39], s60 offen lds
    s_add_u32 s49, s49, 128
    s_add_u32 s50, s50, 229376
    s_add_u32 s53, s53, 32768
    s_and_b32 s53, s53, 0x1ffff
    s_sub_u32 s54, s54, 1
    s_add_u32 s60, s49, 0
    s_add_u32 s61, s53, s64
    s_add_u32 m0, s61, 0
    s_nop 0
    buffer_load_dwordx4 v20, s[32:35], s60 offen sc1 lds
    s_add_u32 s60, s49, 8192
    s_add_u32 s61, s53, s64
    s_add_u32 m0, s61, 1024
    s_nop 0
    buffer_load_dwordx4 v21, s[32:35], s60 offen sc1 lds
    s_add_u32 s60, s49, 16384
    s_add_u32 s61, s53, s64
    s_add_u32 m0, s61, 2048
    s_nop 0
    buffer_load_dwordx4 v20, s[32:35], s60 offen sc1 lds
    s_add_u32 s60, s49, 24576
    s_add_u32 s61, s53, s64
    s_add_u32 m0, s61, 3072
    s_nop 0
    buffer_load_dwordx4 v21, s[32:35], s60 offen sc1 lds
    s_add_u32 s60, s50, 0
    s_add_u32 s61, s53, s65
    s_add_u32 m0, s61, 0
    s_nop 0
    buffer_load_dwordx4 v22, s[36:39], s60 offen lds
    s_add_u32 s60, s50, 28672
    s_add_u32 s61, s53, s65
    s_add_u32 m0, s61, 1024
    s_nop 0
    buffer_load_dwordx4 v22, s[36:39], s60 offen lds
    s_add_u32 s60, s50, 57344
    s_add_u32 s61, s53, s65
    s_add_u32 m0, s61, 2048
    s_nop 0
    buffer_load_dwordx4 v22, s[36:39], s60 offen lds
    s_add_u32 s60, s50, 86016
    s_add_u32 s61, s53, s65
    s_add_u32 m0, s61, 3072
    s_nop 0
    buffer_load_dwordx4 v22, s[36:39], s60 offen lds
    s_add_u32 s49, s49, 128
    s_add_u32 s50, s50, 229376
    s_add_u32 s53, s53, 32768
    s_and_b32 s53, s53, 0x1ffff
    s_sub_u32 s54, s54, 1
    v_mov_b32 v128, 0
    v_mov_b32 v129, 0
    v_mov_b32 v130, 0
    v_mov_b32 v131, 0
    v_mov_b32 v132, 0
    v_mov_b32 v133, 0
    v_mov_b32 v134, 0
    v_mov_b32 v135, 0
    v_mov_b32 v136, 0
    v_mov_b32 v137, 0
    v_mov_b32 v138, 0
    v_mov_b32 v139, 0
    v_mov_b32 v140, 0
    v_mov_b32 v141, 0
    v_mov_b32 v142, 0
    v_mov_b32 v143, 0
    v_mov_b32 v144, 0
    v_mov_b32 v145, 0
    v_mov_b32 v146, 0
    v_mov_b32 v147, 0
    v_mov_b32 v148, 0
    v_mov_b32 v149, 0
    v_mov_b32 v150, 0
    v_mov_b32 v151, 0
    v_mov_b32 v152, 0
    v_mov_b32 v153, 0
    v_mov_b32 v154, 0
    v_mov_b32 v155, 0
    v_mov_b32 v156, 0
    v_mov_b32 v157, 0
    v_mov_b32 v158, 0
    v_mov_b32 v159, 0
    v_mov_b32 v160, 0
    v_mov_b32 v161, 0
    v_mov_b32 v162, 0
    v_mov_b32 v163, 0
    v_mov_b32 v164, 0
    v_mov_b32 v165, 0
    v_mov_b32 v166, 0
    v_mov_b32 v167, 0
    v_mov_b32 v168, 0
    v_mov_b32 v169, 0
    v_mov_b32 v170, 0
    v_mov_b32 v171, 0
    v_mov_b32 v172, 0
    v_mov_b32 v173, 0
    v_mov_b32 v174, 0
    v_mov_b32 v175, 0
    v_mov_b32 v176, 0
    v_mov_b32 v177, 0
    v_mov_b32 v178, 0
    v_mov_b32 v179, 0
    v_mov_b32 v180, 0
    v_mov_b32 v181, 0
    v_mov_b32 v182, 0
    v_mov_b32 v183, 0
    v_mov_b32 v184, 0
    v_mov_b32 v185, 0
    v_mov_b32 v186, 0
    v_mov_b32 v187, 0
    v_mov_b32 v188, 0
    v_mov_b32 v189, 0
    v_mov_b32 v190, 0
    v_mov_b32 v191, 0
    v_add_u32 v14, s52, v8
    v_add_u32 v15, s52, v9
    v_add_u32 v16, s52, v10
    v_add_u32 v17, s52, v11
    v_add_u32 v18, s52, v12
    v_add_u32 v19, s52, v13
    s_waitcnt vmcnt(16)
    s_barrier
    ds_read_b128 v[64:67], v14 offset:0
    ds_read_b128 v[68:71], v14 offset:4096
    ds_read_b64_tr_b16 v[72:73], v18 offset:0
    ds_read_b64_tr_b16 v[74:75], v18 offset:512
    ds_read_b64_tr_b16 v[76:77], v19 offset:0
    ds_read_b64_tr_b16 v[78:79], v19 offset:512
    ds_read_b128 v[80:83], v15 offset:0
    ds_read_b128 v[84:87], v15 offset:4096
    ds_read_b64_tr_b16 v[88:89], v18 offset:2048
    ds_read_b64_tr_b16 v[90:91], v18 offset:2560
    ds_read_b64_tr_b16 v[92:93], v19 offset:2048
    ds_read_b64_tr_b16 v[94:95], v19 offset:2560
L_gk_34:
    s_waitcnt lgkmcnt(6)
    v_mfma_f32_32x32x16_bf16 v[128:143], v[72:75], v[64:67], v[128:143]
    ds_read_b128 v[96:99], v16 offset:0
    ds_read_b128 v[100:103], v16 offset:4096
    v_mfma_f32_32x32x16_bf16 v[144:159], v[76:79], v[64:67], v[144:159]
    ds_read_b64_tr_b16 v[104:105], v18 offset:4096
    ds_read_b64_tr_b16 v[106:107], v18 offset:4608
    v_mfma_f32_32x32x16_bf16 v[160:175], v[72:75], v[68:71], v[160:175]
    ds_read_b64_tr_b16 v[108:109], v19 offset:4096
    ds_read_b64_tr_b16 v[110:111], v19 offset:4608
    v_mfma_f32_32x32x16_bf16 v[176:191], v[76:79], v[68:71], v[176:191]
    s_waitcnt lgkmcnt(6)
    v_mfma_f32_32x32x16_bf16 v[128:143], v[88:91], v[80:83], v[128:143]
    ds_read_b128 v[112:115], v17 offset:0
    ds_read_b128 v[116:119], v17 offset:4096
    v_mfma_f32_32x32x16_bf16 v[144:159], v[92:95], v[80:83], v[144:159]
    ds_read_b64_tr_b16 v[120:121], v18 offset:6144
    ds_read_b64_tr_b16 v[122:123], v18 offset:6656
    v_mfma_f32_32x32x16_bf16 v[160:175], v[88:91], v[84:87], v[160:175]
    ds_read_b64_tr_b16 v[124:125], v19 offset:6144
    ds_read_b64_tr_b16 v[126:127], v19 offset:6656
    v_mfma_f32_32x32x16_bf16 v[176:191], v[92:95], v[84:87], v[176:191]
    s_add_u32 s52, s52, 32768
    s_and_b32 s52, s52, 0x1ffff
    s_cmp_ge_u32 s51, 3
    s_cbranch_scc1 L_gw_35
    s_waitcnt vmcnt(0)
    s_branch L_gw_36
L_gw_35:
    s_waitcnt vmcnt(8)
L_gw_36:
    s_waitcnt lgkmcnt(6)
    s_barrier
    v_add_u32 v14, s52, v8
    v_add_u32 v15, s52, v9
    v_add_u32 v16, s52, v10
    v_add_u32 v17, s52, v11
    v_add_u32 v18, s52, v12
    v_add_u32 v19, s52, v13
    v_mfma_f32_32x32x16_bf16 v[128:143], v[104:107], v[96:99], v[128:143]
    ds_read_b128 v[64:67], v14 offset:0
    ds_read_b128 v[68:71], v14 offset:4096
    v_mfma_f32_32x32x16_bf16 v[144:159], v[108:111], v[96:99], v[144:159]
    ds_read_b64_tr_b16 v[72:73], v18 offset:0
    ds_read_b64_tr_b16 v[74:75], v18 offset:512
    v_mfma_f32_32x32x16_bf16 v[160:175], v[104:107], v[100:103], v[160:175]
    ds_read_b64_tr_b16 v[76:77], v19 offset:0
    ds_read_b64_tr_b16 v[78:79], v19 offset:512
    v_mfma_f32_32x32x16_bf16 v[176:191], v[108:111], v[100:103], v[176:191]
    s_waitcnt lgkmcnt(6)
    s_cmp_eq_u32 s54, 0
    s_cbranch_scc1 L_gnd_37
    v_mfma_f32_32x32x16_bf16 v[128:143], v[120:123], v[112:115], v[128:143]
    ds_read_b128 v[80:83], v15 offset:0
    ds_read_b128 v[84:87], v15 offset:4096
    s_add_u32 s60, s49, 0
    s_add_u32 s61, s53, s64
    s_add_u32 m0, s61, 0
    s_nop 0
    buffer_load_dwordx4 v20, s[32:35], s60 offen sc1 lds
    s_add_u32 s60, s49, 8192
    s_add_u32 s61, s53, s64
    s_add_u32 m0, s61, 1024
    s_nop 0
    buffer_load_dwordx4 v21, s[32:35], s60 offen sc1 lds
    v_mfma_f32_32x32x16_bf16 v[144:159], v[124:127], v[112:115], v[144:159]
    ds_read_b64_tr_b16 v[88:89], v18 offset:2048
    ds_read_b64_tr_b16 v[90:91], v18 offset:2560
    s_add_u32 s60, s49, 16384
    s_add_u32 s61, s53, s64
    s_add_u32 m0, s61, 2048
    s_nop 0
    buffer_load_dwordx4 v20, s[32:35], s60 offen sc1 lds
    s_add_u32 s60, s49, 24576
    s_add_u32 s61, s53, s64
    s_add_u32 m0, s61, 3072
    s_nop 0
    buffer_load_dwordx4 v21, s[32:35], s60 offen sc1 lds
    v_mfma_f32_32x32x16_bf16 v[160:175], v[120:123], v[116:119], v[160:175]
    ds_read_b64_tr_b16 v[92:93], v19 offset:2048
    ds_read_b64_tr_b16 v[94:95], v19 offset:2560
    s_add_u32 s60, s50, 0
    s_add_u32 s61, s53, s65
    s_add_u32 m0, s61, 0
    s_nop 0
    buffer_load_dwordx4 v22, s[36:39], s60 offen lds
    s_add_u32 s60, s50, 28672
    s_add_u32 s61, s53, s65
    s_add_u32 m0, s61, 1024
    s_nop 0
    buffer_load_dwordx4 v22, s[36:39], s60 offen lds
    v_mfma_f32_32x32x16_bf16 v[176:191], v[124:127], v[116:119], v[176:191]
    s_add_u32 s60, s50, 57344
    s_add_u32 s61, s53, s65
    s_add_u32 m0, s61, 2048
    s_nop 0
    buffer_load_dwordx4 v22, s[36:39], s60 offen lds
    s_add_u32 s60, s50, 86016
    s_add_u32 s61, s53, s65
    s_add_u32 m0, s61, 3072
    s_nop 0
    buffer_load_dwordx4 v22, s[36:39], s60 offen lds
    s_add_u32 s49, s49, 128
    s_add_u32 s50, s50, 229376
    s_add_u32 s53, s53, 32768
    s_and_b32 s53, s53, 0x1ffff
    s_sub_u32 s54, s54, 1
    s_branch L_gj_38
L_gnd_37:
    v_mfma_f32_32x32x16_bf16 v[128:143], v[120:123], v[112:115], v[128:143]
    ds_read_b128 v[80:83], v15 offset:0
    ds_read_b128 v[84:87], v15 offset:4096
    v_mfma_f32_32x32x16_bf16 v[144:159], v[124:127], v[112:115], v[144:159]
    ds_read_b64_tr_b16 v[88:89], v18 offset:2048
    ds_read_b64_tr_b16 v[90:91], v18 offset:2560
    v_mfma_f32_32x32x16_bf16 v[160:175], v[120:123], v[116:119], v[160:175]
    ds_read_b64_tr_b16 v[92:93], v19 offset:2048
    ds_read_b64_tr_b16 v[94:95], v19 offset:2560
    v_mfma_f32_32x32x16_bf16 v[176:191], v[124:127], v[116:119], v[176:191]
L_gj_38:
    s_sub_u32 s51, s51, 1
    s_cmp_gt_u32 s51, 0
    s_cbranch_scc1 L_gk_34
    s_waitcnt lgkmcnt(0)
    s_nop 15
    s_barrier
    s_mov_b32 s66, 0xbfb8aa3b
    v_and_b32 v24, 31, v1
    s_mov_b32 s60, 3584
    v_mul_lo_u32 v24, s60, v24
    v_lshrrev_b32 v25, 5, v1
    v_lshl_add_u32 v24, v25, 4, v24
    s_lshr_b32 s60, s3, 1
    s_lshl_b32 s60, s60, 6
    s_lshl_b32 s61, s55, 7
    s_add_u32 s60, s60, s61
    s_mul_i32 s60, s60, 3584
    s_lshl_b32 s61, s56, 7
    s_add_u32 s60, s60, s61
    s_and_b32 s61, s3, 1
    s_lshl_b32 s61, s61, 6
    s_add_u32 s60, s60, s61
    s_add_u32 s60, s60, 85983232
    v_mul_f32 v26, s66, v128
    v_exp_f32 v26, v26
    s_nop 0
    v_add_f32 v26, 1.0, v26
    v_rcp_f32 v26, v26
    s_nop 0
    v_mul_f32 v128, v128, v26
    v_mul_f32 v128, v128, v144
    v_mul_f32 v27, s66, v129
    v_exp_f32 v27, v27
    s_nop 0
    v_add_f32 v27, 1.0, v27
    v_rcp_f32 v27, v27
    s_nop 0
    v_mul_f32 v129, v129, v27
    v_mul_f32 v129, v129, v145
    v_mul_f32 v26, s66, v130
    v_exp_f32 v26, v26
    s_nop 0
    v_add_f32 v26, 1.0, v26
    v_rcp_f32 v26, v26
    s_nop 0
    v_mul_f32 v130, v130, v26
    v_mul_f32 v130, v130, v146
    v_mul_f32 v27, s66, v131
    v_exp_f32 v27, v27
    s_nop 0
    v_add_f32 v27, 1.0, v27
    v_rcp_f32 v27, v27
    s_nop 0
    v_mul_f32 v131, v131, v27
    v_mul_f32 v131, v131, v147
    v_mul_f32 v26, s66, v132
    v_exp_f32 v26, v26
    s_nop 0
    v_add_f32 v26, 1.0, v26
    v_rcp_f32 v26, v26
    s_nop 0
    v_mul_f32 v132, v132, v26
    v_mul_f32 v132, v132, v148
    v_mul_f32 v27, s66, v133
    v_exp_f32 v27, v27
    s_nop 0
    v_add_f32 v27, 1.0, v27
    v_rcp_f32 v27, v27
    s_nop 0
    v_mul_f32 v133, v133, v27
    v_mul_f32 v133, v133, v149
    v_mul_f32 v26, s66, v134
    v_exp_f32 v26, v26
    s_nop 0
    v_add_f32 v26, 1.0, v26
    v_rcp_f32 v26, v26
    s_nop 0
    v_mul_f32 v134, v134, v26
    v_mul_f32 v134, v134, v150
    v_mul_f32 v27, s66, v135
    v_exp_f32 v27, v27
    s_nop 0
    v_add_f32 v27, 1.0, v27
    v_rcp_f32 v27, v27
    s_nop 0
    v_mul_f32 v135, v135, v27
    v_mul_f32 v135, v135, v151
    v_mul_f32 v26, s66, v136
    v_exp_f32 v26, v26
    s_nop 0
    v_add_f32 v26, 1.0, v26
    v_rcp_f32 v26, v26
    s_nop 0
    v_mul_f32 v136, v136, v26
    v_mul_f32 v136, v136, v152
    v_mul_f32 v27, s66, v137
    v_exp_f32 v27, v27
    s_nop 0
    v_add_f32 v27, 1.0, v27
    v_rcp_f32 v27, v27
    s_nop 0
    v_mul_f32 v137, v137, v27
    v_mul_f32 v137, v137, v153
    v_mul_f32 v26, s66, v138
    v_exp_f32 v26, v26
    s_nop 0
    v_add_f32 v26, 1.0, v26
    v_rcp_f32 v26, v26
    s_nop 0
    v_mul_f32 v138, v138, v26
    v_mul_f32 v138, v138, v154
    v_mul_f32 v27, s66, v139
    v_exp_f32 v27, v27
    s_nop 0
    v_add_f32 v27, 1.0, v27
    v_rcp_f32 v27, v27
    s_nop 0
    v_mul_f32 v139, v139, v27
    v_mul_f32 v139, v139, v155
    v_mul_f32 v26, s66, v140
    v_exp_f32 v26, v26
    s_nop 0
    v_add_f32 v26, 1.0, v26
    v_rcp_f32 v26, v26
    s_nop 0
    v_mul_f32 v140, v140, v26
    v_mul_f32 v140, v140, v156
    v_mul_f32 v27, s66, v141
    v_exp_f32 v27, v27
    s_nop 0
    v_add_f32 v27, 1.0, v27
    v_rcp_f32 v27, v27
    s_nop 0
    v_mul_f32 v141, v141, v27
    v_mul_f32 v141, v141, v157
    v_mul_f32 v26, s66, v142
    v_exp_f32 v26, v26
    s_nop 0
    v_add_f32 v26, 1.0, v26
    v_rcp_f32 v26, v26
    s_nop 0
    v_mul_f32 v142, v142, v26
    v_mul_f32 v142, v142, v158
    v_mul_f32 v27, s66, v143
    v_exp_f32 v27, v27
    s_nop 0
    v_add_f32 v27, 1.0, v27
    v_rcp_f32 v27, v27
    s_nop 0
    v_mul_f32 v143, v143, v27
    v_mul_f32 v143, v143, v159
    v_cvt_pk_bf16_f32 v28, v128, v129
    v_cvt_pk_bf16_f32 v29, v130, v131
    v_cvt_pk_bf16_f32 v30, v132, v133
    v_cvt_pk_bf16_f32 v31, v134, v135
    s_add_u32 s61, s60, 0
    buffer_store_dwordx4 v[28:31], v24, s[32:35], s61 offen sc1
    v_cvt_pk_bf16_f32 v32, v136, v137
    v_cvt_pk_bf16_f32 v33, v138, v139
    v_cvt_pk_bf16_f32 v34, v140, v141
    v_cvt_pk_bf16_f32 v35, v142, v143
    s_add_u32 s61, s60, 32
    buffer_store_dwordx4 v[32:35], v24, s[32:35], s61 offen sc1
    v_mul_f32 v26, s66, v160
    v_exp_f32 v26, v26
    s_nop 0
    v_add_f32 v26, 1.0, v26
    v_rcp_f32 v26, v26
    s_nop 0
    v_mul_f32 v160, v160, v26
    v_mul_f32 v160, v160, v176
    v_mul_f32 v27, s66, v161
    v_exp_f32 v27, v27
    s_nop 0
    v_add_f32 v27, 1.0, v27
    v_rcp_f32 v27, v27
    s_nop 0
    v_mul_f32 v161, v161, v27
    v_mul_f32 v161, v161, v177
    v_mul_f32 v26, s66, v162
    v_exp_f32 v26, v26
    s_nop 0
    v_add_f32 v26, 1.0, v26
    v_rcp_f32 v26, v26
    s_nop 0
    v_mul_f32 v162, v162, v26
    v_mul_f32 v162, v162, v178
    v_mul_f32 v27, s66, v163
    v_exp_f32 v27, v27
    s_nop 0
    v_add_f32 v27, 1.0, v27
    v_rcp_f32 v27, v27
    s_nop 0
    v_mul_f32 v163, v163, v27
    v_mul_f32 v163, v163, v179
    v_mul_f32 v26, s66, v164
    v_exp_f32 v26, v26
    s_nop 0
    v_add_f32 v26, 1.0, v26
    v_rcp_f32 v26, v26
    s_nop 0
    v_mul_f32 v164, v164, v26
    v_mul_f32 v164, v164, v180
    v_mul_f32 v27, s66, v165
    v_exp_f32 v27, v27
    s_nop 0
    v_add_f32 v27, 1.0, v27
    v_rcp_f32 v27, v27
    s_nop 0
    v_mul_f32 v165, v165, v27
    v_mul_f32 v165, v165, v181
    v_mul_f32 v26, s66, v166
    v_exp_f32 v26, v26
    s_nop 0
    v_add_f32 v26, 1.0, v26
    v_rcp_f32 v26, v26
    s_nop 0
    v_mul_f32 v166, v166, v26
    v_mul_f32 v166, v166, v182
    v_mul_f32 v27, s66, v167
    v_exp_f32 v27, v27
    s_nop 0
    v_add_f32 v27, 1.0, v27
    v_rcp_f32 v27, v27
    s_nop 0
    v_mul_f32 v167, v167, v27
    v_mul_f32 v167, v167, v183
    v_mul_f32 v26, s66, v168
    v_exp_f32 v26, v26
    s_nop 0
    v_add_f32 v26, 1.0, v26
    v_rcp_f32 v26, v26
    s_nop 0
    v_mul_f32 v168, v168, v26
    v_mul_f32 v168, v168, v184
    v_mul_f32 v27, s66, v169
    v_exp_f32 v27, v27
    s_nop 0
    v_add_f32 v27, 1.0, v27
    v_rcp_f32 v27, v27
    s_nop 0
    v_mul_f32 v169, v169, v27
    v_mul_f32 v169, v169, v185
    v_mul_f32 v26, s66, v170
    v_exp_f32 v26, v26
    s_nop 0
    v_add_f32 v26, 1.0, v26
    v_rcp_f32 v26, v26
    s_nop 0
    v_mul_f32 v170, v170, v26
    v_mul_f32 v170, v170, v186
    v_mul_f32 v27, s66, v171
    v_exp_f32 v27, v27
    s_nop 0
    v_add_f32 v27, 1.0, v27
    v_rcp_f32 v27, v27
    s_nop 0
    v_mul_f32 v171, v171, v27
    v_mul_f32 v171, v171, v187
    v_mul_f32 v26, s66, v172
    v_exp_f32 v26, v26
    s_nop 0
    v_add_f32 v26, 1.0, v26
    v_rcp_f32 v26, v26
    s_nop 0
    v_mul_f32 v172, v172, v26
    v_mul_f32 v172, v172, v188
    v_mul_f32 v27, s66, v173
    v_exp_f32 v27, v27
    s_nop 0
    v_add_f32 v27, 1.0, v27
    v_rcp_f32 v27, v27
    s_nop 0
    v_mul_f32 v173, v173, v27
    v_mul_f32 v173, v173, v189
    v_mul_f32 v26, s66, v174
    v_exp_f32 v26, v26
    s_nop 0
    v_add_f32 v26, 1.0, v26
    v_rcp_f32 v26, v26
    s_nop 0
    v_mul_f32 v174, v174, v26
    v_mul_f32 v174, v174, v190
    v_mul_f32 v27, s66, v175
    v_exp_f32 v27, v27
    s_nop 0
    v_add_f32 v27, 1.0, v27
    v_rcp_f32 v27, v27
    s_nop 0
    v_mul_f32 v175, v175, v27
    v_mul_f32 v175, v175, v191
    v_cvt_pk_bf16_f32 v28, v160, v161
    v_cvt_pk_bf16_f32 v29, v162, v163
    v_cvt_pk_bf16_f32 v30, v164, v165
    v_cvt_pk_bf16_f32 v31, v166, v167
    s_add_u32 s61, s60, 114688
    buffer_store_dwordx4 v[28:31], v24, s[32:35], s61 offen sc1
    v_cvt_pk_bf16_f32 v32, v168, v169
    v_cvt_pk_bf16_f32 v33, v170, v171
    v_cvt_pk_bf16_f32 v34, v172, v173
    v_cvt_pk_bf16_f32 v35, v174, v175
    s_add_u32 s61, s60, 114720
    buffer_store_dwordx4 v[32:35], v24, s[32:35], s61 offen sc1
    s_waitcnt vmcnt(0)
    s_barrier
    s_cmp_lg_u32 s3, 0
    s_cbranch_scc1 L_sg_39
    s_lshl_b32 s60, s55, 7
    s_add_u32 s60, s60, 133175296
    v_mov_b32 v8, 1
    s_mov_b64 exec, 1
    buffer_atomic_add v8, off, s[32:35], s60 sc1
    s_mov_b64 exec, -1
L_sg_39:
    s_add_u32 s48, s48, 32
    s_branch L_u_loop
L_u_done:
    s_add_u32 s60, s84, 96
    s_cmp_ge_u32 s60, 224
    s_cselect_b32 s61, 224, 0
    s_sub_u32 s60, s60, s61
    s_cmp_ge_u32 s60, 64
    s_cbranch_scc1 L_d_done
    s_lshr_b32 s55, s60, 2
    s_and_b32 s56, s60, 3
    s_bitcmp1_b32 s89, s55
    s_cbranch_scc1 L_wf_40
    v_lshlrev_b32 v8, 7, v1
    s_mov_b32 s60, 133175296
L_wfl_41:
    s_mov_b64 exec, 0xffff
    buffer_load_dword v9, v8, s[32:35], s60 offen sc1
    s_waitcnt vmcnt(0)
    v_cmp_le_u32 vcc, 28, v9
    s_mov_b64 exec, -1
    s_mov_b32 s89, vcc_lo
    s_add_u32 s94, s94, 1
    s_cmp_gt_u32 s94, 3000000
    s_cbranch_scc1 L_exit
    s_bitcmp1_b32 s89, s55
    s_cbranch_scc1 L_wf_40
    s_sleep 8
    s_branch L_wfl_41
L_wf_40:
    s_mov_b32 s36, s24
    s_and_b32 s37, s25, 0xffff
    s_mov_b32 s38, 1835008
    s_mov_b32 s39, 0x20000
    s_lshr_b32 s60, s3, 1
    s_and_b32 s61, s3, 1
    v_and_b32 v24, 31, v1
    s_lshl_b32 s62, s60, 6
    v_add_u32 v24, s62, v24
    v_bfe_u32 v25, v24, 1, 3
    v_lshrrev_b32 v26, 5, v1
    v_lshlrev_b32 v24, 7, v24
    v_add_u32 v27, 0, v26
    v_xor_b32 v27, v27, v25
    v_lshl_add_u32 v8, v27, 4, v24
    v_add_u32 v27, 2, v26
    v_xor_b32 v27, v27, v25
    v_lshl_add_u32 v9, v27, 4, v24
    v_add_u32 v27, 4, v26
    v_xor_b32 v27, v27, v25
    v_lshl_add_u32 v10, v27, 4, v24
    v_add_u32 v27, 6, v26
    v_xor_b32 v27, v27, v25
    v_lshl_add_u32 v11, v27, 4, v24
    v_bfe_u32 v24, v1, 2, 2
    v_lshrrev_b32 v25, 5, v1
    v_mul_u32_u24 v25, 4, v25
    v_add_u32 v25, v25, v24
    v_lshlrev_b32 v25, 7, v25
    v_lshrrev_b32 v24, 1, v24
    v_lshlrev_b32 v24, 2, v24
    v_bfe_u32 v26, v1, 4, 1
    v_lshlrev_b32 v26, 1, v26
    v_bfe_u32 v27, v1, 1, 1
    v_add_u32 v26, v26, v27
    v_and_b32 v27, 1, v1
    v_lshlrev_b32 v27, 3, v27
    v_add_u32 v25, v25, v27
    v_add_u32 v28, 0, v26
    v_xor_b32 v28, v28, v24
    v_lshl_add_u32 v28, v28, 4, v25
    s_lshl_b32 s62, s61, 13
    s_add_u32 s62, s62, 16384
    v_add_u32 v12, s62, v28
    v_add_u32 v28, 4, v26
    v_xor_b32 v28, v28, v24
    v_lshl_add_u32 v28, v28, 4, v25
    s_lshl_b32 s62, s61, 13
    s_add_u32 s62, s62, 16384
    v_add_u32 v13, s62, v28
    v_lshrrev_b32 v24, 3, v1
    v_and_b32 v25, 7, v1
    v_lshrrev_b32 v26, 4, v1
    s_mov_b32 s62, 3584
    v_mul_lo_u32 v27, s62, v24
    v_xor_b32 v28, v25, v26
    v_lshl_add_u32 v20, v28, 4, v27
    v_add_u32 v28, 4, v26
    v_xor_b32 v28, v25, v28
    v_lshl_add_u32 v21, v28, 4, v27
    s_mov_b32 s62, 1024
    v_mul_lo_u32 v27, s62, v24
    v_bfe_u32 v26, v1, 4, 1
    v_lshlrev_b32 v26, 2, v26
    v_xor_b32 v25, v25, v26
    v_lshl_add_u32 v22, v25, 4, v27
    s_lshl_b32 s49, s55, 7
    s_lshl_b32 s60, s3, 5
    s_add_u32 s49, s49, s60
    s_mul_i32 s49, s49, 3584
    s_add_u32 s49, s49, 85983232
    s_lshl_b32 s50, s56, 8
    s_lshr_b32 s60, s3, 1
    s_lshl_b32 s60, s60, 7
    s_add_u32 s50, s50, s60
    s_and_b32 s60, s3, 1
    s_lshl_b32 s60, s60, 15
    s_add_u32 s50, s50, s60
    s_mov_b32 s51, 28
    s_lshl_b32 s64, s3, 12
    s_add_u32 s65, s64, 16384
    s_mov_b32 s53, 0
    s_mov_b32 s52, 0
    s_mov_b32 s54, s51
    s_add_u32 s60, s49, 0
    s_add_u32 s61, s53, s64
    s_add_u32 m0, s61, 0
    s_nop 0
    buffer_load_dwordx4 v20, s[32:35], s60 offen sc1 lds
    s_add_u32 s60, s49, 28672
    s_add_u32 s61, s53, s64
    s_add_u32 m0, s61, 1024
    s_nop 0
    buffer_load_dwordx4 v21, s[32:35], s60 offen sc1 lds
    s_add_u32 s60, s49, 57344
    s_add_u32 s61, s53, s64
    s_add_u32 m0, s61, 2048
    s_nop 0
    buffer_load_dwordx4 v20, s[32:35], s60 offen sc1 lds
    s_add_u32 s60, s49, 86016
    s_add_u32 s61, s53, s64
    s_add_u32 m0, s61, 3072
    s_nop 0
    buffer_load_dwordx4 v21, s[32:35], s60 offen sc1 lds
    s_add_u32 s60, s50, 0
    s_add_u32 s61, s53, s65
    s_add_u32 m0, s61, 0
    s_nop 0
    buffer_load_dwordx4 v22, s[36:39], s60 offen lds
    s_add_u32 s60, s50, 8192
    s_add_u32 s61, s53, s65
    s_add_u32 m0, s61, 1024
    s_nop 0
    buffer_load_dwordx4 v22, s[36:39], s60 offen lds
    s_add_u32 s60, s50, 16384
    s_add_u32 s61, s53, s65
    s_add_u32 m0, s61, 2048
    s_nop 0
    buffer_load_dwordx4 v22, s[36:39], s60 offen lds
    s_add_u32 s60, s50, 24576
    s_add_u32 s61, s53, s65
    s_add_u32 m0, s61, 3072
    s_nop 0
    buffer_load_dwordx4 v22, s[36:39], s60 offen lds
    s_add_u32 s49, s49, 128
    s_add_u32 s50, s50, 65536
    s_add_u32 s53, s53, 32768
    s_and_b32 s53, s53, 0x1ffff
    s_sub_u32 s54, s54, 1
    s_add_u32 s60, s49, 0
    s_add_u32 s61, s53, s64
    s_add_u32 m0, s61, 0
    s_nop 0
    buffer_load_dwordx4 v20, s[32:35], s60 offen sc1 lds
    s_add_u32 s60, s49, 28672
    s_add_u32 s61, s53, s64
    s_add_u32 m0, s61, 1024
    s_nop 0
    buffer_load_dwordx4 v21, s[32:35], s60 offen sc1 lds
    s_add_u32 s60, s49, 57344
    s_add_u32 s61, s53, s64
    s_add_u32 m0, s61, 2048
    s_nop 0
    buffer_load_dwordx4 v20, s[32:35], s60 offen sc1 lds
    s_add_u32 s60, s49, 86016
    s_add_u32 s61, s53, s64
    s_add_u32 m0, s61, 3072
    s_nop 0
    buffer_load_dwordx4 v21, s[32:35], s60 offen sc1 lds
    s_add_u32 s60, s50, 0
    s_add_u32 s61, s53, s65
    s_add_u32 m0, s61, 0
    s_nop 0
    buffer_load_dwordx4 v22, s[36:39], s60 offen lds
    s_add_u32 s60, s50, 8192
    s_add_u32 s61, s53, s65
    s_add_u32 m0, s61, 1024
    s_nop 0
    buffer_load_dwordx4 v22, s[36:39], s60 offen lds
    s_add_u32 s60, s50, 16384
    s_add_u32 s61, s53, s65
    s_add_u32 m0, s61, 2048
    s_nop 0
    buffer_load_dwordx4 v22, s[36:39], s60 offen lds
    s_add_u32 s60, s50, 24576
    s_add_u32 s61, s53, s65
    s_add_u32 m0, s61, 3072
    s_nop 0
    buffer_load_dwordx4 v22, s[36:39], s60 offen lds
    s_add_u32 s49, s49, 128
    s_add_u32 s50, s50, 65536
    s_add_u32 s53, s53, 32768
    s_and_b32 s53, s53, 0x1ffff
    s_sub_u32 s54, s54, 1
    s_add_u32 s60, s49, 0
    s_add_u32 s61, s53, s64
    s_add_u32 m0, s61, 0
    s_nop 0
    buffer_load_dwordx4 v20, s[32:35], s60 offen sc1 lds
    s_add_u32 s60, s49, 28672
    s_add_u32 s61, s53, s64
    s_add_u32 m0, s61, 1024
    s_nop 0
    buffer_load_dwordx4 v21, s[32:35], s60 offen sc1 lds
    s_add_u32 s60, s49, 57344
    s_add_u32 s61, s53, s64
    s_add_u32 m0, s61, 2048
    s_nop 0
    buffer_load_dwordx4 v20, s[32:35], s60 offen sc1 lds
    s_add_u32 s60, s49, 86016
    s_add_u32 s61, s53, s64
    s_add_u32 m0, s61, 3072
    s_nop 0
    buffer_load_dwordx4 v21, s[32:35], s60 offen sc1 lds
    s_add_u32 s60, s50, 0
    s_add_u32 s61, s53, s65
    s_add_u32 m0, s61, 0
    s_nop 0
    buffer_load_dwordx4 v22, s[36:39], s60 offen lds
    s_add_u32 s60, s50, 8192
    s_add_u32 s61, s53, s65
    s_add_u32 m0, s61, 1024
    s_nop 0
    buffer_load_dwordx4 v22, s[36:39], s60 offen lds
    s_add_u32 s60, s50, 16384
    s_add_u32 s61, s53, s65
    s_add_u32 m0, s61, 2048
    s_nop 0
    buffer_load_dwordx4 v22, s[36:39], s60 offen lds
    s_add_u32 s60, s50, 24576
    s_add_u32 s61, s53, s65
    s_add_u32 m0, s61, 3072
    s_nop 0
    buffer_load_dwordx4 v22, s[36:39], s60 offen lds
    s_add_u32 s49, s49, 128
    s_add_u32 s50, s50, 65536
    s_add_u32 s53, s53, 32768
    s_and_b32 s53, s53, 0x1ffff
    s_sub_u32 s54, s54, 1
    v_mov_b32 v128, 0
    v_mov_b32 v129, 0
    v_mov_b32 v130, 0
    v_mov_b32 v131, 0
    v_mov_b32 v132, 0
    v_mov_b32 v133, 0
    v_mov_b32 v134, 0
    v_mov_b32 v135, 0
    v_mov_b32 v136, 0
    v_mov_b32 v137, 0
    v_mov_b32 v138, 0
    v_mov_b32 v139, 0
    v_mov_b32 v140, 0
    v_mov_b32 v141, 0
    v_mov_b32 v142, 0
    v_mov_b32 v143, 0
    v_mov_b32 v144, 0
    v_mov_b32 v145, 0
    v_mov_b32 v146, 0
    v_mov_b32 v147, 0
    v_mov_b32 v148, 0
    v_mov_b32 v149, 0
    v_mov_b32 v150, 0
    v_mov_b32 v151, 0
    v_mov_b32 v152, 0
    v_mov_b32 v153, 0
    v_mov_b32 v154, 0
    v_mov_b32 v155, 0
    v_mov_b32 v156, 0
    v_mov_b32 v157, 0
    v_mov_b32 v158, 0
    v_mov_b32 v159, 0
    v_mov_b32 v160, 0
    v_mov_b32 v161, 0
    v_mov_b32 v162, 0
    v_mov_b32 v163, 0
    v_mov_b32 v164, 0
    v_mov_b32 v165, 0
    v_mov_b32 v166, 0
    v_mov_b32 v167, 0
    v_mov_b32 v168, 0
    v_mov_b32 v169, 0
    v_mov_b32 v170, 0
    v_mov_b32 v171, 0
    v_mov_b32 v172, 0
    v_mov_b32 v173, 0
    v_mov_b32 v174, 0
    v_mov_b32 v175, 0
    v_mov_b32 v176, 0
    v_mov_b32 v177, 0
    v_mov_b32 v178, 0
    v_mov_b32 v179, 0
    v_mov_b32 v180, 0
    v_mov_b32 v181, 0
    v_mov_b32 v182, 0
    v_mov_b32 v183, 0
    v_mov_b32 v184, 0
    v_mov_b32 v185, 0
    v_mov_b32 v186, 0
    v_mov_b32 v187, 0
    v_mov_b32 v188, 0
    v_mov_b32 v189, 0
    v_mov_b32 v190, 0
    v_mov_b32 v191, 0
    v_add_u32 v14, s52, v8
    v_add_u32 v15, s52, v9
    v_add_u32 v16, s52, v10
    v_add_u32 v17, s52, v11
    v_add_u32 v18, s52, v12
    v_add_u32 v19, s52, v13
    s_waitcnt vmcnt(16)
    s_barrier
    ds_read_b128 v[64:67], v14 offset:0
    ds_read_b128 v[68:71], v14 offset:4096
    ds_read_b64_tr_b16 v[72:73], v18 offset:0
    ds_read_b64_tr_b16 v[74:75], v18 offset:1024
    ds_read_b64_tr_b16 v[76:77], v19 offset:0
    ds_read_b64_tr_b16 v[78:79], v19 offset:1024
    ds_read_b128 v[80:83], v15 offset:0
    ds_read_b128 v[84:87], v15 offset:4096
    ds_read_b64_tr_b16 v[88:89], v18 offset:2048
    ds_read_b64_tr_b16 v[90:91], v18 offset:3072
    ds_read_b64_tr_b16 v[92:93], v19 offset:2048
    ds_read_b64_tr_b16 v[94:95], v19 offset:3072
L_gk_42:
    s_waitcnt lgkmcnt(6)
    v_mfma_f32_32x32x16_bf16 v[128:143], v[72:75], v[64:67], v[128:143]
    ds_read_b128 v[96:99], v16 offset:0
    ds_read_b128 v[100:103], v16 offset:4096
    v_mfma_f32_32x32x16_bf16 v[144:159], v[76:79], v[64:67], v[144:159]
    ds_read_b64_tr_b16 v[104:105], v18 offset:4096
    ds_read_b64_tr_b16 v[106:107], v18 offset:5120
    v_mfma_f32_32x32x16_bf16 v[160:175], v[72:75], v[68:71], v[160:175]
    ds_read_b64_tr_b16 v[108:109], v19 offset:4096
    ds_read_b64_tr_b16 v[110:111], v19 offset:5120
    v_mfma_f32_32x32x16_bf16 v[176:191], v[76:79], v[68:71], v[176:191]
    s_waitcnt lgkmcnt(6)
    v_mfma_f32_32x32x16_bf16 v[128:143], v[88:91], v[80:83], v[128:143]
    ds_read_b128 v[112:115], v17 offset:0
    ds_read_b128 v[116:119], v17 offset:4096
    v_mfma_f32_32x32x16_bf16 v[144:159], v[92:95], v[80:83], v[144:159]
    ds_read_b64_tr_b16 v[120:121], v18 offset:6144
    ds_read_b64_tr_b16 v[122:123], v18 offset:7168
    v_mfma_f32_32x32x16_bf16 v[160:175], v[88:91], v[84:87], v[160:175]
    ds_read_b64_tr_b16 v[124:125], v19 offset:6144
    ds_read_b64_tr_b16 v[126:127], v19 offset:7168
    v_mfma_f32_32x32x16_bf16 v[176:191], v[92:95], v[84:87], v[176:191]
    s_add_u32 s52, s52, 32768
    s_and_b32 s52, s52, 0x1ffff
    s_cmp_ge_u32 s51, 3
    s_cbranch_scc1 L_gw_43
    s_waitcnt vmcnt(0)
    s_branch L_gw_44
L_gw_43:
    s_waitcnt vmcnt(8)
L_gw_44:
    s_waitcnt lgkmcnt(6)
    s_barrier
    v_add_u32 v14, s52, v8
    v_add_u32 v15, s52, v9
    v_add_u32 v16, s52, v10
    v_add_u32 v17, s52, v11
    v_add_u32 v18, s52, v12
    v_add_u32 v19, s52, v13
    v_mfma_f32_32x32x16_bf16 v[128:143], v[104:107], v[96:99], v[128:143]
    ds_read_b128 v[64:67], v14 offset:0
    ds_read_b128 v[68:71], v14 offset:4096
    v_mfma_f32_32x32x16_bf16 v[144:159], v[108:111], v[96:99], v[144:159]
    ds_read_b64_tr_b16 v[72:73], v18 offset:0
    ds_read_b64_tr_b16 v[74:75], v18 offset:1024
    v_mfma_f32_32x32x16_bf16 v[160:175], v[104:107], v[100:103], v[160:175]
    ds_read_b64_tr_b16 v[76:77], v19 offset:0
    ds_read_b64_tr_b16 v[78:79], v19 offset:1024
    v_mfma_f32_32x32x16_bf16 v[176:191], v[108:111], v[100:103], v[176:191]
    s_waitcnt lgkmcnt(6)
    s_cmp_eq_u32 s54, 0
    s_cbranch_scc1 L_gnd_45
    v_mfma_f32_32x32x16_bf16 v[128:143], v[120:123], v[112:115], v[128:143]
    ds_read_b128 v[80:83], v15 offset:0
    ds_read_b128 v[84:87], v15 offset:4096
    s_add_u32 s60, s49, 0
    s_add_u32 s61, s53, s64
    s_add_u32 m0, s61, 0
    s_nop 0
    buffer_load_dwordx4 v20, s[32:35], s60 offen sc1 lds
    s_add_u32 s60, s49, 28672
    s_add_u32 s61, s53, s64
    s_add_u32 m0, s61, 1024
    s_nop 0
    buffer_load_dwordx4 v21, s[32:35], s60 offen sc1 lds
    v_mfma_f32_32x32x16_bf16 v[144:159], v[124:127], v[112:115], v[144:159]
    ds_read_b64_tr_b16 v[88:89], v18 offset:2048
    ds_read_b64_tr_b16 v[90:91], v18 offset:3072
    s_add_u32 s60, s49, 57344
    s_add_u32 s61, s53, s64
    s_add_u32 m0, s61, 2048
    s_nop 0
    buffer_load_dwordx4 v20, s[32:35], s60 offen sc1 lds
    s_add_u32 s60, s49, 86016
    s_add_u32 s61, s53, s64
    s_add_u32 m0, s61, 3072
    s_nop 0
    buffer_load_dwordx4 v21, s[32:35], s60 offen sc1 lds
    v_mfma_f32_32x32x16_bf16 v[160:175], v[120:123], v[116:119], v[160:175]
    ds_read_b64_tr_b16 v[92:93], v19 offset:2048
    ds_read_b64_tr_b16 v[94:95], v19 offset:3072
    s_add_u32 s60, s50, 0
    s_add_u32 s61, s53, s65
    s_add_u32 m0, s61, 0
    s_nop 0
    buffer_load_dwordx4 v22, s[36:39], s60 offen lds
    s_add_u32 s60, s50, 8192
    s_add_u32 s61, s53, s65
    s_add_u32 m0, s61, 1024
    s_nop 0
    buffer_load_dwordx4 v22, s[36:39], s60 offen lds
    v_mfma_f32_32x32x16_bf16 v[176:191], v[124:127], v[116:119], v[176:191]
    s_add_u32 s60, s50, 16384
    s_add_u32 s61, s53, s65
    s_add_u32 m0, s61, 2048
    s_nop 0
    buffer_load_dwordx4 v22, s[36:39], s60 offen lds
    s_add_u32 s60, s50, 24576
    s_add_u32 s61, s53, s65
    s_add_u32 m0, s61, 3072
    s_nop 0
    buffer_load_dwordx4 v22, s[36:39], s60 offen lds
    s_add_u32 s49, s49, 128
    s_add_u32 s50, s50, 65536
    s_add_u32 s53, s53, 32768
    s_and_b32 s53, s53, 0x1ffff
    s_sub_u32 s54, s54, 1
    s_branch L_gj_46
L_gnd_45:
    v_mfma_f32_32x32x16_bf16 v[128:143], v[120:123], v[112:115], v[128:143]
    ds_read_b128 v[80:83], v15 offset:0
    ds_read_b128 v[84:87], v15 offset:4096
    v_mfma_f32_32x32x16_bf16 v[144:159], v[124:127], v[112:115], v[144:159]
    ds_read_b64_tr_b16 v[88:89], v18 offset:2048
    ds_read_b64_tr_b16 v[90:91], v18 offset:3072
    v_mfma_f32_32x32x16_bf16 v[160:175], v[120:123], v[116:119], v[160:175]
    ds_read_b64_tr_b16 v[92:93], v19 offset:2048
    ds_read_b64_tr_b16 v[94:95], v19 offset:3072
    v_mfma_f32_32x32x16_bf16 v[176:191], v[124:127], v[116:119], v[176:191]
L_gj_46:
    s_sub_u32 s51, s51, 1
    s_cmp_gt_u32 s51, 0
    s_cbranch_scc1 L_gk_42
    s_waitcnt lgkmcnt(0)
    s_nop 15
    s_barrier
    s_lshl_b32 s59, s55, 2
    s_add_u32 s59, s59, s56
    s_lshl_b32 s59, s59, 16
    s_add_u32 s59, s59, 94371840
    v_lshlrev_b32 v24, 4, v1
    s_lshl_b32 s60, s3, 14
    s_add_u32 s60, s60, s59
    s_mov_b32 s66, 0xbfb8aa3b
    v_mul_f32 v26, s66, v128
    v_exp_f32 v26, v26
    s_nop 0
    v_add_f32 v26, 1.0, v26
    v_rcp_f32 v26, v26
    s_nop 0
    v_mul_f32 v128, v128, v26
    v_mul_f32 v27, s66, v129
    v_exp_f32 v27, v27
    s_nop 0
    v_add_f32 v27, 1.0, v27
    v_rcp_f32 v27, v27
    s_nop 0
    v_mul_f32 v129, v129, v27
    v_mul_f32 v26, s66, v130
    v_exp_f32 v26, v26
    s_nop 0
    v_add_f32 v26, 1.0, v26
    v_rcp_f32 v26, v26
    s_nop 0
    v_mul_f32 v130, v130, v26
    v_mul_f32 v27, s66, v131
    v_exp_f32 v27, v27
    s_nop 0
    v_add_f32 v27, 1.0, v27
    v_rcp_f32 v27, v27
    s_nop 0
    v_mul_f32 v131, v131, v27
    v_mul_f32 v26, s66, v132
    v_exp_f32 v26, v26
    s_nop 0
    v_add_f32 v26, 1.0, v26
    v_rcp_f32 v26, v26
    s_nop 0
    v_mul_f32 v132, v132, v26
    v_mul_f32 v27, s66, v133
    v_exp_f32 v27, v27
    s_nop 0
    v_add_f32 v27, 1.0, v27
    v_rcp_f32 v27, v27
    s_nop 0
    v_mul_f32 v133, v133, v27
    v_mul_f32 v26, s66, v134
    v_exp_f32 v26, v26
    s_nop 0
    v_add_f32 v26, 1.0, v26
    v_rcp_f32 v26, v26
    s_nop 0
    v_mul_f32 v134, v134, v26
    v_mul_f32 v27, s66, v135
    v_exp_f32 v27, v27
    s_nop 0
    v_add_f32 v27, 1.0, v27
    v_rcp_f32 v27, v27
    s_nop 0
    v_mul_f32 v135, v135, v27
    v_mul_f32 v26, s66, v136
    v_exp_f32 v26, v26
    s_nop 0
    v_add_f32 v26, 1.0, v26
    v_rcp_f32 v26, v26
    s_nop 0
    v_mul_f32 v136, v136, v26
    v_mul_f32 v27, s66, v137
    v_exp_f32 v27, v27
    s_nop 0
    v_add_f32 v27, 1.0, v27
    v_rcp_f32 v27, v27
    s_nop 0
    v_mul_f32 v137, v137, v27
    v_mul_f32 v26, s66, v138
    v_exp_f32 v26, v26
    s_nop 0
    v_add_f32 v26, 1.0, v26
    v_rcp_f32 v26, v26
    s_nop 0
    v_mul_f32 v138, v138, v26
    v_mul_f32 v27, s66, v139
    v_exp_f32 v27, v27
    s_nop 0
    v_add_f32 v27, 1.0, v27
    v_rcp_f32 v27, v27
    s_nop 0
    v_mul_f32 v139, v139, v27
    v_mul_f32 v26, s66, v140
    v_exp_f32 v26, v26
    s_nop 0
    v_add_f32 v26, 1.0, v26
    v_rcp_f32 v26, v26
    s_nop 0
    v_mul_f32 v140, v140, v26
    v_mul_f32 v27, s66, v141
    v_exp_f32 v27, v27
    s_nop 0
    v_add_f32 v27, 1.0, v27
    v_rcp_f32 v27, v27
    s_nop 0
    v_mul_f32 v141, v141, v27
    v_mul_f32 v26, s66, v142
    v_exp_f32 v26, v26
    s_nop 0
    v_add_f32 v26, 1.0, v26
    v_rcp_f32 v26, v26
    s_nop 0
    v_mul_f32 v142, v142, v26
    v_mul_f32 v27, s66, v143
    v_exp_f32 v27, v27
    s_nop 0
    v_add_f32 v27, 1.0, v27
    v_rcp_f32 v27, v27
    s_nop 0
    v_mul_f32 v143, v143, v27
    s_add_u32 s61, s60, 0
    buffer_store_dwordx4 v[128:131], v24, s[32:35], s61 offen sc1
    s_add_u32 s61, s60, 1024
    buffer_store_dwordx4 v[132:135], v24, s[32:35], s61 offen sc1
    s_add_u32 s61, s60, 2048
    buffer_store_dwordx4 v[136:139], v24, s[32:35], s61 offen sc1
    s_add_u32 s61, s60, 3072
    buffer_store_dwordx4 v[140:143], v24, s[32:35], s61 offen sc1
    v_mul_f32 v26, s66, v144
    v_exp_f32 v26, v26
    s_nop 0
    v_add_f32 v26, 1.0, v26
    v_rcp_f32 v26, v26
    s_nop 0
    v_mul_f32 v144, v144, v26
    v_mul_f32 v27, s66, v145
    v_exp_f32 v27, v27
    s_nop 0
    v_add_f32 v27, 1.0, v27
    v_rcp_f32 v27, v27
    s_nop 0
    v_mul_f32 v145, v145, v27
    v_mul_f32 v26, s66, v146
    v_exp_f32 v26, v26
    s_nop 0
    v_add_f32 v26, 1.0, v26
    v_rcp_f32 v26, v26
    s_nop 0
    v_mul_f32 v146, v146, v26
    v_mul_f32 v27, s66, v147
    v_exp_f32 v27, v27
    s_nop 0
    v_add_f32 v27, 1.0, v27
    v_rcp_f32 v27, v27
    s_nop 0
    v_mul_f32 v147, v147, v27
    v_mul_f32 v26, s66, v148
    v_exp_f32 v26, v26
    s_nop 0
    v_add_f32 v26, 1.0, v26
    v_rcp_f32 v26, v26
    s_nop 0
    v_mul_f32 v148, v148, v26
    v_mul_f32 v27, s66, v149
    v_exp_f32 v27, v27
    s_nop 0
    v_add_f32 v27, 1.0, v27
    v_rcp_f32 v27, v27
    s_nop 0
    v_mul_f32 v149, v149, v27
    v_mul_f32 v26, s66, v150
    v_exp_f32 v26, v26
    s_nop 0
    v_add_f32 v26, 1.0, v26
    v_rcp_f32 v26, v26
    s_nop 0
    v_mul_f32 v150, v150, v26
    v_mul_f32 v27, s66, v151
    v_exp_f32 v27, v27
    s_nop 0
    v_add_f32 v27, 1.0, v27
    v_rcp_f32 v27, v27
    s_nop 0
    v_mul_f32 v151, v151, v27
    v_mul_f32 v26, s66, v152
    v_exp_f32 v26, v26
    s_nop 0
    v_add_f32 v26, 1.0, v26
    v_rcp_f32 v26, v26
    s_nop 0
    v_mul_f32 v152, v152, v26
    v_mul_f32 v27, s66, v153
    v_exp_f32 v27, v27
    s_nop 0
    v_add_f32 v27, 1.0, v27
    v_rcp_f32 v27, v27
    s_nop 0
    v_mul_f32 v153, v153, v27
    v_mul_f32 v26, s66, v154
    v_exp_f32 v26, v26
    s_nop 0
    v_add_f32 v26, 1.0, v26
    v_rcp_f32 v26, v26
    s_nop 0
    v_mul_f32 v154, v154, v26
    v_mul_f32 v27, s66, v155
    v_exp_f32 v27, v27
    s_nop 0
    v_add_f32 v27, 1.0, v27
    v_rcp_f32 v27, v27
    s_nop 0
    v_mul_f32 v155, v155, v27
    v_mul_f32 v26, s66, v156
    v_exp_f32 v26, v26
    s_nop 0
    v_add_f32 v26, 1.0, v26
    v_rcp_f32 v26, v26
    s_nop 0
    v_mul_f32 v156, v156, v26
    v_mul_f32 v27, s66, v157
    v_exp_f32 v27, v27
    s_nop 0
    v_add_f32 v27, 1.0, v27
    v_rcp_f32 v27, v27
    s_nop 0
    v_mul_f32 v157, v157, v27
    v_mul_f32 v26, s66, v158
    v_exp_f32 v26, v26
    s_nop 0
    v_add_f32 v26, 1.0, v26
    v_rcp_f32 v26, v26
    s_nop 0
    v_mul_f32 v158, v158, v26
    v_mul_f32 v27, s66, v159
    v_exp_f32 v27, v27
    s_nop 0
    v_add_f32 v27, 1.0, v27
    v_rcp_f32 v27, v27
    s_nop 0
    v_mul_f32 v159, v159, v27
    s_add_u32 s61, s60, 4096
    buffer_store_dwordx4 v[144:147], v24, s[32:35], s61 offen sc1
    s_add_u32 s61, s60, 5120
    buffer_store_dwordx4 v[148:151], v24, s[32:35], s61 offen sc1
    s_add_u32 s61, s60, 6144
    buffer_store_dwordx4 v[152:155], v24, s[32:35], s61 offen sc1
    s_add_u32 s61, s60, 7168
    buffer_store_dwordx4 v[156:159], v24, s[32:35], s61 offen sc1
    v_mul_f32 v26, s66, v160
    v_exp_f32 v26, v26
    s_nop 0
    v_add_f32 v26, 1.0, v26
    v_rcp_f32 v26, v26
    s_nop 0
    v_mul_f32 v160, v160, v26
    v_mul_f32 v27, s66, v161
    v_exp_f32 v27, v27
    s_nop 0
    v_add_f32 v27, 1.0, v27
    v_rcp_f32 v27, v27
    s_nop 0
    v_mul_f32 v161, v161, v27
    v_mul_f32 v26, s66, v162
    v_exp_f32 v26, v26
    s_nop 0
    v_add_f32 v26, 1.0, v26
    v_rcp_f32 v26, v26
    s_nop 0
    v_mul_f32 v162, v162, v26
    v_mul_f32 v27, s66, v163
    v_exp_f32 v27, v27
    s_nop 0
    v_add_f32 v27, 1.0, v27
    v_rcp_f32 v27, v27
    s_nop 0
    v_mul_f32 v163, v163, v27
    v_mul_f32 v26, s66, v164
    v_exp_f32 v26, v26
    s_nop 0
    v_add_f32 v26, 1.0, v26
    v_rcp_f32 v26, v26
    s_nop 0
    v_mul_f32 v164, v164, v26
    v_mul_f32 v27, s66, v165
    v_exp_f32 v27, v27
    s_nop 0
    v_add_f32 v27, 1.0, v27
    v_rcp_f32 v27, v27
    s_nop 0
    v_mul_f32 v165, v165, v27
    v_mul_f32 v26, s66, v166
    v_exp_f32 v26, v26
    s_nop 0
    v_add_f32 v26, 1.0, v26
    v_rcp_f32 v26, v26
    s_nop 0
    v_mul_f32 v166, v166, v26
    v_mul_f32 v27, s66, v167
    v_exp_f32 v27, v27
    s_nop 0
    v_add_f32 v27, 1.0, v27
    v_rcp_f32 v27, v27
    s_nop 0
    v_mul_f32 v167, v167, v27
    v_mul_f32 v26, s66, v168
    v_exp_f32 v26, v26
    s_nop 0
    v_add_f32 v26, 1.0, v26
    v_rcp_f32 v26, v26
    s_nop 0
    v_mul_f32 v168, v168, v26
    v_mul_f32 v27, s66, v169
    v_exp_f32 v27, v27
    s_nop 0
    v_add_f32 v27, 1.0, v27
    v_rcp_f32 v27, v27
    s_nop 0
    v_mul_f32 v169, v169, v27
    v_mul_f32 v26, s66, v170
    v_exp_f32 v26, v26
    s_nop 0
    v_add_f32 v26, 1.0, v26
    v_rcp_f32 v26, v26
    s_nop 0
    v_mul_f32 v170, v170, v26
    v_mul_f32 v27, s66, v171
    v_exp_f32 v27, v27
    s_nop 0
    v_add_f32 v27, 1.0, v27
    v_rcp_f32 v27, v27
    s_nop 0
    v_mul_f32 v171, v171, v27
    v_mul_f32 v26, s66, v172
    v_exp_f32 v26, v26
    s_nop 0
    v_add_f32 v26, 1.0, v26
    v_rcp_f32 v26, v26
    s_nop 0
    v_mul_f32 v172, v172, v26
    v_mul_f32 v27, s66, v173
    v_exp_f32 v27, v27
    s_nop 0
    v_add_f32 v27, 1.0, v27
    v_rcp_f32 v27, v27
    s_nop 0
    v_mul_f32 v173, v173, v27
    v_mul_f32 v26, s66, v174
    v_exp_f32 v26, v26
    s_nop 0
    v_add_f32 v26, 1.0, v26
    v_rcp_f32 v26, v26
    s_nop 0
    v_mul_f32 v174, v174, v26
    v_mul_f32 v27, s66, v175
    v_exp_f32 v27, v27
    s_nop 0
    v_add_f32 v27, 1.0, v27
    v_rcp_f32 v27, v27
    s_nop 0
    v_mul_f32 v175, v175, v27
    s_add_u32 s61, s60, 8192
    buffer_store_dwordx4 v[160:163], v24, s[32:35], s61 offen sc1
    s_add_u32 s61, s60, 9216
    buffer_store_dwordx4 v[164:167], v24, s[32:35], s61 offen sc1
    s_add_u32 s61, s60, 10240
    buffer_store_dwordx4 v[168:171], v24, s[32:35], s61 offen sc1
    s_add_u32 s61, s60, 11264
    buffer_store_dwordx4 v[172:175], v24, s[32:35], s61 offen sc1
    v_mul_f32 v26, s66, v176
    v_exp_f32 v26, v26
    s_nop 0
    v_add_f32 v26, 1.0, v26
    v_rcp_f32 v26, v26
    s_nop 0
    v_mul_f32 v176, v176, v26
    v_mul_f32 v27, s66, v177
    v_exp_f32 v27, v27
    s_nop 0
    v_add_f32 v27, 1.0, v27
    v_rcp_f32 v27, v27
    s_nop 0
    v_mul_f32 v177, v177, v27
    v_mul_f32 v26, s66, v178
    v_exp_f32 v26, v26
    s_nop 0
    v_add_f32 v26, 1.0, v26
    v_rcp_f32 v26, v26
    s_nop 0
    v_mul_f32 v178, v178, v26
    v_mul_f32 v27, s66, v179
    v_exp_f32 v27, v27
    s_nop 0
    v_add_f32 v27, 1.0, v27
    v_rcp_f32 v27, v27
    s_nop 0
    v_mul_f32 v179, v179, v27
    v_mul_f32 v26, s66, v180
    v_exp_f32 v26, v26
    s_nop 0
    v_add_f32 v26, 1.0, v26
    v_rcp_f32 v26, v26
    s_nop 0
    v_mul_f32 v180, v180, v26
    v_mul_f32 v27, s66, v181
    v_exp_f32 v27, v27
    s_nop 0
    v_add_f32 v27, 1.0, v27
    v_rcp_f32 v27, v27
    s_nop 0
    v_mul_f32 v181, v181, v27
    v_mul_f32 v26, s66, v182
    v_exp_f32 v26, v26
    s_nop 0
    v_add_f32 v26, 1.0, v26
    v_rcp_f32 v26, v26
    s_nop 0
    v_mul_f32 v182, v182, v26
    v_mul_f32 v27, s66, v183
    v_exp_f32 v27, v27
    s_nop 0
    v_add_f32 v27, 1.0, v27
    v_rcp_f32 v27, v27
    s_nop 0
    v_mul_f32 v183, v183, v27
    v_mul_f32 v26, s66, v184
    v_exp_f32 v26, v26
    s_nop 0
    v_add_f32 v26, 1.0, v26
    v_rcp_f32 v26, v26
    s_nop 0
    v_mul_f32 v184, v184, v26
    v_mul_f32 v27, s66, v185
    v_exp_f32 v27, v27
    s_nop 0
    v_add_f32 v27, 1.0, v27
    v_rcp_f32 v27, v27
    s_nop 0
    v_mul_f32 v185, v185, v27
    v_mul_f32 v26, s66, v186
    v_exp_f32 v26, v26
    s_nop 0
    v_add_f32 v26, 1.0, v26
    v_rcp_f32 v26, v26
    s_nop 0
    v_mul_f32 v186, v186, v26
    v_mul_f32 v27, s66, v187
    v_exp_f32 v27, v27
    s_nop 0
    v_add_f32 v27, 1.0, v27
    v_rcp_f32 v27, v27
    s_nop 0
    v_mul_f32 v187, v187, v27
    v_mul_f32 v26, s66, v188
    v_exp_f32 v26, v26
    s_nop 0
    v_add_f32 v26, 1.0, v26
    v_rcp_f32 v26, v26
    s_nop 0
    v_mul_f32 v188, v188, v26
    v_mul_f32 v27, s66, v189
    v_exp_f32 v27, v27
    s_nop 0
    v_add_f32 v27, 1.0, v27
    v_rcp_f32 v27, v27
    s_nop 0
    v_mul_f32 v189, v189, v27
    v_mul_f32 v26, s66, v190
    v_exp_f32 v26, v26
    s_nop 0
    v_add_f32 v26, 1.0, v26
    v_rcp_f32 v26, v26
    s_nop 0
    v_mul_f32 v190, v190, v26
    v_mul_f32 v27, s66, v191
    v_exp_f32 v27, v27
    s_nop 0
    v_add_f32 v27, 1.0, v27
    v_rcp_f32 v27, v27
    s_nop 0
    v_mul_f32 v191, v191, v27
    s_add_u32 s61, s60, 12288
    buffer_store_dwordx4 v[176:179], v24, s[32:35], s61 offen sc1
    s_add_u32 s61, s60, 13312
    buffer_store_dwordx4 v[180:183], v24, s[32:35], s61 offen sc1
    s_add_u32 s61, s60, 14336
    buffer_store_dwordx4 v[184:187], v24, s[32:35], s61 offen sc1
    s_add_u32 s61, s60, 15360
    buffer_store_dwordx4 v[188:191], v24, s[32:35], s61 offen sc1
    s_waitcnt vmcnt(0)
    s_barrier
    s_cmp_lg_u32 s3, 0
    s_cbranch_scc1 L_sg_47
    s_lshl_b32 s60, s55, 7
    s_add_u32 s60, s60, 133177344
    v_mov_b32 v8, 1
    s_mov_b64 exec, 1
    buffer_atomic_add v8, off, s[32:35], s60 sc1
    s_mov_b64 exec, -1
L_sg_47:
L_d_done:
    s_sub_u32 s60, s96, 2
    s_cmp_ge_u32 s60, 4
    s_cbranch_scc1 L_nobload
    s_and_b32 s60, s60, 1
    s_lshl_b32 s60, s60, 5
    s_add_u32 s60, s60, s97
    s_and_b32 s98, s60, 7
    s_lshr_b32 s99, s60, 3
    s_mov_b32 s36, s14
    s_and_b32 s37, s15, 0xffff
    s_mov_b32 s38, 4194304
    s_mov_b32 s39, 0x20000
    s_lshr_b32 s60, s3, 1
    s_and_b32 s61, s3, 1
    v_and_b32 v18, 31, v1
    s_lshl_b32 s62, s60, 5
    v_add_u32 v18, s62, v18
    v_bfe_u32 v19, v18, 1, 3
    v_lshrrev_b32 v20, 5, v1
    v_lshlrev_b32 v18, 7, v18
    v_add_u32 v21, 0, v20
    v_xor_b32 v21, v21, v19
    v_lshl_add_u32 v112, v21, 4, v18
    v_add_u32 v112, 65536, v112
    v_add_u32 v21, 2, v20
    v_xor_b32 v21, v21, v19
    v_lshl_add_u32 v113, v21, 4, v18
    v_add_u32 v113, 65536, v113
    v_add_u32 v21, 4, v20
    v_xor_b32 v21, v21, v19
    v_lshl_add_u32 v114, v21, 4, v18
    v_add_u32 v114, 65536, v114
    v_add_u32 v21, 6, v20
    v_xor_b32 v21, v21, v19
    v_lshl_add_u32 v115, v21, 4, v18
    v_add_u32 v115, 65536, v115
    v_bfe_u32 v18, v1, 2, 2
    v_lshrrev_b32 v19, 5, v1
    v_lshl_add_u32 v19, v19, 2, v18
    v_lshlrev_b32 v19, 7, v19
    v_lshrrev_b32 v18, 1, v18
    v_lshlrev_b32 v18, 2, v18
    v_bfe_u32 v20, v1, 4, 1
    v_lshlrev_b32 v20, 1, v20
    v_bfe_u32 v21, v1, 1, 1
    v_add_u32 v20, v20, v21
    s_lshl_b32 s62, s61, 2
    v_add_u32 v20, s62, v20
    v_xor_b32 v20, v20, v18
    v_and_b32 v21, 1, v1
    v_lshlrev_b32 v21, 3, v21
    v_add_u32 v19, v19, v21
    v_lshl_add_u32 v116, v20, 4, v19
    v_lshrrev_b32 v18, 3, v1
    v_and_b32 v19, 7, v1
    v_lshrrev_b32 v20, 4, v1
    v_lshlrev_b32 v21, 13, v18
    v_xor_b32 v22, v19, v20
    v_lshl_add_u32 v118, v22, 4, v21
    v_add_u32 v22, 4, v20
    v_xor_b32 v22, v19, v22
    v_lshl_add_u32 v119, v22, 4, v21
    v_lshlrev_b32 v21, 10, v18
    v_bfe_u32 v20, v1, 4, 1
    v_lshlrev_b32 v20, 2, v20
    v_xor_b32 v19, v19, v20
    v_lshl_add_u32 v120, v19, 4, v21
    s_lshl_b32 s60, s99, 19
    s_lshl_b32 s61, s98, 7
    s_add_u32 s60, s60, s61
    s_lshl_b32 s61, s3, 17
    s_add_u32 s60, s60, s61
    s_lshl_b32 s61, s3, 14
    s_add_u32 s62, s60, 0
    s_add_u32 m0, s61, 0
    s_nop 0
    buffer_load_dwordx4 v120, s[36:39], s62 offen lds
    s_add_u32 s62, s60, 8192
    s_add_u32 m0, s61, 1024
    s_nop 0
    buffer_load_dwordx4 v120, s[36:39], s62 offen lds
    s_add_u32 s62, s60, 16384
    s_add_u32 m0, s61, 2048
    s_nop 0
    buffer_load_dwordx4 v120, s[36:39], s62 offen lds
    s_add_u32 s62, s60, 24576
    s_add_u32 m0, s61, 3072
    s_nop 0
    buffer_load_dwordx4 v120, s[36:39], s62 offen lds
    s_add_u32 s62, s60, 32768
    s_add_u32 m0, s61, 4096
    s_nop 0
    buffer_load_dwordx4 v120, s[36:39], s62 offen lds
    s_add_u32 s62, s60, 40960
    s_add_u32 m0, s61, 5120
    s_nop 0
    buffer_load_dwordx4 v120, s[36:39], s62 offen lds
    s_add_u32 s62, s60, 49152
    s_add_u32 m0, s61, 6144
    s_nop 0
    buffer_load_dwordx4 v120, s[36:39], s62 offen lds
    s_add_u32 s62, s60, 57344
    s_add_u32 m0, s61, 7168
    s_nop 0
    buffer_load_dwordx4 v120, s[36:39], s62 offen lds
    s_add_u32 s62, s60, 65536
    s_add_u32 m0, s61, 8192
    s_nop 0
    buffer_load_dwordx4 v120, s[36:39], s62 offen lds
    s_add_u32 s62, s60, 73728
    s_add_u32 m0, s61, 9216
    s_nop 0
    buffer_load_dwordx4 v120, s[36:39], s62 offen lds
    s_add_u32 s62, s60, 81920
    s_add_u32 m0, s61, 10240
    s_nop 0
    buffer_load_dwordx4 v120, s[36:39], s62 offen lds
    s_add_u32 s62, s60, 90112
    s_add_u32 m0, s61, 11264
    s_nop 0
    buffer_load_dwordx4 v120, s[36:39], s62 offen lds
    s_add_u32 s62, s60, 98304
    s_add_u32 m0, s61, 12288
    s_nop 0
    buffer_load_dwordx4 v120, s[36:39], s62 offen lds
    s_add_u32 s62, s60, 106496
    s_add_u32 m0, s61, 13312
    s_nop 0
    buffer_load_dwordx4 v120, s[36:39], s62 offen lds
    s_add_u32 s62, s60, 114688
    s_add_u32 m0, s61, 14336
    s_nop 0
    buffer_load_dwordx4 v120, s[36:39], s62 offen lds
    s_add_u32 s62, s60, 122880
    s_add_u32 m0, s61, 15360
    s_nop 0
    buffer_load_dwordx4 v120, s[36:39], s62 offen lds
    s_waitcnt vmcnt(0)
    s_barrier
L_nobload:
    s_mov_b32 s100, 0
L_rb_loop:
    s_mov_b32 s55, s100
    s_and_b32 s60, s100, 1
    s_cmp_lg_u32 s60, s96
    s_cbranch_scc1 L_rb_noat
    s_mov_b32 s56, s97
    s_bitcmp1_b32 s87, s55
    s_cbranch_scc1 L_wf_48
    v_lshlrev_b32 v8, 7, v1
    s_mov_b32 s60, 133171200
L_wfl_49:
    s_mov_b64 exec, 0xffff
    buffer_load_dword v9, v8, s[32:35], s60 offen sc1
    s_waitcnt vmcnt(0)
    v_cmp_le_u32 vcc, 64, v9
    s_mov_b64 exec, -1
    s_mov_b32 s87, vcc_lo
    s_add_u32 s94, s94, 1
    s_cmp_gt_u32 s94, 3000000
    s_cbranch_scc1 L_exit
    s_bitcmp1_b32 s87, s55
    s_cbranch_scc1 L_wf_48
    s_sleep 8
    s_branch L_wfl_49
L_wf_48:
    s_bitcmp1_b32 s88, s55
    s_cbranch_scc1 L_wf_50
    v_lshlrev_b32 v8, 7, v1
    s_mov_b32 s60, 133173248
L_wfl_51:
    s_mov_b64 exec, 0xffff
    buffer_load_dword v9, v8, s[32:35], s60 offen sc1
    s_waitcnt vmcnt(0)
    v_cmp_le_u32 vcc, 32, v9
    s_mov_b64 exec, -1
    s_mov_b32 s88, vcc_lo
    s_add_u32 s94, s94, 1
    s_cmp_gt_u32 s94, 3000000
    s_cbranch_scc1 L_exit
    s_bitcmp1_b32 s88, s55
    s_cbranch_scc1 L_wf_50
    s_sleep 8
    s_branch L_wfl_51
L_wf_50:
    v_lshlrev_b32 v2, 4, v1
    s_lshl_b32 s60, s55, 2
    s_add_u32 s60, s60, s3
    s_lshl_b32 s61, s60, 5
    s_add_u32 s61, s61, s56
    s_lshl_b32 s62, s61, 13
    s_lshl_b32 s63, s61, 12
    s_add_u32 s64, s62, 18874368
    buffer_load_dwordx4 v[8:11], v2, s[32:35], s64 offen offset:0 sc1
    buffer_load_dwordx4 v[12:15], v2, s[32:35], s64 offen offset:1024 sc1
    buffer_load_dwordx4 v[16:19], v2, s[32:35], s64 offen offset:2048 sc1
    buffer_load_dwordx4 v[20:23], v2, s[32:35], s64 offen offset:3072 sc1
    s_add_u32 s64, s62, 18878464
    buffer_load_dwordx4 v[24:27], v2, s[32:35], s64 offen offset:0 sc1
    buffer_load_dwordx4 v[28:31], v2, s[32:35], s64 offen offset:1024 sc1
    buffer_load_dwordx4 v[32:35], v2, s[32:35], s64 offen offset:2048 sc1
    buffer_load_dwordx4 v[36:39], v2, s[32:35], s64 offen offset:3072 sc1
    s_add_u32 s64, s62, 2097152
    buffer_load_dwordx4 v[40:43], v2, s[32:35], s64 offen offset:0 sc1
    buffer_load_dwordx4 v[44:47], v2, s[32:35], s64 offen offset:1024 sc1
    buffer_load_dwordx4 v[48:51], v2, s[32:35], s64 offen offset:2048 sc1
    buffer_load_dwordx4 v[52:55], v2, s[32:35], s64 offen offset:3072 sc1
    s_add_u32 s64, s62, 2101248
    buffer_load_dwordx4 v[56:59], v2, s[32:35], s64 offen offset:0 sc1
    buffer_load_dwordx4 v[60:63], v2, s[32:35], s64 offen offset:1024 sc1
    buffer_load_dwordx4 v[64:67], v2, s[32:35], s64 offen offset:2048 sc1
    buffer_load_dwordx4 v[68:71], v2, s[32:35], s64 offen offset:3072 sc1
    s_add_u32 s64, s62, 35651584
    buffer_load_dwordx4 v[88:91], v2, s[32:35], s64 offen offset:0 sc1
    buffer_load_dwordx4 v[92:95], v2, s[32:35], s64 offen offset:1024 sc1
    buffer_load_dwordx4 v[96:99], v2, s[32:35], s64 offen offset:2048 sc1
    buffer_load_dwordx4 v[100:103], v2, s[32:35], s64 offen offset:3072 sc1
    s_add_u32 s64, s62, 35655680
    buffer_load_dwordx4 v[104:107], v2, s[32:35], s64 offen offset:0 sc1
    buffer_load_dwordx4 v[108:111], v2, s[32:35], s64 offen offset:1024 sc1
    buffer_load_dwordx4 v[112:115], v2, s[32:35], s64 offen offset:2048 sc1
    buffer_load_dwordx4 v[116:119], v2, s[32:35], s64 offen offset:3072 sc1
    s_mov_b32 s65, s60
    s_mov_b32 s76, s63
    s_lshl_b32 s60, s55, 5
    s_add_u32 s60, s60, s56
    s_lshl_b32 s60, s60, 7
    s_add_u32 s60, s60, 133300224
    s_cmp_lg_u32 s3, 0
    s_cbranch_scc1 L_w1_52
    s_mov_b64 exec, 1
L_w1l_53:
    buffer_load_dword v7, off, s[32:35], s60 sc1
    s_waitcnt vmcnt(0)
    v_readfirstlane_b32 s61, v7
    s_add_u32 s94, s94, 1
    s_cmp_gt_u32 s94, 3000000
    s_cbranch_scc1 L_exit
    s_cmp_ge_u32 s61, 1
    s_cbranch_scc1 L_w1k_54
    s_sleep 1
    s_branch L_w1l_53
L_w1k_54:
    s_mov_b64 exec, -1
L_w1_52:
    s_barrier
    s_mov_b32 s60, s65
    s_add_u32 s64, s76, 52428800
    buffer_load_dwordx4 v[72:75], v2, s[32:35], s64 offen offset:0 sc1
    buffer_load_dwordx4 v[76:79], v2, s[32:35], s64 offen offset:1024 sc1
    buffer_load_dwordx4 v[80:83], v2, s[32:35], s64 offen offset:2048 sc1
    buffer_load_dwordx4 v[84:87], v2, s[32:35], s64 offen offset:3072 sc1
    s_add_u32 s64, s76, 60817408
    buffer_load_dwordx4 v[120:123], v2, s[32:35], s64 offen offset:0 sc1
    buffer_load_dwordx4 v[124:127], v2, s[32:35], s64 offen offset:1024 sc1
    buffer_load_dwordx4 v[128:131], v2, s[32:35], s64 offen offset:2048 sc1
    buffer_load_dwordx4 v[132:135], v2, s[32:35], s64 offen offset:3072 sc1
    v_and_b32 v3, 15, v1
    v_lshrrev_b32 v4, 4, v1
    v_lshlrev_b32 v4, 2, v4
    v_sub_u32 v3, v3, v4
    v_cmp_le_i32 s[68:69], 0, v3
    v_cmp_le_i32 s[70:71], 1, v3
    v_cmp_le_i32 s[72:73], 2, v3
    v_cmp_le_i32 s[74:75], 3, v3
    s_mov_b32 s66, 0x3e0293ee
    s_mov_b32 s67, 0xff800000
    s_waitcnt vmcnt(4)
    v_mfma_f32_16x16x32_bf16 v[136:139], v[72:75], v[8:11], 0
    v_mfma_f32_16x16x32_bf16 v[136:139], v[76:79], v[12:15], v[136:139]
    v_mfma_f32_16x16x32_bf16 v[136:139], v[80:83], v[16:19], v[136:139]
    v_mfma_f32_16x16x32_bf16 v[136:139], v[84:87], v[20:23], v[136:139]
    v_mfma_f32_16x16x32_bf16 v[140:143], v[40:43], v[8:11], 0
    v_mfma_f32_16x16x32_bf16 v[140:143], v[44:47], v[12:15], v[140:143]
    v_mfma_f32_16x16x32_bf16 v[140:143], v[48:51], v[16:19], v[140:143]
    v_mfma_f32_16x16x32_bf16 v[140:143], v[52:55], v[20:23], v[140:143]
    v_mfma_f32_16x16x32_bf16 v[148:151], v[72:75], v[24:27], 0
    v_mfma_f32_16x16x32_bf16 v[148:151], v[76:79], v[28:31], v[148:151]
    v_mfma_f32_16x16x32_bf16 v[148:151], v[80:83], v[32:35], v[148:151]
    v_mfma_f32_16x16x32_bf16 v[148:151], v[84:87], v[36:39], v[148:151]
    v_mfma_f32_16x16x32_bf16 v[152:155], v[40:43], v[24:27], 0
    v_mfma_f32_16x16x32_bf16 v[152:155], v[44:47], v[28:31], v[152:155]
    v_mfma_f32_16x16x32_bf16 v[152:155], v[48:51], v[32:35], v[152:155]
    v_mfma_f32_16x16x32_bf16 v[152:155], v[52:55], v[36:39], v[152:155]
    v_mfma_f32_16x16x32_bf16 v[156:159], v[56:59], v[24:27], 0
    v_mfma_f32_16x16x32_bf16 v[156:159], v[60:63], v[28:31], v[156:159]
    v_mfma_f32_16x16x32_bf16 v[156:159], v[64:67], v[32:35], v[156:159]
    v_mfma_f32_16x16x32_bf16 v[156:159], v[68:71], v[36:39], v[156:159]
    v_mov_b32 v5, s67
    v_cndmask_b32 v140, v5, v140, s[68:69]
    v_mov_b32 v5, s67
    v_cndmask_b32 v141, v5, v141, s[70:71]
    v_mov_b32 v5, s67
    v_cndmask_b32 v142, v5, v142, s[72:73]
    v_mov_b32 v5, s67
    v_cndmask_b32 v143, v5, v143, s[74:75]
    v_max3_f32 v5, v140, v141, v142
    v_max3_f32 v5, v5, v143, v136
    v_max_f32 v5, v5, v137
    v_mov_b32 v6, v5
    s_nop 1
    v_permlane16_swap_b32 v5, v6
    v_max_f32 v5, v5, v6
    v_mov_b32 v6, v5
    s_nop 1
    v_permlane32_swap_b32 v5, v6
    v_max_f32 v5, v5, v6
    v_mul_f32 v5, s66, v5
    v_fma_f32 v140, v140, s66, -v5
    v_fma_f32 v141, v141, s66, -v5
    v_fma_f32 v142, v142, s66, -v5
    v_fma_f32 v143, v143, s66, -v5
    v_fma_f32 v136, v136, s66, -v5
    v_fma_f32 v137, v137, s66, -v5
    v_exp_f32 v140, v140
    v_exp_f32 v141, v141
    v_exp_f32 v142, v142
    v_exp_f32 v143, v143
    v_exp_f32 v136, v136
    v_exp_f32 v137, v137
    v_cvt_pk_bf16_f32 v224, v140, v141
    v_cvt_pk_bf16_f32 v225, v142, v143
    v_mov_b32 v226, 0
    v_mov_b32 v227, 0
    v_cvt_pk_bf16_f32 v228, v136, v137
    v_mov_b32 v229, v228
    v_add_f32 v5, v140, v141
    v_add_f32 v5, v5, v142
    v_add_f32 v5, v5, v143
    v_add_f32 v5, v5, v136
    v_add_f32 v5, v5, v137
    v_mov_b32 v6, v5
    s_nop 1
    v_permlane16_swap_b32 v5, v6
    v_add_f32 v5, v5, v6
    v_mov_b32 v6, v5
    s_nop 1
    v_permlane32_swap_b32 v5, v6
    v_add_f32 v5, v5, v6
    v_rcp_f32 v230, v5
    v_mov_b32 v5, s67
    v_cndmask_b32 v156, v5, v156, s[68:69]
    v_mov_b32 v5, s67
    v_cndmask_b32 v157, v5, v157, s[70:71]
    v_mov_b32 v5, s67
    v_cndmask_b32 v158, v5, v158, s[72:73]
    v_mov_b32 v5, s67
    v_cndmask_b32 v159, v5, v159, s[74:75]
    v_max3_f32 v5, v152, v153, v154
    v_max3_f32 v5, v5, v155, v156
    v_max3_f32 v5, v5, v157, v158
    v_max3_f32 v5, v5, v159, v148
    v_max_f32 v5, v5, v149
    v_mov_b32 v6, v5
    s_nop 1
    v_permlane16_swap_b32 v5, v6
    v_max_f32 v5, v5, v6
    v_mov_b32 v6, v5
    s_nop 1
    v_permlane32_swap_b32 v5, v6
    v_max_f32 v5, v5, v6
    v_mul_f32 v5, s66, v5
    v_fma_f32 v152, v152, s66, -v5
    v_fma_f32 v153, v153, s66, -v5
    v_fma_f32 v154, v154, s66, -v5
    v_fma_f32 v155, v155, s66, -v5
    v_fma_f32 v156, v156, s66, -v5
    v_fma_f32 v157, v157, s66, -v5
    v_fma_f32 v158, v158, s66, -v5
    v_fma_f32 v159, v159, s66, -v5
    v_fma_f32 v148, v148, s66, -v5
    v_fma_f32 v149, v149, s66, -v5
    v_exp_f32 v152, v152
    v_exp_f32 v153, v153
    v_exp_f32 v154, v154
    v_exp_f32 v155, v155
    v_exp_f32 v156, v156
    v_exp_f32 v157, v157
    v_exp_f32 v158, v158
    v_exp_f32 v159, v159
    v_exp_f32 v148, v148
    v_exp_f32 v149, v149
    v_cvt_pk_bf16_f32 v232, v152, v153
    v_cvt_pk_bf16_f32 v233, v154, v155
    v_cvt_pk_bf16_f32 v234, v156, v157
    v_cvt_pk_bf16_f32 v235, v158, v159
    v_cvt_pk_bf16_f32 v236, v148, v149
    v_mov_b32 v237, v236
    v_add_f32 v5, v152, v153
    v_add_f32 v5, v5, v154
    v_add_f32 v5, v5, v155
    v_add_f32 v5, v5, v156
    v_add_f32 v5, v5, v157
    v_add_f32 v5, v5, v158
    v_add_f32 v5, v5, v159
    v_add_f32 v5, v5, v148
    v_add_f32 v5, v5, v149
    v_mov_b32 v6, v5
    s_nop 1
    v_permlane16_swap_b32 v5, v6
    v_add_f32 v5, v5, v6
    v_mov_b32 v6, v5
    s_nop 1
    v_permlane32_swap_b32 v5, v6
    v_add_f32 v5, v5, v6
    v_rcp_f32 v238, v5
    s_waitcnt vmcnt(0)
    v_mfma_f32_16x16x32_bf16 v[160:163], v[88:91], v[224:227], 0
    v_mfma_f32_16x16x32_bf16 v[164:167], v[92:95], v[224:227], 0
    v_mfma_f32_16x16x32_bf16 v[168:171], v[96:99], v[224:227], 0
    v_mfma_f32_16x16x32_bf16 v[172:175], v[100:103], v[224:227], 0
    v_mfma_f32_16x16x32_bf16 v[176:179], v[104:107], v[224:227], 0
    v_mfma_f32_16x16x32_bf16 v[180:183], v[108:111], v[224:227], 0
    v_mfma_f32_16x16x32_bf16 v[184:187], v[112:115], v[224:227], 0
    v_mfma_f32_16x16x32_bf16 v[188:191], v[116:119], v[224:227], 0
    v_mfma_f32_16x16x16_bf16 v[160:163], v[120:121], v[228:229], v[160:163]
    v_mfma_f32_16x16x16_bf16 v[164:167], v[122:123], v[228:229], v[164:167]
    v_mfma_f32_16x16x16_bf16 v[168:171], v[124:125], v[228:229], v[168:171]
    v_mfma_f32_16x16x16_bf16 v[172:175], v[126:127], v[228:229], v[172:175]
    v_mfma_f32_16x16x16_bf16 v[176:179], v[128:129], v[228:229], v[176:179]
    v_mfma_f32_16x16x16_bf16 v[180:183], v[130:131], v[228:229], v[180:183]
    v_mfma_f32_16x16x16_bf16 v[184:187], v[132:133], v[228:229], v[184:187]
    v_mfma_f32_16x16x16_bf16 v[188:191], v[134:135], v[228:229], v[188:191]
    v_mfma_f32_16x16x32_bf16 v[192:195], v[88:91], v[232:235], 0
    v_mfma_f32_16x16x32_bf16 v[196:199], v[92:95], v[232:235], 0
    v_mfma_f32_16x16x32_bf16 v[200:203], v[96:99], v[232:235], 0
    v_mfma_f32_16x16x32_bf16 v[204:207], v[100:103], v[232:235], 0
    v_mfma_f32_16x16x32_bf16 v[208:211], v[104:107], v[232:235], 0
    v_mfma_f32_16x16x32_bf16 v[212:215], v[108:111], v[232:235], 0
    v_mfma_f32_16x16x32_bf16 v[216:219], v[112:115], v[232:235], 0
    v_mfma_f32_16x16x32_bf16 v[220:223], v[116:119], v[232:235], 0
    v_mfma_f32_16x16x16_bf16 v[192:195], v[120:121], v[236:237], v[192:195]
    v_mfma_f32_16x16x16_bf16 v[196:199], v[122:123], v[236:237], v[196:199]
    v_mfma_f32_16x16x16_bf16 v[200:203], v[124:125], v[236:237], v[200:203]
    v_mfma_f32_16x16x16_bf16 v[204:207], v[126:127], v[236:237], v[204:207]
    v_mfma_f32_16x16x16_bf16 v[208:211], v[128:129], v[236:237], v[208:211]
    v_mfma_f32_16x16x16_bf16 v[212:215], v[130:131], v[236:237], v[212:215]
    v_mfma_f32_16x16x16_bf16 v[216:219], v[132:133], v[236:237], v[216:219]
    v_mfma_f32_16x16x16_bf16 v[220:223], v[134:135], v[236:237], v[220:223]
    v_and_b32 v3, 15, v1
    v_lshlrev_b32 v3, 13, v3
    v_lshrrev_b32 v4, 4, v1
    v_lshl_add_u32 v3, v4, 4, v3
    s_lshl_b32 s60, s60, 18
    s_lshl_b32 s61, s56, 8
    s_add_u32 s60, s60, s61
    s_add_u32 s60, s60, 69206016
    v_mul_f32 v160, v160, v230
    v_mul_f32 v161, v161, v230
    v_mul_f32 v162, v162, v230
    v_mul_f32 v163, v163, v230
    v_mul_f32 v164, v164, v230
    v_mul_f32 v165, v165, v230
    v_mul_f32 v166, v166, v230
    v_mul_f32 v167, v167, v230
    v_cvt_pk_bf16_f32 v8, v160, v161
    v_cvt_pk_bf16_f32 v9, v162, v163
    v_cvt_pk_bf16_f32 v10, v164, v165
    v_cvt_pk_bf16_f32 v11, v166, v167
    s_add_u32 s64, s60, 0
    buffer_store_dwordx4 v[8:11], v3, s[32:35], s64 offen sc1
    v_mul_f32 v168, v168, v230
    v_mul_f32 v169, v169, v230
    v_mul_f32 v170, v170, v230
    v_mul_f32 v171, v171, v230
    v_mul_f32 v172, v172, v230
    v_mul_f32 v173, v173, v230
    v_mul_f32 v174, v174, v230
    v_mul_f32 v175, v175, v230
    v_cvt_pk_bf16_f32 v12, v168, v169
    v_cvt_pk_bf16_f32 v13, v170, v171
    v_cvt_pk_bf16_f32 v14, v172, v173
    v_cvt_pk_bf16_f32 v15, v174, v175
    s_add_u32 s64, s60, 64
    buffer_store_dwordx4 v[12:15], v3, s[32:35], s64 offen sc1
    v_mul_f32 v176, v176, v230
    v_mul_f32 v177, v177, v230
    v_mul_f32 v178, v178, v230
    v_mul_f32 v179, v179, v230
    v_mul_f32 v180, v180, v230
    v_mul_f32 v181, v181, v230
    v_mul_f32 v182, v182, v230
    v_mul_f32 v183, v183, v230
    v_cvt_pk_bf16_f32 v16, v176, v177
    v_cvt_pk_bf16_f32 v17, v178, v179
    v_cvt_pk_bf16_f32 v18, v180, v181
    v_cvt_pk_bf16_f32 v19, v182, v183
    s_add_u32 s64, s60, 128
    buffer_store_dwordx4 v[16:19], v3, s[32:35], s64 offen sc1
    v_mul_f32 v184, v184, v230
    v_mul_f32 v185, v185, v230
    v_mul_f32 v186, v186, v230
    v_mul_f32 v187, v187, v230
    v_mul_f32 v188, v188, v230
    v_mul_f32 v189, v189, v230
    v_mul_f32 v190, v190, v230
    v_mul_f32 v191, v191, v230
    v_cvt_pk_bf16_f32 v20, v184, v185
    v_cvt_pk_bf16_f32 v21, v186, v187
    v_cvt_pk_bf16_f32 v22, v188, v189
    v_cvt_pk_bf16_f32 v23, v190, v191
    s_add_u32 s64, s60, 192
    buffer_store_dwordx4 v[20:23], v3, s[32:35], s64 offen sc1
    v_mul_f32 v192, v192, v238
    v_mul_f32 v193, v193, v238
    v_mul_f32 v194, v194, v238
    v_mul_f32 v195, v195, v238
    v_mul_f32 v196, v196, v238
    v_mul_f32 v197, v197, v238
    v_mul_f32 v198, v198, v238
    v_mul_f32 v199, v199, v238
    v_cvt_pk_bf16_f32 v24, v192, v193
    v_cvt_pk_bf16_f32 v25, v194, v195
    v_cvt_pk_bf16_f32 v26, v196, v197
    v_cvt_pk_bf16_f32 v27, v198, v199
    s_add_u32 s64, s60, 131072
    buffer_store_dwordx4 v[24:27], v3, s[32:35], s64 offen sc1
    v_mul_f32 v200, v200, v238
    v_mul_f32 v201, v201, v238
    v_mul_f32 v202, v202, v238
    v_mul_f32 v203, v203, v238
    v_mul_f32 v204, v204, v238
    v_mul_f32 v205, v205, v238
    v_mul_f32 v206, v206, v238
    v_mul_f32 v207, v207, v238
    v_cvt_pk_bf16_f32 v28, v200, v201
    v_cvt_pk_bf16_f32 v29, v202, v203
    v_cvt_pk_bf16_f32 v30, v204, v205
    v_cvt_pk_bf16_f32 v31, v206, v207
    s_add_u32 s64, s60, 131136
    buffer_store_dwordx4 v[28:31], v3, s[32:35], s64 offen sc1
    v_mul_f32 v208, v208, v238
    v_mul_f32 v209, v209, v238
    v_mul_f32 v210, v210, v238
    v_mul_f32 v211, v211, v238
    v_mul_f32 v212, v212, v238
    v_mul_f32 v213, v213, v238
    v_mul_f32 v214, v214, v238
    v_mul_f32 v215, v215, v238
    v_cvt_pk_bf16_f32 v32, v208, v209
    v_cvt_pk_bf16_f32 v33, v210, v211
    v_cvt_pk_bf16_f32 v34, v212, v213
    v_cvt_pk_bf16_f32 v35, v214, v215
    s_add_u32 s64, s60, 131200
    buffer_store_dwordx4 v[32:35], v3, s[32:35], s64 offen sc1
    v_mul_f32 v216, v216, v238
    v_mul_f32 v217, v217, v238
    v_mul_f32 v218, v218, v238
    v_mul_f32 v219, v219, v238
    v_mul_f32 v220, v220, v238
    v_mul_f32 v221, v221, v238
    v_mul_f32 v222, v222, v238
    v_mul_f32 v223, v223, v238
    v_cvt_pk_bf16_f32 v36, v216, v217
    v_cvt_pk_bf16_f32 v37, v218, v219
    v_cvt_pk_bf16_f32 v38, v220, v221
    v_cvt_pk_bf16_f32 v39, v222, v223
    s_add_u32 s64, s60, 131264
    buffer_store_dwordx4 v[36:39], v3, s[32:35], s64 offen sc1
    s_lshl_b32 s60, s55, 3
    s_lshr_b32 s61, s56, 2
    s_add_u32 s60, s60, s61
    s_lshl_b32 s60, s60, 7
    s_add_u32 s60, s60, 133365760
    s_waitcnt vmcnt(0)
    s_barrier
    s_cmp_lg_u32 s3, 0
    s_cbranch_scc1 L_sg_55
    v_mov_b32 v8, 1
    s_mov_b64 exec, 1
    buffer_atomic_add v8, off, s[32:35], s60 sc1
    s_mov_b64 exec, -1
L_sg_55:
L_rb_noat:
    s_sub_u32 s60, s96, 2
    s_cmp_ge_u32 s60, 4
    s_cbranch_scc1 L_rb_nop
    s_lshr_b32 s57, s60, 1
    s_lshr_b32 s60, s3, 1
    s_and_b32 s61, s3, 1
    v_and_b32 v18, 31, v1
    s_lshl_b32 s62, s60, 5
    v_add_u32 v18, s62, v18
    v_bfe_u32 v19, v18, 1, 3
    v_lshrrev_b32 v20, 5, v1
    v_lshlrev_b32 v18, 7, v18
    v_add_u32 v21, 0, v20
    v_xor_b32 v21, v21, v19
    v_lshl_add_u32 v112, v21, 4, v18
    v_add_u32 v112, 65536, v112
    v_add_u32 v21, 2, v20
    v_xor_b32 v21, v21, v19
    v_lshl_add_u32 v113, v21, 4, v18
    v_add_u32 v113, 65536, v113
    v_add_u32 v21, 4, v20
    v_xor_b32 v21, v21, v19
    v_lshl_add_u32 v114, v21, 4, v18
    v_add_u32 v114, 65536, v114
    v_add_u32 v21, 6, v20
    v_xor_b32 v21, v21, v19
    v_lshl_add_u32 v115, v21, 4, v18
    v_add_u32 v115, 65536, v115
    v_bfe_u32 v18, v1, 2, 2
    v_lshrrev_b32 v19, 5, v1
    v_lshl_add_u32 v19, v19, 2, v18
    v_lshlrev_b32 v19, 7, v19
    v_lshrrev_b32 v18, 1, v18
    v_lshlrev_b32 v18, 2, v18
    v_bfe_u32 v20, v1, 4, 1
    v_lshlrev_b32 v20, 1, v20
    v_bfe_u32 v21, v1, 1, 1
    v_add_u32 v20, v20, v21
    s_lshl_b32 s62, s61, 2
    v_add_u32 v20, s62, v20
    v_xor_b32 v20, v20, v18
    v_and_b32 v21, 1, v1
    v_lshlrev_b32 v21, 3, v21
    v_add_u32 v19, v19, v21
    v_lshl_add_u32 v116, v20, 4, v19
    v_lshrrev_b32 v18, 3, v1
    v_and_b32 v19, 7, v1
    v_lshrrev_b32 v20, 4, v1
    v_lshlrev_b32 v21, 13, v18
    v_xor_b32 v22, v19, v20
    v_lshl_add_u32 v118, v22, 4, v21
    v_add_u32 v22, 4, v20
    v_xor_b32 v22, v19, v22
    v_lshl_add_u32 v119, v22, 4, v21
    v_lshlrev_b32 v21, 10, v18
    v_bfe_u32 v20, v1, 4, 1
    v_lshlrev_b32 v20, 2, v20
    v_xor_b32 v19, v19, v20
    v_lshl_add_u32 v120, v19, 4, v21
    v_mov_b32 v92, 0
    v_mov_b32 v93, 0
    v_mov_b32 v94, 0
    v_mov_b32 v95, 0
    v_mov_b32 v96, 0
    v_mov_b32 v97, 0
    v_mov_b32 v98, 0
    v_mov_b32 v99, 0
    v_mov_b32 v100, 0
    v_mov_b32 v101, 0
    v_mov_b32 v102, 0
    v_mov_b32 v103, 0
    v_mov_b32 v104, 0
    v_mov_b32 v105, 0
    v_mov_b32 v106, 0
    v_mov_b32 v107, 0
    s_lshl_b32 s49, s55, 7
    s_lshl_b32 s60, s57, 6
    s_add_u32 s49, s49, s60
    s_lshl_b32 s60, s3, 4
    s_add_u32 s49, s49, s60
    s_lshl_b32 s49, s49, 13
    s_lshl_b32 s60, s99, 10
    s_add_u32 s49, s49, s60
    s_add_u32 s49, s49, 69206016
    s_lshl_b32 s64, s3, 11
    s_lshl_b32 s60, s55, 3
    s_add_u32 s60, s60, s99
    s_lshl_b32 s60, s60, 7
    s_add_u32 s60, s60, 133365760
    s_cmp_lg_u32 s3, 0
    s_cbranch_scc1 L_w1_56
    s_mov_b64 exec, 1
L_w1l_57:
    buffer_load_dword v7, off, s[32:35], s60 sc1
    s_waitcnt vmcnt(0)
    v_readfirstlane_b32 s61, v7
    s_add_u32 s94, s94, 1
    s_cmp_gt_u32 s94, 3000000
    s_cbranch_scc1 L_exit
    s_cmp_ge_u32 s61, 4
    s_cbranch_scc1 L_w1k_58
    s_sleep 1
    s_branch L_w1l_57
L_w1k_58:
    s_mov_b64 exec, -1
L_w1_56:
    s_barrier
    s_add_u32 s60, s49, 0
    s_add_u32 m0, s64, 65536
    s_nop 0
    buffer_load_dwordx4 v118, s[32:35], s60 offen sc1 lds
    s_add_u32 s60, s49, 65536
    s_add_u32 m0, s64, 66560
    s_nop 0
    buffer_load_dwordx4 v119, s[32:35], s60 offen sc1 lds
    s_add_u32 s60, s49, 128
    s_add_u32 m0, s64, 73728
    s_nop 0
    buffer_load_dwordx4 v118, s[32:35], s60 offen sc1 lds
    s_add_u32 s60, s49, 65664
    s_add_u32 m0, s64, 74752
    s_nop 0
    buffer_load_dwordx4 v119, s[32:35], s60 offen sc1 lds
    s_add_u32 s60, s49, 256
    s_add_u32 m0, s64, 81920
    s_nop 0
    buffer_load_dwordx4 v118, s[32:35], s60 offen sc1 lds
    s_add_u32 s60, s49, 65792
    s_add_u32 m0, s64, 82944
    s_nop 0
    buffer_load_dwordx4 v119, s[32:35], s60 offen sc1 lds
    s_add_u32 s60, s49, 384
    s_add_u32 m0, s64, 90112
    s_nop 0
    buffer_load_dwordx4 v118, s[32:35], s60 offen sc1 lds
    s_add_u32 s60, s49, 65920
    s_add_u32 m0, s64, 91136
    s_nop 0
    buffer_load_dwordx4 v119, s[32:35], s60 offen sc1 lds
    s_add_u32 s60, s49, 512
    s_add_u32 m0, s64, 98304
    s_nop 0
    buffer_load_dwordx4 v118, s[32:35], s60 offen sc1 lds
    s_add_u32 s60, s49, 66048
    s_add_u32 m0, s64, 99328
    s_nop 0
    buffer_load_dwordx4 v119, s[32:35], s60 offen sc1 lds
    s_add_u32 s60, s49, 640
    s_add_u32 m0, s64, 106496
    s_nop 0
    buffer_load_dwordx4 v118, s[32:35], s60 offen sc1 lds
    s_add_u32 s60, s49, 66176
    s_add_u32 m0, s64, 107520
    s_nop 0
    buffer_load_dwordx4 v119, s[32:35], s60 offen sc1 lds
    s_add_u32 s60, s49, 768
    s_add_u32 m0, s64, 114688
    s_nop 0
    buffer_load_dwordx4 v118, s[32:35], s60 offen sc1 lds
    s_add_u32 s60, s49, 66304
    s_add_u32 m0, s64, 115712
    s_nop 0
    buffer_load_dwordx4 v119, s[32:35], s60 offen sc1 lds
    s_add_u32 s60, s49, 896
    s_add_u32 m0, s64, 122880
    s_nop 0
    buffer_load_dwordx4 v118, s[32:35], s60 offen sc1 lds
    s_add_u32 s60, s49, 66432
    s_add_u32 m0, s64, 123904
    s_nop 0
    buffer_load_dwordx4 v119, s[32:35], s60 offen sc1 lds
    s_waitcnt vmcnt(14)
    s_barrier
    ds_read_b128 v[24:27], v112 offset:0
    ds_read_b64_tr_b16 v[28:29], v116 offset:0
    ds_read_b64_tr_b16 v[30:31], v116 offset:2048
    ds_read_b128 v[32:35], v113 offset:0
    ds_read_b64_tr_b16 v[36:37], v116 offset:1024
    ds_read_b64_tr_b16 v[38:39], v116 offset:3072
    ds_read_b128 v[40:43], v114 offset:0
    ds_read_b64_tr_b16 v[44:45], v116 offset:4096
    ds_read_b64_tr_b16 v[46:47], v116 offset:6144
    ds_read_b128 v[48:51], v115 offset:0
    ds_read_b64_tr_b16 v[52:53], v116 offset:5120
    ds_read_b64_tr_b16 v[54:55], v116 offset:7168
    s_waitcnt lgkmcnt(9)
    v_mfma_f32_32x32x16_bf16 v[92:107], v[28:31], v[24:27], v[92:107]
    s_waitcnt lgkmcnt(6)
    v_mfma_f32_32x32x16_bf16 v[92:107], v[36:39], v[32:35], v[92:107]
    s_waitcnt lgkmcnt(3)
    v_mfma_f32_32x32x16_bf16 v[92:107], v[44:47], v[40:43], v[92:107]
    s_waitcnt lgkmcnt(0)
    v_mfma_f32_32x32x16_bf16 v[92:107], v[52:55], v[48:51], v[92:107]
    s_waitcnt vmcnt(12)
    s_barrier
    ds_read_b128 v[56:59], v112 offset:8192
    ds_read_b64_tr_b16 v[60:61], v116 offset:8192
    ds_read_b64_tr_b16 v[62:63], v116 offset:10240
    ds_read_b128 v[64:67], v113 offset:8192
    ds_read_b64_tr_b16 v[68:69], v116 offset:9216
    ds_read_b64_tr_b16 v[70:71], v116 offset:11264
    ds_read_b128 v[72:75], v114 offset:8192
    ds_read_b64_tr_b16 v[76:77], v116 offset:12288
    ds_read_b64_tr_b16 v[78:79], v116 offset:14336
    ds_read_b128 v[80:83], v115 offset:8192
    ds_read_b64_tr_b16 v[84:85], v116 offset:13312
    ds_read_b64_tr_b16 v[86:87], v116 offset:15360
    s_waitcnt lgkmcnt(9)
    v_mfma_f32_32x32x16_bf16 v[92:107], v[60:63], v[56:59], v[92:107]
    s_waitcnt lgkmcnt(6)
    v_mfma_f32_32x32x16_bf16 v[92:107], v[68:71], v[64:67], v[92:107]
    s_waitcnt lgkmcnt(3)
    v_mfma_f32_32x32x16_bf16 v[92:107], v[76:79], v[72:75], v[92:107]
    s_waitcnt lgkmcnt(0)
    v_mfma_f32_32x32x16_bf16 v[92:107], v[84:87], v[80:83], v[92:107]
    s_waitcnt vmcnt(10)
    s_barrier
    ds_read_b128 v[24:27], v112 offset:16384
    ds_read_b64_tr_b16 v[28:29], v116 offset:16384
    ds_read_b64_tr_b16 v[30:31], v116 offset:18432
    ds_read_b128 v[32:35], v113 offset:16384
    ds_read_b64_tr_b16 v[36:37], v116 offset:17408
    ds_read_b64_tr_b16 v[38:39], v116 offset:19456
    ds_read_b128 v[40:43], v114 offset:16384
    ds_read_b64_tr_b16 v[44:45], v116 offset:20480
    ds_read_b64_tr_b16 v[46:47], v116 offset:22528
    ds_read_b128 v[48:51], v115 offset:16384
    ds_read_b64_tr_b16 v[52:53], v116 offset:21504
    ds_read_b64_tr_b16 v[54:55], v116 offset:23552
    s_waitcnt lgkmcnt(9)
    v_mfma_f32_32x32x16_bf16 v[92:107], v[28:31], v[24:27], v[92:107]
    s_waitcnt lgkmcnt(6)
    v_mfma_f32_32x32x16_bf16 v[92:107], v[36:39], v[32:35], v[92:107]
    s_waitcnt lgkmcnt(3)
    v_mfma_f32_32x32x16_bf16 v[92:107], v[44:47], v[40:43], v[92:107]
    s_waitcnt lgkmcnt(0)
    v_mfma_f32_32x32x16_bf16 v[92:107], v[52:55], v[48:51], v[92:107]
    s_waitcnt vmcnt(8)
    s_barrier
    ds_read_b128 v[56:59], v112 offset:24576
    ds_read_b64_tr_b16 v[60:61], v116 offset:24576
    ds_read_b64_tr_b16 v[62:63], v116 offset:26624
    ds_read_b128 v[64:67], v113 offset:24576
    ds_read_b64_tr_b16 v[68:69], v116 offset:25600
    ds_read_b64_tr_b16 v[70:71], v116 offset:27648
    ds_read_b128 v[72:75], v114 offset:24576
    ds_read_b64_tr_b16 v[76:77], v116 offset:28672
    ds_read_b64_tr_b16 v[78:79], v116 offset:30720
    ds_read_b128 v[80:83], v115 offset:24576
    ds_read_b64_tr_b16 v[84:85], v116 offset:29696
    ds_read_b64_tr_b16 v[86:87], v116 offset:31744
    s_waitcnt lgkmcnt(9)
    v_mfma_f32_32x32x16_bf16 v[92:107], v[60:63], v[56:59], v[92:107]
    s_waitcnt lgkmcnt(6)
    v_mfma_f32_32x32x16_bf16 v[92:107], v[68:71], v[64:67], v[92:107]
    s_waitcnt lgkmcnt(3)
    v_mfma_f32_32x32x16_bf16 v[92:107], v[76:79], v[72:75], v[92:107]
    s_waitcnt lgkmcnt(0)
    v_mfma_f32_32x32x16_bf16 v[92:107], v[84:87], v[80:83], v[92:107]
    s_waitcnt vmcnt(6)
    s_barrier
    ds_read_b128 v[24:27], v112 offset:32768
    ds_read_b64_tr_b16 v[28:29], v116 offset:32768
    ds_read_b64_tr_b16 v[30:31], v116 offset:34816
    ds_read_b128 v[32:35], v113 offset:32768
    ds_read_b64_tr_b16 v[36:37], v116 offset:33792
    ds_read_b64_tr_b16 v[38:39], v116 offset:35840
    ds_read_b128 v[40:43], v114 offset:32768
    ds_read_b64_tr_b16 v[44:45], v116 offset:36864
    ds_read_b64_tr_b16 v[46:47], v116 offset:38912
    ds_read_b128 v[48:51], v115 offset:32768
    ds_read_b64_tr_b16 v[52:53], v116 offset:37888
    ds_read_b64_tr_b16 v[54:55], v116 offset:39936
    s_waitcnt lgkmcnt(9)
    v_mfma_f32_32x32x16_bf16 v[92:107], v[28:31], v[24:27], v[92:107]
    s_waitcnt lgkmcnt(6)
    v_mfma_f32_32x32x16_bf16 v[92:107], v[36:39], v[32:35], v[92:107]
    s_waitcnt lgkmcnt(3)
    v_mfma_f32_32x32x16_bf16 v[92:107], v[44:47], v[40:43], v[92:107]
    s_waitcnt lgkmcnt(0)
    v_mfma_f32_32x32x16_bf16 v[92:107], v[52:55], v[48:51], v[92:107]
    s_waitcnt vmcnt(4)
    s_barrier
    ds_read_b128 v[56:59], v112 offset:40960
    ds_read_b64_tr_b16 v[60:61], v116 offset:40960
    ds_read_b64_tr_b16 v[62:63], v116 offset:43008
    ds_read_b128 v[64:67], v113 offset:40960
    ds_read_b64_tr_b16 v[68:69], v116 offset:41984
    ds_read_b64_tr_b16 v[70:71], v116 offset:44032
    ds_read_b128 v[72:75], v114 offset:40960
    ds_read_b64_tr_b16 v[76:77], v116 offset:45056
    ds_read_b64_tr_b16 v[78:79], v116 offset:47104
    ds_read_b128 v[80:83], v115 offset:40960
    ds_read_b64_tr_b16 v[84:85], v116 offset:46080
    ds_read_b64_tr_b16 v[86:87], v116 offset:48128
    s_waitcnt lgkmcnt(9)
    v_mfma_f32_32x32x16_bf16 v[92:107], v[60:63], v[56:59], v[92:107]
    s_waitcnt lgkmcnt(6)
    v_mfma_f32_32x32x16_bf16 v[92:107], v[68:71], v[64:67], v[92:107]
    s_waitcnt lgkmcnt(3)
    v_mfma_f32_32x32x16_bf16 v[92:107], v[76:79], v[72:75], v[92:107]
    s_waitcnt lgkmcnt(0)
    v_mfma_f32_32x32x16_bf16 v[92:107], v[84:87], v[80:83], v[92:107]
    s_waitcnt vmcnt(2)
    s_barrier
    ds_read_b128 v[24:27], v112 offset:49152
    ds_read_b64_tr_b16 v[28:29], v116 offset:49152
    ds_read_b64_tr_b16 v[30:31], v116 offset:51200
    ds_read_b128 v[32:35], v113 offset:49152
    ds_read_b64_tr_b16 v[36:37], v116 offset:50176
    ds_read_b64_tr_b16 v[38:39], v116 offset:52224
    ds_read_b128 v[40:43], v114 offset:49152
    ds_read_b64_tr_b16 v[44:45], v116 offset:53248
    ds_read_b64_tr_b16 v[46:47], v116 offset:55296
    ds_read_b128 v[48:51], v115 offset:49152
    ds_read_b64_tr_b16 v[52:53], v116 offset:54272
    ds_read_b64_tr_b16 v[54:55], v116 offset:56320
    s_waitcnt lgkmcnt(9)
    v_mfma_f32_32x32x16_bf16 v[92:107], v[28:31], v[24:27], v[92:107]
    s_waitcnt lgkmcnt(6)
    v_mfma_f32_32x32x16_bf16 v[92:107], v[36:39], v[32:35], v[92:107]
    s_waitcnt lgkmcnt(3)
    v_mfma_f32_32x32x16_bf16 v[92:107], v[44:47], v[40:43], v[92:107]
    s_waitcnt lgkmcnt(0)
    v_mfma_f32_32x32x16_bf16 v[92:107], v[52:55], v[48:51], v[92:107]
    s_waitcnt vmcnt(0)
    s_barrier
    ds_read_b128 v[56:59], v112 offset:57344
    ds_read_b64_tr_b16 v[60:61], v116 offset:57344
    ds_read_b64_tr_b16 v[62:63], v116 offset:59392
    ds_read_b128 v[64:67], v113 offset:57344
    ds_read_b64_tr_b16 v[68:69], v116 offset:58368
    ds_read_b64_tr_b16 v[70:71], v116 offset:60416
    ds_read_b128 v[72:75], v114 offset:57344
    ds_read_b64_tr_b16 v[76:77], v116 offset:61440
    ds_read_b64_tr_b16 v[78:79], v116 offset:63488
    ds_read_b128 v[80:83], v115 offset:57344
    ds_read_b64_tr_b16 v[84:85], v116 offset:62464
    ds_read_b64_tr_b16 v[86:87], v116 offset:64512
    s_waitcnt lgkmcnt(9)
    v_mfma_f32_32x32x16_bf16 v[92:107], v[60:63], v[56:59], v[92:107]
    s_waitcnt lgkmcnt(6)
    v_mfma_f32_32x32x16_bf16 v[92:107], v[68:71], v[64:67], v[92:107]
    s_waitcnt lgkmcnt(3)
    v_mfma_f32_32x32x16_bf16 v[92:107], v[76:79], v[72:75], v[92:107]
    s_waitcnt lgkmcnt(0)
    v_mfma_f32_32x32x16_bf16 v[92:107], v[84:87], v[80:83], v[92:107]
    v_lshlrev_b32 v18, 4, v1
    s_lshl_b32 s60, s55, 2
    s_lshr_b32 s61, s98, 1
    s_add_u32 s60, s60, s61
    s_lshl_b32 s60, s60, 2
    s_lshl_b32 s61, s57, 1
    s_add_u32 s60, s60, s61
    s_and_b32 s61, s98, 1
    s_add_u32 s60, s60, s61
    s_lshl_b32 s60, s60, 14
    s_lshl_b32 s61, s3, 12
    s_add_u32 s60, s60, s61
    s_lshl_b32 s61, s99, 22
    s_add_u32 s60, s60, s61
    s_add_u32 s60, s60, 98566144
    s_add_u32 s61, s60, 0
    buffer_store_dwordx4 v[92:95], v18, s[32:35], s61 offen sc1
    s_add_u32 s61, s60, 1024
    buffer_store_dwordx4 v[96:99], v18, s[32:35], s61 offen sc1
    s_add_u32 s61, s60, 2048
    buffer_store_dwordx4 v[100:103], v18, s[32:35], s61 offen sc1
    s_add_u32 s61, s60, 3072
    buffer_store_dwordx4 v[104:107], v18, s[32:35], s61 offen sc1
    s_barrier
    s_lshl_b32 s60, s55, 2
    s_lshr_b32 s61, s98, 1
    s_add_u32 s60, s60, s61
    s_lshl_b32 s60, s60, 7
    s_add_u32 s60, s60, 133382144
    s_waitcnt vmcnt(0)
    s_barrier
    s_cmp_lg_u32 s3, 0
    s_cbranch_scc1 L_sg_59
    v_mov_b32 v8, 1
    s_mov_b64 exec, 1
    buffer_atomic_add v8, off, s[32:35], s60 sc1
    s_mov_b64 exec, -1
L_sg_59:
L_rb_nop:
    s_cmp_lg_u32 s96, 6
    s_cbranch_scc1 L_rb_nof
    s_lshr_b32 s56, s97, 3
    s_bfe_u32 s57, s97, 0x20001
    s_and_b32 s58, s97, 1
    s_bitcmp1_b32 s90, s55
    s_cbranch_scc1 L_wf_60
    v_lshlrev_b32 v8, 7, v1
    s_mov_b32 s60, 133177344
L_wfl_61:
    s_mov_b64 exec, 0xffff
    buffer_load_dword v9, v8, s[32:35], s60 offen sc1
    s_waitcnt vmcnt(0)
    v_cmp_le_u32 vcc, 4, v9
    s_mov_b64 exec, -1
    s_mov_b32 s90, vcc_lo
    s_add_u32 s94, s94, 1
    s_cmp_gt_u32 s94, 3000000
    s_cbranch_scc1 L_exit
    s_bitcmp1_b32 s90, s55
    s_cbranch_scc1 L_wf_60
    s_sleep 8
    s_branch L_wfl_61
L_wf_60:
    v_lshlrev_b32 v2, 4, v1
    s_lshl_b32 s60, s55, 2
    s_add_u32 s60, s60, s56
    s_lshl_b32 s60, s60, 2
    s_add_u32 s60, s60, s3
    s_lshl_b32 s60, s60, 14
    s_lshl_b32 s61, s57, 12
    s_add_u32 s60, s60, s61
    s_lshl_b32 s61, s58, 11
    s_add_u32 s60, s60, s61
    s_add_u32 s64, s60, 94371840
    buffer_load_dwordx4 v[8:11], v2, s[32:35], s64 offen offset:0 sc1
    buffer_load_dwordx4 v[12:15], v2, s[32:35], s64 offen offset:1024 sc1
    s_mov_b32 s65, s60
    s_mov_b32 s40, s4
    s_and_b32 s41, s5, 0xffff
    s_mov_b32 s42, 2097152
    s_mov_b32 s43, 0x20000
    s_mov_b32 s44, s26
    s_and_b32 s45, s27, 0xffff
    s_mov_b32 s46, 2097152
    s_mov_b32 s47, 0x20000
    v_and_b32 v3, 31, v1
    v_lshlrev_b32 v3, 10, v3
    v_lshrrev_b32 v4, 5, v1
    v_lshl_add_u32 v3, v4, 3, v3
    s_lshr_b32 s61, s3, 1
    s_lshl_b32 s61, s61, 1
    s_lshr_b32 s62, s57, 1
    s_add_u32 s61, s61, s62
    s_lshl_b32 s61, s61, 5
    s_lshl_b32 s62, s55, 7
    s_add_u32 s61, s61, s62
    s_lshl_b32 s61, s61, 10
    s_and_b32 s62, s3, 1
    s_lshl_b32 s62, s62, 1
    s_and_b32 s63, s57, 1
    s_add_u32 s62, s62, s63
    s_lshl_b32 s62, s62, 6
    s_lshl_b32 s63, s56, 8
    s_add_u32 s61, s61, s62
    s_add_u32 s61, s61, s63
    s_lshl_b32 s62, s58, 5
    s_add_u32 s61, s61, s62
    buffer_load_dwordx2 v[80:81], v3, s[40:43], s61 offen offset:0
    buffer_load_dwordx2 v[82:83], v3, s[40:43], s61 offen offset:16
    s_mov_b32 s76, s61
    s_lshl_b32 s60, s55, 2
    s_add_u32 s60, s60, s56
    s_lshl_b32 s60, s60, 7
    s_add_u32 s60, s60, 133382144
    s_cmp_lg_u32 s3, 0
    s_cbranch_scc1 L_w1_62
    s_mov_b64 exec, 1
L_w1l_63:
    buffer_load_dword v7, off, s[32:35], s60 sc1
    s_waitcnt vmcnt(0)
    v_readfirstlane_b32 s61, v7
    s_add_u32 s94, s94, 1
    s_cmp_gt_u32 s94, 3000000
    s_cbranch_scc1 L_exit
    s_cmp_ge_u32 s61, 32
    s_cbranch_scc1 L_w1k_64
    s_sleep 1
    s_branch L_w1l_63
L_w1k_64:
    s_mov_b64 exec, -1
L_w1_62:
    s_barrier
    s_add_u32 s64, s65, 98566144
    buffer_load_dwordx4 v[16:19], v2, s[32:35], s64 offen offset:0 sc1
    buffer_load_dwordx4 v[20:23], v2, s[32:35], s64 offen offset:1024 sc1
    s_add_u32 s64, s65, 102760448
    buffer_load_dwordx4 v[24:27], v2, s[32:35], s64 offen offset:0 sc1
    buffer_load_dwordx4 v[28:31], v2, s[32:35], s64 offen offset:1024 sc1
    s_add_u32 s64, s65, 106954752
    buffer_load_dwordx4 v[32:35], v2, s[32:35], s64 offen offset:0 sc1
    buffer_load_dwordx4 v[36:39], v2, s[32:35], s64 offen offset:1024 sc1
    s_add_u32 s64, s65, 111149056
    buffer_load_dwordx4 v[40:43], v2, s[32:35], s64 offen offset:0 sc1
    buffer_load_dwordx4 v[44:47], v2, s[32:35], s64 offen offset:1024 sc1
    s_add_u32 s64, s65, 115343360
    buffer_load_dwordx4 v[48:51], v2, s[32:35], s64 offen offset:0 sc1
    buffer_load_dwordx4 v[52:55], v2, s[32:35], s64 offen offset:1024 sc1
    s_add_u32 s64, s65, 119537664
    buffer_load_dwordx4 v[56:59], v2, s[32:35], s64 offen offset:0 sc1
    buffer_load_dwordx4 v[60:63], v2, s[32:35], s64 offen offset:1024 sc1
    s_add_u32 s64, s65, 123731968
    buffer_load_dwordx4 v[64:67], v2, s[32:35], s64 offen offset:0 sc1
    buffer_load_dwordx4 v[68:71], v2, s[32:35], s64 offen offset:1024 sc1
    s_add_u32 s64, s65, 127926272
    buffer_load_dwordx4 v[72:75], v2, s[32:35], s64 offen offset:0 sc1
    buffer_load_dwordx4 v[76:79], v2, s[32:35], s64 offen offset:1024 sc1
    s_waitcnt vmcnt(12)
    v_pk_add_f32 v[16:17], v[16:17], v[24:25]
    v_pk_add_f32 v[18:19], v[18:19], v[26:27]
    v_pk_add_f32 v[20:21], v[20:21], v[28:29]
    v_pk_add_f32 v[22:23], v[22:23], v[30:31]
    s_waitcnt vmcnt(10)
    v_pk_add_f32 v[16:17], v[16:17], v[32:33]
    v_pk_add_f32 v[18:19], v[18:19], v[34:35]
    v_pk_add_f32 v[20:21], v[20:21], v[36:37]
    v_pk_add_f32 v[22:23], v[22:23], v[38:39]
    s_waitcnt vmcnt(8)
    v_pk_add_f32 v[16:17], v[16:17], v[40:41]
    v_pk_add_f32 v[18:19], v[18:19], v[42:43]
    v_pk_add_f32 v[20:21], v[20:21], v[44:45]
    v_pk_add_f32 v[22:23], v[22:23], v[46:47]
    s_waitcnt vmcnt(6)
    v_pk_add_f32 v[16:17], v[16:17], v[48:49]
    v_pk_add_f32 v[18:19], v[18:19], v[50:51]
    v_pk_add_f32 v[20:21], v[20:21], v[52:53]
    v_pk_add_f32 v[22:23], v[22:23], v[54:55]
    s_waitcnt vmcnt(4)
    v_pk_add_f32 v[16:17], v[16:17], v[56:57]
    v_pk_add_f32 v[18:19], v[18:19], v[58:59]
    v_pk_add_f32 v[20:21], v[20:21], v[60:61]
    v_pk_add_f32 v[22:23], v[22:23], v[62:63]
    s_waitcnt vmcnt(2)
    v_pk_add_f32 v[16:17], v[16:17], v[64:65]
    v_pk_add_f32 v[18:19], v[18:19], v[66:67]
    v_pk_add_f32 v[20:21], v[20:21], v[68:69]
    v_pk_add_f32 v[22:23], v[22:23], v[70:71]
    s_waitcnt vmcnt(0)
    v_pk_add_f32 v[16:17], v[16:17], v[72:73]
    v_pk_add_f32 v[18:19], v[18:19], v[74:75]
    v_pk_add_f32 v[20:21], v[20:21], v[76:77]
    v_pk_add_f32 v[22:23], v[22:23], v[78:79]
    v_lshlrev_b32 v5, 16, v80
    v_and_b32 v6, 0xffff0000, v80
    v_fmac_f32 v5, v16, v8
    v_fmac_f32 v6, v17, v9
    v_cvt_pk_bf16_f32 v80, v5, v6
    v_lshlrev_b32 v5, 16, v81
    v_and_b32 v6, 0xffff0000, v81
    v_fmac_f32 v5, v18, v10
    v_fmac_f32 v6, v19, v11
    v_cvt_pk_bf16_f32 v81, v5, v6
    v_lshlrev_b32 v5, 16, v82
    v_and_b32 v6, 0xffff0000, v82
    v_fmac_f32 v5, v20, v12
    v_fmac_f32 v6, v21, v13
    v_cvt_pk_bf16_f32 v82, v5, v6
    v_lshlrev_b32 v5, 16, v83
    v_and_b32 v6, 0xffff0000, v83
    v_fmac_f32 v5, v22, v14
    v_fmac_f32 v6, v23, v15
    v_cvt_pk_bf16_f32 v83, v5, v6
    s_cmp_eq_u32 s55, 15
    s_cbranch_scc1 L_fpl_65
    buffer_store_dwordx2 v[80:81], v3, s[44:47], s76 offen offset:0 sc1
    buffer_store_dwordx2 v[82:83], v3, s[44:47], s76 offen offset:16 sc1
    s_branch L_fpe_66
L_fpl_65:
    buffer_store_dwordx2 v[80:81], v3, s[44:47], s76 offen offset:0
    buffer_store_dwordx2 v[82:83], v3, s[44:47], s76 offen offset:16
L_fpe_66:
L_rb_nof:
    s_add_u32 s100, s100, 1
    s_cmp_lt_u32 s100, 16
    s_cbranch_scc1 L_rb_loop
    s_branch L_exit0
L_chain:
    s_lshl_b32 s57, s3, 11
    s_lshl_b32 s56, s48, 8
    s_lshl_b32 s54, s3, 16
    s_lshl_b32 s66, s48, 6
    s_add_u32 s54, s54, s66
    s_lshl_b32 s55, s48, 13
    s_add_u32 s55, s55, s57
    s_mov_b32 s64, 0x3e0293ee
    s_mov_b32 s65, 0
    v_mov_b32 v8, v1
    v_lshlrev_b32 v1, 4, v8
    v_bfe_u32 v9, v8, 1, 1
    v_cmp_eq_u32 vcc, 1, v9
    v_mov_b32 v10, 0x4444
    v_mov_b32 v11, 0xeeee
    v_cndmask_b32 v0, v10, v11, vcc
    v_and_b32 v10, 15, v8
    v_cmp_le_u32 vcc, 8, v10
    s_nop 0
    s_mov_b64 s[62:63], vcc
    v_lshrrev_b32 v11, 4, v8
    v_lshrrev_b32 v12, 3, v10
    v_lshlrev_b32 v12, 13, v12
    v_lshl_add_u32 v12, v11, 11, v12
    v_and_b32 v13, 7, v10
    v_lshl_add_u32 v2, v13, 3, v12
    s_lshl_b32 s66, s3, 9
    s_add_u32 s66, s66, 155648
    v_lshlrev_b32 v12, 4, v10
    v_lshl_add_u32 v12, v11, 2, v12
    v_add_u32 v3, s66, v12
    s_lshl_b32 s66, s3, 10
    s_add_u32 s66, s66, 147456
    v_lshlrev_b32 v12, 5, v10
    v_lshl_add_u32 v12, v11, 3, v12
    v_add_u32 v4, s66, v12
    v_lshrrev_b32 v12, 5, v8
    v_lshlrev_b32 v12, 4, v12
    v_bfe_u32 v13, v8, 4, 1
    v_lshl_add_u32 v12, v13, 2, v12
    v_bfe_u32 v13, v8, 2, 2
    v_add_u32 v12, v12, v13
    v_and_b32 v13, 1, v8
    v_lshlrev_b32 v13, 3, v13
    v_lshl_add_u32 v13, v12, 4, v13
    v_add_u32 v5, 155648, v13
    v_and_b32 v13, 3, v8
    v_lshlrev_b32 v13, 3, v13
    v_lshl_add_u32 v13, v12, 5, v13
    v_add_u32 v6, 147456, v13
    v_add_u32 v7, s57, v1
    v_and_b32 v12, 7, v10
    v_mul_u32_u24 v12, 272, v12
    v_lshrrev_b32 v13, 3, v10
    v_lshl_add_u32 v12, v13, 5, v12
    v_lshl_add_u32 v12, v11, 2, v12
    s_lshl_b32 s66, s3, 6
    s_add_u32 s66, s66, 151552
    v_add_u32 v16, s66, v12
    v_lshrrev_b32 v12, 2, v10
    v_and_b32 v13, 1, v10
    v_lshl_add_u32 v12, v12, 1, v13
    v_mul_u32_u24 v12, 272, v12
    v_lshl_add_u32 v12, v11, 5, v12
    v_lshl_add_u32 v12, v9, 4, v12
    v_add_u32 v17, 151552, v12
    v_lshrrev_b32 v12, 2, v10
    v_lshlrev_b32 v12, 6, v12
    v_lshl_add_u32 v12, v11, 5, v12
    v_and_b32 v13, 3, v10
    v_lshl_add_u32 v18, v13, 2, v12
    v_lshlrev_b32 v12, 13, v11
    v_lshl_add_u32 v19, v10, 4, v12
    v_lshlrev_b32 v12, 5, v11
    v_bfe_u32 v13, v10, 2, 1
    v_lshl_add_u32 v12, v13, 4, v12
    v_and_b32 v13, 3, v10
    v_lshl_add_u32 v28, v13, 2, v12
    v_lshlrev_b32 v29, 4, v8
    v_bfe_u32 v13, v10, 2, 1
    v_cmp_eq_u32 vcc, 1, v13
    s_nop 0
    s_mov_b64 s[76:77], vcc
    v_and_b32 v12, 1, v10
    v_cmp_eq_u32 vcc, 1, v12
    v_mov_b32 v12, 0x3f80
    v_mov_b32 v13, 0x3f800000
    v_cndmask_b32 v12, v12, v13, vcc
    v_lshrrev_b32 v13, 2, v10
    v_cmp_eq_u32 vcc, 0, v13
    s_nop 1
    v_cndmask_b32 v20, 0, v12, vcc
    v_cmp_eq_u32 vcc, 1, v13
    s_nop 1
    v_cndmask_b32 v21, 0, v12, vcc
    v_cmp_eq_u32 vcc, 0, v13
    s_nop 1
    v_cndmask_b32 v22, 0, v12, vcc
    v_cmp_eq_u32 vcc, 1, v13
    s_nop 1
    v_cndmask_b32 v23, 0, v12, vcc
    v_lshrrev_b32 v9, 4, v8
    v_and_b32 v10, 15, v8
    s_and_b32 s66, s3, 1
    s_lshl_b32 s66, s66, 2
    s_or_b32 s66, s66, 0
    v_and_b32 v11, 1, v9
    v_or_b32 v11, s66, v11
    v_lshlrev_b32 v11, 1, v11
    v_xor_b32 v11, v10, v11
    v_lshlrev_b32 v12, 13, v9
    v_lshl_add_u32 v112, v11, 4, v12
    v_or_b32 v11, 0, v9
    v_lshlrev_b32 v11, 1, v11
    v_xor_b32 v11, v10, v11
    v_lshlrev_b32 v12, 10, v9
    v_lshrrev_b32 v13, 2, v11
    v_lshl_add_u32 v12, v13, 8, v12
    v_and_b32 v13, 3, v11
    v_lshl_add_u32 v114, v13, 4, v12
    s_and_b32 s66, s3, 1
    s_lshl_b32 s66, s66, 2
    s_or_b32 s66, s66, 2
    v_and_b32 v11, 1, v9
    v_or_b32 v11, s66, v11
    v_lshlrev_b32 v11, 1, v11
    v_xor_b32 v11, v10, v11
    v_lshlrev_b32 v12, 13, v9
    v_lshl_add_u32 v113, v11, 4, v12
    v_or_b32 v11, 4, v9
    v_lshlrev_b32 v11, 1, v11
    v_xor_b32 v11, v10, v11
    v_lshlrev_b32 v12, 10, v9
    v_lshrrev_b32 v13, 2, v11
    v_lshl_add_u32 v12, v13, 8, v12
    v_and_b32 v13, 3, v11
    v_lshl_add_u32 v115, v13, 4, v12
    v_bfe_u32 v11, v8, 2, 2
    v_and_b32 v12, 3, v8
    v_lshrrev_b32 v13, 5, v8
    v_lshlrev_b32 v13, 3, v13
    v_bfe_u32 v14, v8, 4, 1
    v_lshl_add_u32 v13, v14, 2, v13
    v_lshrrev_b32 v15, 1, v11
    v_add_u32 v13, v13, v15
    v_and_b32 v11, 1, v11
    v_lshl_add_u32 v13, v11, 4, v13
    v_lshl_or_b32 v14, v14, 1, v15
    v_lshl_or_b32 v14, v11, 2, v14
    v_lshlrev_b32 v14, 1, v14
    s_lshl_b32 s66, s3, 2
    s_add_u32 s66, s66, 0
    v_lshrrev_b32 v15, 1, v12
    v_add_u32 v15, s66, v15
    v_xor_b32 v15, v15, v14
    v_lshlrev_b32 v15, 4, v15
    v_lshl_add_u32 v15, v13, 8, v15
    v_and_b32 v11, 1, v12
    v_lshl_add_u32 v116, v11, 3, v15
    s_lshl_b32 s66, s3, 2
    s_add_u32 s66, s66, 2
    v_lshrrev_b32 v15, 1, v12
    v_add_u32 v15, s66, v15
    v_xor_b32 v15, v15, v14
    v_lshlrev_b32 v15, 4, v15
    v_lshl_add_u32 v15, v13, 8, v15
    v_and_b32 v11, 1, v12
    v_lshl_add_u32 v117, v11, 3, v15
    v_bfe_u32 v11, v8, 2, 2
    v_and_b32 v12, 3, v8
    v_lshrrev_b32 v13, 5, v8
    v_lshlrev_b32 v13, 4, v13
    v_bfe_u32 v14, v8, 4, 1
    v_lshl_add_u32 v13, v14, 3, v13
    v_add_u32 v13, v13, v11
    v_lshl_or_b32 v14, v14, 2, v11
    v_lshlrev_b32 v14, 1, v14
    s_lshl_b32 s66, s3, 2
    s_add_u32 s66, s66, 0
    v_lshrrev_b32 v15, 1, v12
    v_add_u32 v15, s66, v15
    v_xor_b32 v15, v15, v14
    v_lshlrev_b32 v15, 4, v15
    v_lshl_add_u32 v15, v13, 8, v15
    v_and_b32 v11, 1, v12
    v_lshl_add_u32 v118, v11, 3, v15
    s_lshl_b32 s66, s3, 2
    s_add_u32 s66, s66, 2
    v_lshrrev_b32 v15, 1, v12
    v_add_u32 v15, s66, v15
    v_xor_b32 v15, v15, v14
    v_lshlrev_b32 v15, 4, v15
    v_lshl_add_u32 v15, v13, 8, v15
    v_and_b32 v11, 1, v12
    v_lshl_add_u32 v119, v11, 3, v15
    s_mov_b32 s36, s8
    s_and_b32 s37, s9, 0xffff
    s_mov_b32 s38, 4194304
    s_mov_b32 s39, 0x20000
    s_mov_b32 s40, s10
    s_and_b32 s41, s11, 0xffff
    s_mov_b32 s42, 4194304
    s_mov_b32 s43, 0x20000
    s_mov_b32 s44, s12
    s_and_b32 s45, s13, 0xffff
    s_mov_b32 s46, 4194304
    s_mov_b32 s47, 0x20000
    s_mov_b32 s80, s14
    s_and_b32 s81, s15, 0xffff
    s_mov_b32 s82, 4194304
    s_mov_b32 s83, 0x20000
    s_lshl_b32 s66, s3, 17
    s_add_u32 s66, s66, s56
    s_lshl_b32 s67, s48, 17
    s_lshl_b32 s68, s3, 14
    s_add_u32 s67, s67, s68
    s_lshl_b32 s68, s3, 12
    s_add_u32 s69, s67, 0
    s_add_u32 m0, s68, 32768
    s_nop 0
    buffer_load_dwordx4 v114, s[80:83], s69 offen nt lds
    s_add_u32 s69, s67, 4096
    s_add_u32 m0, s68, 33792
    s_nop 0
    buffer_load_dwordx4 v114, s[80:83], s69 offen nt lds
    s_add_u32 s69, s67, 8192
    s_add_u32 m0, s68, 34816
    s_nop 0
    buffer_load_dwordx4 v115, s[80:83], s69 offen nt lds
    s_add_u32 s69, s67, 12288
    s_add_u32 m0, s68, 35840
    s_nop 0
    buffer_load_dwordx4 v115, s[80:83], s69 offen nt lds
    s_add_u32 s69, s67, 64
    s_add_u32 m0, s68, 49152
    s_nop 0
    buffer_load_dwordx4 v114, s[80:83], s69 offen nt lds
    s_add_u32 s69, s67, 4160
    s_add_u32 m0, s68, 50176
    s_nop 0
    buffer_load_dwordx4 v114, s[80:83], s69 offen nt lds
    s_add_u32 s69, s67, 8256
    s_add_u32 m0, s68, 51200
    s_nop 0
    buffer_load_dwordx4 v115, s[80:83], s69 offen nt lds
    s_add_u32 s69, s67, 12352
    s_add_u32 m0, s68, 52224
    s_nop 0
    buffer_load_dwordx4 v115, s[80:83], s69 offen nt lds
    s_add_u32 s69, s67, 128
    s_add_u32 m0, s68, 65536
    s_nop 0
    buffer_load_dwordx4 v114, s[80:83], s69 offen nt lds
    s_add_u32 s69, s67, 4224
    s_add_u32 m0, s68, 66560
    s_nop 0
    buffer_load_dwordx4 v114, s[80:83], s69 offen nt lds
    s_add_u32 s69, s67, 8320
    s_add_u32 m0, s68, 67584
    s_nop 0
    buffer_load_dwordx4 v115, s[80:83], s69 offen nt lds
    s_add_u32 s69, s67, 12416
    s_add_u32 m0, s68, 68608
    s_nop 0
    buffer_load_dwordx4 v115, s[80:83], s69 offen nt lds
    s_add_u32 s69, s67, 192
    s_add_u32 m0, s68, 81920
    s_nop 0
    buffer_load_dwordx4 v114, s[80:83], s69 offen nt lds
    s_add_u32 s69, s67, 4288
    s_add_u32 m0, s68, 82944
    s_nop 0
    buffer_load_dwordx4 v114, s[80:83], s69 offen nt lds
    s_add_u32 s69, s67, 8384
    s_add_u32 m0, s68, 83968
    s_nop 0
    buffer_load_dwordx4 v115, s[80:83], s69 offen nt lds
    s_add_u32 s69, s67, 12480
    s_add_u32 m0, s68, 84992
    s_nop 0
    buffer_load_dwordx4 v115, s[80:83], s69 offen nt lds
    s_add_u32 s69, s67, 65536
    s_add_u32 m0, s68, 98304
    s_nop 0
    buffer_load_dwordx4 v114, s[80:83], s69 offen nt lds
    s_add_u32 s69, s67, 69632
    s_add_u32 m0, s68, 99328
    s_nop 0
    buffer_load_dwordx4 v114, s[80:83], s69 offen nt lds
    s_add_u32 s69, s67, 73728
    s_add_u32 m0, s68, 100352
    s_nop 0
    buffer_load_dwordx4 v115, s[80:83], s69 offen nt lds
    s_add_u32 s69, s67, 77824
    s_add_u32 m0, s68, 101376
    s_nop 0
    buffer_load_dwordx4 v115, s[80:83], s69 offen nt lds
    s_add_u32 s69, s67, 65600
    s_add_u32 m0, s68, 114688
    s_nop 0
    buffer_load_dwordx4 v114, s[80:83], s69 offen nt lds
    s_add_u32 s69, s67, 69696
    s_add_u32 m0, s68, 115712
    s_nop 0
    buffer_load_dwordx4 v114, s[80:83], s69 offen nt lds
    s_add_u32 s69, s67, 73792
    s_add_u32 m0, s68, 116736
    s_nop 0
    buffer_load_dwordx4 v115, s[80:83], s69 offen nt lds
    s_add_u32 s69, s67, 77888
    s_add_u32 m0, s68, 117760
    s_nop 0
    buffer_load_dwordx4 v115, s[80:83], s69 offen nt lds
    s_add_u32 s69, s67, 65664
    s_add_u32 m0, s68, 131072
    s_nop 0
    buffer_load_dwordx4 v114, s[80:83], s69 offen nt lds
    s_add_u32 s69, s67, 69760
    s_add_u32 m0, s68, 132096
    s_nop 0
    buffer_load_dwordx4 v114, s[80:83], s69 offen nt lds
    s_add_u32 s69, s67, 73856
    s_add_u32 m0, s68, 133120
    s_nop 0
    buffer_load_dwordx4 v115, s[80:83], s69 offen nt lds
    s_add_u32 s69, s67, 77952
    s_add_u32 m0, s68, 134144
    s_nop 0
    buffer_load_dwordx4 v115, s[80:83], s69 offen nt lds
    s_waitcnt vmcnt(24) lgkmcnt(0)
    s_barrier
    s_add_u32 s69, s67, 65728
    s_add_u32 m0, s68, 147456
    s_nop 0
    buffer_load_dwordx4 v114, s[80:83], s69 offen nt lds
    s_add_u32 s69, s67, 69824
    s_add_u32 m0, s68, 148480
    s_nop 0
    buffer_load_dwordx4 v114, s[80:83], s69 offen nt lds
    s_add_u32 s69, s67, 73920
    s_add_u32 m0, s68, 149504
    s_nop 0
    buffer_load_dwordx4 v115, s[80:83], s69 offen nt lds
    s_add_u32 s69, s67, 78016
    s_add_u32 m0, s68, 150528
    s_nop 0
    buffer_load_dwordx4 v115, s[80:83], s69 offen nt lds
    v_add_u32 v12, 32768, v118
    v_add_u32 v13, 32768, v119
    ds_read_b64_tr_b16 v[128:129], v12 offset:0
    ds_read_b64_tr_b16 v[130:131], v12 offset:1024
    ds_read_b64_tr_b16 v[132:133], v12 offset:8192
    ds_read_b64_tr_b16 v[134:135], v12 offset:9216
    ds_read_b64_tr_b16 v[136:137], v13 offset:0
    ds_read_b64_tr_b16 v[138:139], v13 offset:1024
    ds_read_b64_tr_b16 v[140:141], v13 offset:8192
    ds_read_b64_tr_b16 v[142:143], v13 offset:9216
    s_waitcnt vmcnt(24) lgkmcnt(0)
    s_barrier
    s_add_u32 s69, s66, 0
    s_add_u32 m0, s68, 32768
    s_nop 0
    buffer_load_dwordx4 v112, s[36:39], s69 offen nt lds
    s_add_u32 s69, s66, 32768
    s_add_u32 m0, s68, 33792
    s_nop 0
    buffer_load_dwordx4 v113, s[36:39], s69 offen nt lds
    s_add_u32 s69, s66, 65536
    s_add_u32 m0, s68, 34816
    s_nop 0
    buffer_load_dwordx4 v112, s[36:39], s69 offen nt lds
    s_add_u32 s69, s66, 98304
    s_add_u32 m0, s68, 35840
    s_nop 0
    buffer_load_dwordx4 v113, s[36:39], s69 offen nt lds
    v_add_u32 v12, 49152, v118
    v_add_u32 v13, 49152, v119
    ds_read_b64_tr_b16 v[160:161], v12 offset:0
    ds_read_b64_tr_b16 v[162:163], v12 offset:1024
    ds_read_b64_tr_b16 v[164:165], v12 offset:8192
    ds_read_b64_tr_b16 v[166:167], v12 offset:9216
    ds_read_b64_tr_b16 v[168:169], v13 offset:0
    ds_read_b64_tr_b16 v[170:171], v13 offset:1024
    ds_read_b64_tr_b16 v[172:173], v13 offset:8192
    ds_read_b64_tr_b16 v[174:175], v13 offset:9216
    s_waitcnt vmcnt(24) lgkmcnt(0)
    s_barrier
    s_add_u32 s69, s66, 524288
    s_add_u32 m0, s68, 49152
    s_nop 0
    buffer_load_dwordx4 v112, s[36:39], s69 offen nt lds
    s_add_u32 s69, s66, 557056
    s_add_u32 m0, s68, 50176
    s_nop 0
    buffer_load_dwordx4 v113, s[36:39], s69 offen nt lds
    s_add_u32 s69, s66, 589824
    s_add_u32 m0, s68, 51200
    s_nop 0
    buffer_load_dwordx4 v112, s[36:39], s69 offen nt lds
    s_add_u32 s69, s66, 622592
    s_add_u32 m0, s68, 52224
    s_nop 0
    buffer_load_dwordx4 v113, s[36:39], s69 offen nt lds
    v_add_u32 v12, 65536, v118
    v_add_u32 v13, 65536, v119
    ds_read_b64_tr_b16 v[192:193], v12 offset:0
    ds_read_b64_tr_b16 v[194:195], v12 offset:1024
    ds_read_b64_tr_b16 v[196:197], v12 offset:8192
    ds_read_b64_tr_b16 v[198:199], v12 offset:9216
    ds_read_b64_tr_b16 v[200:201], v13 offset:0
    ds_read_b64_tr_b16 v[202:203], v13 offset:1024
    ds_read_b64_tr_b16 v[204:205], v13 offset:8192
    ds_read_b64_tr_b16 v[206:207], v13 offset:9216
    s_waitcnt vmcnt(24) lgkmcnt(0)
    s_barrier
    s_add_u32 s69, s66, 1048576
    s_add_u32 m0, s68, 65536
    s_nop 0
    buffer_load_dwordx4 v112, s[36:39], s69 offen nt lds
    s_add_u32 s69, s66, 1081344
    s_add_u32 m0, s68, 66560
    s_nop 0
    buffer_load_dwordx4 v113, s[36:39], s69 offen nt lds
    s_add_u32 s69, s66, 1114112
    s_add_u32 m0, s68, 67584
    s_nop 0
    buffer_load_dwordx4 v112, s[36:39], s69 offen nt lds
    s_add_u32 s69, s66, 1146880
    s_add_u32 m0, s68, 68608
    s_nop 0
    buffer_load_dwordx4 v113, s[36:39], s69 offen nt lds
    v_add_u32 v12, 81920, v118
    v_add_u32 v13, 81920, v119
    ds_read_b64_tr_b16 v[224:225], v12 offset:0
    ds_read_b64_tr_b16 v[226:227], v12 offset:1024
    ds_read_b64_tr_b16 v[228:229], v12 offset:8192
    ds_read_b64_tr_b16 v[230:231], v12 offset:9216
    ds_read_b64_tr_b16 v[232:233], v13 offset:0
    ds_read_b64_tr_b16 v[234:235], v13 offset:1024
    ds_read_b64_tr_b16 v[236:237], v13 offset:8192
    ds_read_b64_tr_b16 v[238:239], v13 offset:9216
    s_waitcnt vmcnt(24) lgkmcnt(0)
    s_barrier
    s_add_u32 s69, s66, 1572864
    s_add_u32 m0, s68, 81920
    s_nop 0
    buffer_load_dwordx4 v112, s[36:39], s69 offen nt lds
    s_add_u32 s69, s66, 1605632
    s_add_u32 m0, s68, 82944
    s_nop 0
    buffer_load_dwordx4 v113, s[36:39], s69 offen nt lds
    s_add_u32 s69, s66, 1638400
    s_add_u32 m0, s68, 83968
    s_nop 0
    buffer_load_dwordx4 v112, s[36:39], s69 offen nt lds
    s_add_u32 s69, s66, 1671168
    s_add_u32 m0, s68, 84992
    s_nop 0
    buffer_load_dwordx4 v113, s[36:39], s69 offen nt lds
    v_add_u32 v12, 98304, v118
    v_add_u32 v13, 98304, v119
    ds_read_b64_tr_b16 v[144:145], v12 offset:0
    ds_read_b64_tr_b16 v[146:147], v12 offset:1024
    ds_read_b64_tr_b16 v[148:149], v12 offset:8192
    ds_read_b64_tr_b16 v[150:151], v12 offset:9216
    ds_read_b64_tr_b16 v[152:153], v13 offset:0
    ds_read_b64_tr_b16 v[154:155], v13 offset:1024
    ds_read_b64_tr_b16 v[156:157], v13 offset:8192
    ds_read_b64_tr_b16 v[158:159], v13 offset:9216
    s_waitcnt vmcnt(24) lgkmcnt(0)
    s_barrier
    s_add_u32 s69, s66, 2097152
    s_add_u32 m0, s68, 98304
    s_nop 0
    buffer_load_dwordx4 v112, s[36:39], s69 offen nt lds
    s_add_u32 s69, s66, 2129920
    s_add_u32 m0, s68, 99328
    s_nop 0
    buffer_load_dwordx4 v113, s[36:39], s69 offen nt lds
    s_add_u32 s69, s66, 2162688
    s_add_u32 m0, s68, 100352
    s_nop 0
    buffer_load_dwordx4 v112, s[36:39], s69 offen nt lds
    s_add_u32 s69, s66, 2195456
    s_add_u32 m0, s68, 101376
    s_nop 0
    buffer_load_dwordx4 v113, s[36:39], s69 offen nt lds
    v_add_u32 v12, 114688, v118
    v_add_u32 v13, 114688, v119
    ds_read_b64_tr_b16 v[176:177], v12 offset:0
    ds_read_b64_tr_b16 v[178:179], v12 offset:1024
    ds_read_b64_tr_b16 v[180:181], v12 offset:8192
    ds_read_b64_tr_b16 v[182:183], v12 offset:9216
    ds_read_b64_tr_b16 v[184:185], v13 offset:0
    ds_read_b64_tr_b16 v[186:187], v13 offset:1024
    ds_read_b64_tr_b16 v[188:189], v13 offset:8192
    ds_read_b64_tr_b16 v[190:191], v13 offset:9216
    s_waitcnt vmcnt(24) lgkmcnt(0)
    s_barrier
    s_add_u32 s69, s66, 2621440
    s_add_u32 m0, s68, 114688
    s_nop 0
    buffer_load_dwordx4 v112, s[36:39], s69 offen nt lds
    s_add_u32 s69, s66, 2654208
    s_add_u32 m0, s68, 115712
    s_nop 0
    buffer_load_dwordx4 v113, s[36:39], s69 offen nt lds
    s_add_u32 s69, s66, 2686976
    s_add_u32 m0, s68, 116736
    s_nop 0
    buffer_load_dwordx4 v112, s[36:39], s69 offen nt lds
    s_add_u32 s69, s66, 2719744
    s_add_u32 m0, s68, 117760
    s_nop 0
    buffer_load_dwordx4 v113, s[36:39], s69 offen nt lds
    v_add_u32 v12, 131072, v118
    v_add_u32 v13, 131072, v119
    ds_read_b64_tr_b16 v[208:209], v12 offset:0
    ds_read_b64_tr_b16 v[210:211], v12 offset:1024
    ds_read_b64_tr_b16 v[212:213], v12 offset:8192
    ds_read_b64_tr_b16 v[214:215], v12 offset:9216
    ds_read_b64_tr_b16 v[216:217], v13 offset:0
    ds_read_b64_tr_b16 v[218:219], v13 offset:1024
    ds_read_b64_tr_b16 v[220:221], v13 offset:8192
    ds_read_b64_tr_b16 v[222:223], v13 offset:9216
    s_waitcnt vmcnt(24) lgkmcnt(0)
    s_barrier
    s_add_u32 s69, s66, 3145728
    s_add_u32 m0, s68, 131072
    s_nop 0
    buffer_load_dwordx4 v112, s[36:39], s69 offen nt lds
    s_add_u32 s69, s66, 3178496
    s_add_u32 m0, s68, 132096
    s_nop 0
    buffer_load_dwordx4 v113, s[36:39], s69 offen nt lds
    s_add_u32 s69, s66, 3211264
    s_add_u32 m0, s68, 133120
    s_nop 0
    buffer_load_dwordx4 v112, s[36:39], s69 offen nt lds
    s_add_u32 s69, s66, 3244032
    s_add_u32 m0, s68, 134144
    s_nop 0
    buffer_load_dwordx4 v113, s[36:39], s69 offen nt lds
    v_add_u32 v12, 147456, v118
    v_add_u32 v13, 147456, v119
    ds_read_b64_tr_b16 v[240:241], v12 offset:0
    ds_read_b64_tr_b16 v[242:243], v12 offset:1024
    ds_read_b64_tr_b16 v[244:245], v12 offset:8192
    ds_read_b64_tr_b16 v[246:247], v12 offset:9216
    ds_read_b64_tr_b16 v[248:249], v13 offset:0
    ds_read_b64_tr_b16 v[250:251], v13 offset:1024
    ds_read_b64_tr_b16 v[252:253], v13 offset:8192
    ds_read_b64_tr_b16 v[254:255], v13 offset:9216
    s_waitcnt vmcnt(24) lgkmcnt(0)
    s_barrier
    s_add_u32 s69, s66, 3670016
    s_add_u32 m0, s68, 147456
    s_nop 0
    buffer_load_dwordx4 v112, s[36:39], s69 offen nt lds
    s_add_u32 s69, s66, 3702784
    s_add_u32 m0, s68, 148480
    s_nop 0
    buffer_load_dwordx4 v113, s[36:39], s69 offen nt lds
    s_add_u32 s69, s66, 3735552
    s_add_u32 m0, s68, 149504
    s_nop 0
    buffer_load_dwordx4 v112, s[36:39], s69 offen nt lds
    s_add_u32 s69, s66, 3768320
    s_add_u32 m0, s68, 150528
    s_nop 0
    buffer_load_dwordx4 v113, s[36:39], s69 offen nt lds
    v_add_u32 v12, 32768, v116
    v_add_u32 v13, 32768, v117
    s_cmp_eq_u32 s3, 1
    s_cbranch_scc1 L_wv_68
    s_cmp_eq_u32 s3, 2
    s_cbranch_scc1 L_wv_69
    s_cmp_eq_u32 s3, 3
    s_cbranch_scc1 L_wv_70
    ds_read_b64_tr_b16 a[0:1], v12 offset:0
    ds_read_b64_tr_b16 a[2:3], v12 offset:512
    ds_read_b64_tr_b16 a[4:5], v12 offset:8192
    ds_read_b64_tr_b16 a[6:7], v12 offset:8704
    ds_read_b64_tr_b16 a[16:17], v13 offset:0
    ds_read_b64_tr_b16 a[18:19], v13 offset:512
    ds_read_b64_tr_b16 a[20:21], v13 offset:8192
    ds_read_b64_tr_b16 a[22:23], v13 offset:8704
    s_branch L_wve_71
L_wv_68:
    ds_read_b64_tr_b16 v[16:17], v12 offset:0
    ds_read_b64_tr_b16 v[18:19], v12 offset:512
    ds_read_b64_tr_b16 v[20:21], v12 offset:8192
    ds_read_b64_tr_b16 v[22:23], v12 offset:8704
    ds_read_b64_tr_b16 a[64:65], v13 offset:0
    ds_read_b64_tr_b16 a[66:67], v13 offset:512
    ds_read_b64_tr_b16 a[68:69], v13 offset:8192
    ds_read_b64_tr_b16 a[70:71], v13 offset:8704
    s_branch L_wve_71
L_wv_69:
    ds_read_b64_tr_b16 v[120:121], v12 offset:0
    ds_read_b64_tr_b16 v[122:123], v12 offset:512
    ds_read_b64_tr_b16 v[124:125], v12 offset:8192
    ds_read_b64_tr_b16 v[126:127], v12 offset:8704
    s_waitcnt lgkmcnt(0)
    v_add_u32 v10, 16384, v7
    ds_write_b128 v10, v[120:123]
    ds_write_b128 v10, v[124:127] offset:1024
    s_waitcnt lgkmcnt(0)
    ds_read_b64_tr_b16 a[48:49], v13 offset:0
    ds_read_b64_tr_b16 a[50:51], v13 offset:512
    ds_read_b64_tr_b16 a[52:53], v13 offset:8192
    ds_read_b64_tr_b16 a[54:55], v13 offset:8704
    s_branch L_wve_71
L_wv_70:
    ds_read_b64_tr_b16 v[120:121], v12 offset:0
    ds_read_b64_tr_b16 v[122:123], v12 offset:512
    ds_read_b64_tr_b16 v[124:125], v12 offset:8192
    ds_read_b64_tr_b16 v[126:127], v12 offset:8704
    s_waitcnt lgkmcnt(0)
    v_add_u32 v10, 0, v7
    ds_write_b128 v10, v[120:123]
    ds_write_b128 v10, v[124:127] offset:1024
    s_waitcnt lgkmcnt(0)
    ds_read_b64_tr_b16 a[32:33], v13 offset:0
    ds_read_b64_tr_b16 a[34:35], v13 offset:512
    ds_read_b64_tr_b16 a[36:37], v13 offset:8192
    ds_read_b64_tr_b16 a[38:39], v13 offset:8704
L_wve_71:
    s_waitcnt vmcnt(24) lgkmcnt(0)
    s_barrier
    s_add_u32 s69, s66, 0
    s_add_u32 m0, s68, 32768
    s_nop 0
    buffer_load_dwordx4 v112, s[40:43], s69 offen nt lds
    s_add_u32 s69, s66, 32768
    s_add_u32 m0, s68, 33792
    s_nop 0
    buffer_load_dwordx4 v113, s[40:43], s69 offen nt lds
    s_add_u32 s69, s66, 65536
    s_add_u32 m0, s68, 34816
    s_nop 0
    buffer_load_dwordx4 v112, s[40:43], s69 offen nt lds
    s_add_u32 s69, s66, 98304
    s_add_u32 m0, s68, 35840
    s_nop 0
    buffer_load_dwordx4 v113, s[40:43], s69 offen nt lds
    v_add_u32 v12, 49152, v116
    v_add_u32 v13, 49152, v117
    s_cmp_eq_u32 s3, 1
    s_cbranch_scc1 L_wv_73
    s_cmp_eq_u32 s3, 2
    s_cbranch_scc1 L_wv_74
    s_cmp_eq_u32 s3, 3
    s_cbranch_scc1 L_wv_75
    ds_read_b64_tr_b16 a[8:9], v12 offset:0
    ds_read_b64_tr_b16 a[10:11], v12 offset:512
    ds_read_b64_tr_b16 a[12:13], v12 offset:8192
    ds_read_b64_tr_b16 a[14:15], v12 offset:8704
    ds_read_b64_tr_b16 a[24:25], v13 offset:0
    ds_read_b64_tr_b16 a[26:27], v13 offset:512
    ds_read_b64_tr_b16 a[28:29], v13 offset:8192
    ds_read_b64_tr_b16 a[30:31], v13 offset:8704
    s_branch L_wve_76
L_wv_73:
    ds_read_b64_tr_b16 v[24:25], v12 offset:0
    ds_read_b64_tr_b16 v[26:27], v12 offset:512
    ds_read_b64_tr_b16 v[28:29], v12 offset:8192
    ds_read_b64_tr_b16 v[30:31], v12 offset:8704
    ds_read_b64_tr_b16 a[72:73], v13 offset:0
    ds_read_b64_tr_b16 a[74:75], v13 offset:512
    ds_read_b64_tr_b16 a[76:77], v13 offset:8192
    ds_read_b64_tr_b16 a[78:79], v13 offset:8704
    s_branch L_wve_76
L_wv_74:
    ds_read_b64_tr_b16 v[120:121], v12 offset:0
    ds_read_b64_tr_b16 v[122:123], v12 offset:512
    ds_read_b64_tr_b16 v[124:125], v12 offset:8192
    ds_read_b64_tr_b16 v[126:127], v12 offset:8704
    s_waitcnt lgkmcnt(0)
    v_add_u32 v10, 24576, v7
    ds_write_b128 v10, v[120:123]
    ds_write_b128 v10, v[124:127] offset:1024
    s_waitcnt lgkmcnt(0)
    ds_read_b64_tr_b16 a[56:57], v13 offset:0
    ds_read_b64_tr_b16 a[58:59], v13 offset:512
    ds_read_b64_tr_b16 a[60:61], v13 offset:8192
    ds_read_b64_tr_b16 a[62:63], v13 offset:8704
    s_branch L_wve_76
L_wv_75:
    ds_read_b64_tr_b16 v[120:121], v12 offset:0
    ds_read_b64_tr_b16 v[122:123], v12 offset:512
    ds_read_b64_tr_b16 v[124:125], v12 offset:8192
    ds_read_b64_tr_b16 v[126:127], v12 offset:8704
    s_waitcnt lgkmcnt(0)
    v_add_u32 v10, 8192, v7
    ds_write_b128 v10, v[120:123]
    ds_write_b128 v10, v[124:127] offset:1024
    s_waitcnt lgkmcnt(0)
    ds_read_b64_tr_b16 a[40:41], v13 offset:0
    ds_read_b64_tr_b16 a[42:43], v13 offset:512
    ds_read_b64_tr_b16 a[44:45], v13 offset:8192
    ds_read_b64_tr_b16 a[46:47], v13 offset:8704
L_wve_76:
    s_waitcnt vmcnt(24) lgkmcnt(0)
    s_barrier
    s_add_u32 s69, s66, 524288
    s_add_u32 m0, s68, 49152
    s_nop 0
    buffer_load_dwordx4 v112, s[40:43], s69 offen nt lds
    s_add_u32 s69, s66, 557056
    s_add_u32 m0, s68, 50176
    s_nop 0
    buffer_load_dwordx4 v113, s[40:43], s69 offen nt lds
    s_add_u32 s69, s66, 589824
    s_add_u32 m0, s68, 51200
    s_nop 0
    buffer_load_dwordx4 v112, s[40:43], s69 offen nt lds
    s_add_u32 s69, s66, 622592
    s_add_u32 m0, s68, 52224
    s_nop 0
    buffer_load_dwordx4 v113, s[40:43], s69 offen nt lds
    v_add_u32 v12, 65536, v116
    v_add_u32 v13, 65536, v117
    s_cmp_eq_u32 s3, 1
    s_cbranch_scc1 L_wv_78
    s_cmp_eq_u32 s3, 2
    s_cbranch_scc1 L_wv_79
    s_cmp_eq_u32 s3, 3
    s_cbranch_scc1 L_wv_80
    ds_read_b64_tr_b16 v[120:121], v12 offset:0
    ds_read_b64_tr_b16 v[122:123], v12 offset:512
    ds_read_b64_tr_b16 v[124:125], v12 offset:8192
    ds_read_b64_tr_b16 v[126:127], v12 offset:8704
    s_waitcnt lgkmcnt(0)
    v_add_u32 v10, 0, v7
    ds_write_b128 v10, v[120:123]
    ds_write_b128 v10, v[124:127] offset:1024
    s_waitcnt lgkmcnt(0)
    ds_read_b64_tr_b16 a[32:33], v13 offset:0
    ds_read_b64_tr_b16 a[34:35], v13 offset:512
    ds_read_b64_tr_b16 a[36:37], v13 offset:8192
    ds_read_b64_tr_b16 a[38:39], v13 offset:8704
    s_branch L_wve_81
L_wv_78:
    ds_read_b64_tr_b16 a[0:1], v12 offset:0
    ds_read_b64_tr_b16 a[2:3], v12 offset:512
    ds_read_b64_tr_b16 a[4:5], v12 offset:8192
    ds_read_b64_tr_b16 a[6:7], v12 offset:8704
    ds_read_b64_tr_b16 a[16:17], v13 offset:0
    ds_read_b64_tr_b16 a[18:19], v13 offset:512
    ds_read_b64_tr_b16 a[20:21], v13 offset:8192
    ds_read_b64_tr_b16 a[22:23], v13 offset:8704
    s_branch L_wve_81
L_wv_79:
    ds_read_b64_tr_b16 v[16:17], v12 offset:0
    ds_read_b64_tr_b16 v[18:19], v12 offset:512
    ds_read_b64_tr_b16 v[20:21], v12 offset:8192
    ds_read_b64_tr_b16 v[22:23], v12 offset:8704
    ds_read_b64_tr_b16 a[64:65], v13 offset:0
    ds_read_b64_tr_b16 a[66:67], v13 offset:512
    ds_read_b64_tr_b16 a[68:69], v13 offset:8192
    ds_read_b64_tr_b16 a[70:71], v13 offset:8704
    s_branch L_wve_81
L_wv_80:
    ds_read_b64_tr_b16 v[120:121], v12 offset:0
    ds_read_b64_tr_b16 v[122:123], v12 offset:512
    ds_read_b64_tr_b16 v[124:125], v12 offset:8192
    ds_read_b64_tr_b16 v[126:127], v12 offset:8704
    s_waitcnt lgkmcnt(0)
    v_add_u32 v10, 16384, v7
    ds_write_b128 v10, v[120:123]
    ds_write_b128 v10, v[124:127] offset:1024
    s_waitcnt lgkmcnt(0)
    ds_read_b64_tr_b16 a[48:49], v13 offset:0
    ds_read_b64_tr_b16 a[50:51], v13 offset:512
    ds_read_b64_tr_b16 a[52:53], v13 offset:8192
    ds_read_b64_tr_b16 a[54:55], v13 offset:8704
L_wve_81:
    s_waitcnt vmcnt(24) lgkmcnt(0)
    s_barrier
    s_add_u32 s69, s66, 1048576
    s_add_u32 m0, s68, 65536
    s_nop 0
    buffer_load_dwordx4 v112, s[40:43], s69 offen nt lds
    s_add_u32 s69, s66, 1081344
    s_add_u32 m0, s68, 66560
    s_nop 0
    buffer_load_dwordx4 v113, s[40:43], s69 offen nt lds
    s_add_u32 s69, s66, 1114112
    s_add_u32 m0, s68, 67584
    s_nop 0
    buffer_load_dwordx4 v112, s[40:43], s69 offen nt lds
    s_add_u32 s69, s66, 1146880
    s_add_u32 m0, s68, 68608
    s_nop 0
    buffer_load_dwordx4 v113, s[40:43], s69 offen nt lds
    v_add_u32 v12, 81920, v116
    v_add_u32 v13, 81920, v117
    s_cmp_eq_u32 s3, 1
    s_cbranch_scc1 L_wv_83
    s_cmp_eq_u32 s3, 2
    s_cbranch_scc1 L_wv_84
    s_cmp_eq_u32 s3, 3
    s_cbranch_scc1 L_wv_85
    ds_read_b64_tr_b16 v[120:121], v12 offset:0
    ds_read_b64_tr_b16 v[122:123], v12 offset:512
    ds_read_b64_tr_b16 v[124:125], v12 offset:8192
    ds_read_b64_tr_b16 v[126:127], v12 offset:8704
    s_waitcnt lgkmcnt(0)
    v_add_u32 v10, 8192, v7
    ds_write_b128 v10, v[120:123]
    ds_write_b128 v10, v[124:127] offset:1024
    s_waitcnt lgkmcnt(0)
    ds_read_b64_tr_b16 a[40:41], v13 offset:0
    ds_read_b64_tr_b16 a[42:43], v13 offset:512
    ds_read_b64_tr_b16 a[44:45], v13 offset:8192
    ds_read_b64_tr_b16 a[46:47], v13 offset:8704
    s_branch L_wve_86
L_wv_83:
    ds_read_b64_tr_b16 a[8:9], v12 offset:0
    ds_read_b64_tr_b16 a[10:11], v12 offset:512
    ds_read_b64_tr_b16 a[12:13], v12 offset:8192
    ds_read_b64_tr_b16 a[14:15], v12 offset:8704
    ds_read_b64_tr_b16 a[24:25], v13 offset:0
    ds_read_b64_tr_b16 a[26:27], v13 offset:512
    ds_read_b64_tr_b16 a[28:29], v13 offset:8192
    ds_read_b64_tr_b16 a[30:31], v13 offset:8704
    s_branch L_wve_86
L_wv_84:
    ds_read_b64_tr_b16 v[24:25], v12 offset:0
    ds_read_b64_tr_b16 v[26:27], v12 offset:512
    ds_read_b64_tr_b16 v[28:29], v12 offset:8192
    ds_read_b64_tr_b16 v[30:31], v12 offset:8704
    ds_read_b64_tr_b16 a[72:73], v13 offset:0
    ds_read_b64_tr_b16 a[74:75], v13 offset:512
    ds_read_b64_tr_b16 a[76:77], v13 offset:8192
    ds_read_b64_tr_b16 a[78:79], v13 offset:8704
    s_branch L_wve_86
L_wv_85:
    ds_read_b64_tr_b16 v[120:121], v12 offset:0
    ds_read_b64_tr_b16 v[122:123], v12 offset:512
    ds_read_b64_tr_b16 v[124:125], v12 offset:8192
    ds_read_b64_tr_b16 v[126:127], v12 offset:8704
    s_waitcnt lgkmcnt(0)
    v_add_u32 v10, 24576, v7
    ds_write_b128 v10, v[120:123]
    ds_write_b128 v10, v[124:127] offset:1024
    s_waitcnt lgkmcnt(0)
    ds_read_b64_tr_b16 a[56:57], v13 offset:0
    ds_read_b64_tr_b16 a[58:59], v13 offset:512
    ds_read_b64_tr_b16 a[60:61], v13 offset:8192
    ds_read_b64_tr_b16 a[62:63], v13 offset:8704
L_wve_86:
    s_waitcnt vmcnt(24) lgkmcnt(0)
    s_barrier
    s_add_u32 s69, s66, 1572864
    s_add_u32 m0, s68, 81920
    s_nop 0
    buffer_load_dwordx4 v112, s[40:43], s69 offen nt lds
    s_add_u32 s69, s66, 1605632
    s_add_u32 m0, s68, 82944
    s_nop 0
    buffer_load_dwordx4 v113, s[40:43], s69 offen nt lds
    s_add_u32 s69, s66, 1638400
    s_add_u32 m0, s68, 83968
    s_nop 0
    buffer_load_dwordx4 v112, s[40:43], s69 offen nt lds
    s_add_u32 s69, s66, 1671168
    s_add_u32 m0, s68, 84992
    s_nop 0
    buffer_load_dwordx4 v113, s[40:43], s69 offen nt lds
    v_add_u32 v12, 98304, v116
    v_add_u32 v13, 98304, v117
    s_cmp_eq_u32 s3, 1
    s_cbranch_scc1 L_wv_88
    s_cmp_eq_u32 s3, 2
    s_cbranch_scc1 L_wv_89
    s_cmp_eq_u32 s3, 3
    s_cbranch_scc1 L_wv_90
    ds_read_b64_tr_b16 v[120:121], v12 offset:0
    ds_read_b64_tr_b16 v[122:123], v12 offset:512
    ds_read_b64_tr_b16 v[124:125], v12 offset:8192
    ds_read_b64_tr_b16 v[126:127], v12 offset:8704
    s_waitcnt lgkmcnt(0)
    v_add_u32 v10, 16384, v7
    ds_write_b128 v10, v[120:123]
    ds_write_b128 v10, v[124:127] offset:1024
    s_waitcnt lgkmcnt(0)
    ds_read_b64_tr_b16 a[48:49], v13 offset:0
    ds_read_b64_tr_b16 a[50:51], v13 offset:512
    ds_read_b64_tr_b16 a[52:53], v13 offset:8192
    ds_read_b64_tr_b16 a[54:55], v13 offset:8704
    s_branch L_wve_91
L_wv_88:
    ds_read_b64_tr_b16 v[120:121], v12 offset:0
    ds_read_b64_tr_b16 v[122:123], v12 offset:512
    ds_read_b64_tr_b16 v[124:125], v12 offset:8192
    ds_read_b64_tr_b16 v[126:127], v12 offset:8704
    s_waitcnt lgkmcnt(0)
    v_add_u32 v10, 0, v7
    ds_write_b128 v10, v[120:123]
    ds_write_b128 v10, v[124:127] offset:1024
    s_waitcnt lgkmcnt(0)
    ds_read_b64_tr_b16 a[32:33], v13 offset:0
    ds_read_b64_tr_b16 a[34:35], v13 offset:512
    ds_read_b64_tr_b16 a[36:37], v13 offset:8192
    ds_read_b64_tr_b16 a[38:39], v13 offset:8704
    s_branch L_wve_91
L_wv_89:
    ds_read_b64_tr_b16 a[0:1], v12 offset:0
    ds_read_b64_tr_b16 a[2:3], v12 offset:512
    ds_read_b64_tr_b16 a[4:5], v12 offset:8192
    ds_read_b64_tr_b16 a[6:7], v12 offset:8704
    ds_read_b64_tr_b16 a[16:17], v13 offset:0
    ds_read_b64_tr_b16 a[18:19], v13 offset:512
    ds_read_b64_tr_b16 a[20:21], v13 offset:8192
    ds_read_b64_tr_b16 a[22:23], v13 offset:8704
    s_branch L_wve_91
L_wv_90:
    ds_read_b64_tr_b16 v[16:17], v12 offset:0
    ds_read_b64_tr_b16 v[18:19], v12 offset:512
    ds_read_b64_tr_b16 v[20:21], v12 offset:8192
    ds_read_b64_tr_b16 v[22:23], v12 offset:8704
    ds_read_b64_tr_b16 a[64:65], v13 offset:0
    ds_read_b64_tr_b16 a[66:67], v13 offset:512
    ds_read_b64_tr_b16 a[68:69], v13 offset:8192
    ds_read_b64_tr_b16 a[70:71], v13 offset:8704
L_wve_91:
    s_waitcnt vmcnt(24) lgkmcnt(0)
    s_barrier
    s_add_u32 s69, s66, 2097152
    s_add_u32 m0, s68, 98304
    s_nop 0
    buffer_load_dwordx4 v112, s[40:43], s69 offen nt lds
    s_add_u32 s69, s66, 2129920
    s_add_u32 m0, s68, 99328
    s_nop 0
    buffer_load_dwordx4 v113, s[40:43], s69 offen nt lds
    s_add_u32 s69, s66, 2162688
    s_add_u32 m0, s68, 100352
    s_nop 0
    buffer_load_dwordx4 v112, s[40:43], s69 offen nt lds
    s_add_u32 s69, s66, 2195456
    s_add_u32 m0, s68, 101376
    s_nop 0
    buffer_load_dwordx4 v113, s[40:43], s69 offen nt lds
    v_add_u32 v12, 114688, v116
    v_add_u32 v13, 114688, v117
    s_cmp_eq_u32 s3, 1
    s_cbranch_scc1 L_wv_93
    s_cmp_eq_u32 s3, 2
    s_cbranch_scc1 L_wv_94
    s_cmp_eq_u32 s3, 3
    s_cbranch_scc1 L_wv_95
    ds_read_b64_tr_b16 v[120:121], v12 offset:0
    ds_read_b64_tr_b16 v[122:123], v12 offset:512
    ds_read_b64_tr_b16 v[124:125], v12 offset:8192
    ds_read_b64_tr_b16 v[126:127], v12 offset:8704
    s_waitcnt lgkmcnt(0)
    v_add_u32 v10, 24576, v7
    ds_write_b128 v10, v[120:123]
    ds_write_b128 v10, v[124:127] offset:1024
    s_waitcnt lgkmcnt(0)
    ds_read_b64_tr_b16 a[56:57], v13 offset:0
    ds_read_b64_tr_b16 a[58:59], v13 offset:512
    ds_read_b64_tr_b16 a[60:61], v13 offset:8192
    ds_read_b64_tr_b16 a[62:63], v13 offset:8704
    s_branch L_wve_96
L_wv_93:
    ds_read_b64_tr_b16 v[120:121], v12 offset:0
    ds_read_b64_tr_b16 v[122:123], v12 offset:512
    ds_read_b64_tr_b16 v[124:125], v12 offset:8192
    ds_read_b64_tr_b16 v[126:127], v12 offset:8704
    s_waitcnt lgkmcnt(0)
    v_add_u32 v10, 8192, v7
    ds_write_b128 v10, v[120:123]
    ds_write_b128 v10, v[124:127] offset:1024
    s_waitcnt lgkmcnt(0)
    ds_read_b64_tr_b16 a[40:41], v13 offset:0
    ds_read_b64_tr_b16 a[42:43], v13 offset:512
    ds_read_b64_tr_b16 a[44:45], v13 offset:8192
    ds_read_b64_tr_b16 a[46:47], v13 offset:8704
    s_branch L_wve_96
L_wv_94:
    ds_read_b64_tr_b16 a[8:9], v12 offset:0
    ds_read_b64_tr_b16 a[10:11], v12 offset:512
    ds_read_b64_tr_b16 a[12:13], v12 offset:8192
    ds_read_b64_tr_b16 a[14:15], v12 offset:8704
    ds_read_b64_tr_b16 a[24:25], v13 offset:0
    ds_read_b64_tr_b16 a[26:27], v13 offset:512
    ds_read_b64_tr_b16 a[28:29], v13 offset:8192
    ds_read_b64_tr_b16 a[30:31], v13 offset:8704
    s_branch L_wve_96
L_wv_95:
    ds_read_b64_tr_b16 v[24:25], v12 offset:0
    ds_read_b64_tr_b16 v[26:27], v12 offset:512
    ds_read_b64_tr_b16 v[28:29], v12 offset:8192
    ds_read_b64_tr_b16 v[30:31], v12 offset:8704
    ds_read_b64_tr_b16 a[72:73], v13 offset:0
    ds_read_b64_tr_b16 a[74:75], v13 offset:512
    ds_read_b64_tr_b16 a[76:77], v13 offset:8192
    ds_read_b64_tr_b16 a[78:79], v13 offset:8704
L_wve_96:
    s_waitcnt vmcnt(24) lgkmcnt(0)
    s_barrier
    s_add_u32 s69, s66, 2621440
    s_add_u32 m0, s68, 114688
    s_nop 0
    buffer_load_dwordx4 v112, s[40:43], s69 offen nt lds
    s_add_u32 s69, s66, 2654208
    s_add_u32 m0, s68, 115712
    s_nop 0
    buffer_load_dwordx4 v113, s[40:43], s69 offen nt lds
    s_add_u32 s69, s66, 2686976
    s_add_u32 m0, s68, 116736
    s_nop 0
    buffer_load_dwordx4 v112, s[40:43], s69 offen nt lds
    s_add_u32 s69, s66, 2719744
    s_add_u32 m0, s68, 117760
    s_nop 0
    buffer_load_dwordx4 v113, s[40:43], s69 offen nt lds
    v_add_u32 v12, 131072, v116
    v_add_u32 v13, 131072, v117
    s_cmp_eq_u32 s3, 1
    s_cbranch_scc1 L_wv_98
    s_cmp_eq_u32 s3, 2
    s_cbranch_scc1 L_wv_99
    s_cmp_eq_u32 s3, 3
    s_cbranch_scc1 L_wv_100
    ds_read_b64_tr_b16 v[16:17], v12 offset:0
    ds_read_b64_tr_b16 v[18:19], v12 offset:512
    ds_read_b64_tr_b16 v[20:21], v12 offset:8192
    ds_read_b64_tr_b16 v[22:23], v12 offset:8704
    ds_read_b64_tr_b16 a[64:65], v13 offset:0
    ds_read_b64_tr_b16 a[66:67], v13 offset:512
    ds_read_b64_tr_b16 a[68:69], v13 offset:8192
    ds_read_b64_tr_b16 a[70:71], v13 offset:8704
    s_branch L_wve_101
L_wv_98:
    ds_read_b64_tr_b16 v[120:121], v12 offset:0
    ds_read_b64_tr_b16 v[122:123], v12 offset:512
    ds_read_b64_tr_b16 v[124:125], v12 offset:8192
    ds_read_b64_tr_b16 v[126:127], v12 offset:8704
    s_waitcnt lgkmcnt(0)
    v_add_u32 v10, 16384, v7
    ds_write_b128 v10, v[120:123]
    ds_write_b128 v10, v[124:127] offset:1024
    s_waitcnt lgkmcnt(0)
    ds_read_b64_tr_b16 a[48:49], v13 offset:0
    ds_read_b64_tr_b16 a[50:51], v13 offset:512
    ds_read_b64_tr_b16 a[52:53], v13 offset:8192
    ds_read_b64_tr_b16 a[54:55], v13 offset:8704
    s_branch L_wve_101
L_wv_99:
    ds_read_b64_tr_b16 v[120:121], v12 offset:0
    ds_read_b64_tr_b16 v[122:123], v12 offset:512
    ds_read_b64_tr_b16 v[124:125], v12 offset:8192
    ds_read_b64_tr_b16 v[126:127], v12 offset:8704
    s_waitcnt lgkmcnt(0)
    v_add_u32 v10, 0, v7
    ds_write_b128 v10, v[120:123]
    ds_write_b128 v10, v[124:127] offset:1024
    s_waitcnt lgkmcnt(0)
    ds_read_b64_tr_b16 a[32:33], v13 offset:0
    ds_read_b64_tr_b16 a[34:35], v13 offset:512
    ds_read_b64_tr_b16 a[36:37], v13 offset:8192
    ds_read_b64_tr_b16 a[38:39], v13 offset:8704
    s_branch L_wve_101
L_wv_100:
    ds_read_b64_tr_b16 a[0:1], v12 offset:0
    ds_read_b64_tr_b16 a[2:3], v12 offset:512
    ds_read_b64_tr_b16 a[4:5], v12 offset:8192
    ds_read_b64_tr_b16 a[6:7], v12 offset:8704
    ds_read_b64_tr_b16 a[16:17], v13 offset:0
    ds_read_b64_tr_b16 a[18:19], v13 offset:512
    ds_read_b64_tr_b16 a[20:21], v13 offset:8192
    ds_read_b64_tr_b16 a[22:23], v13 offset:8704
L_wve_101:
    s_waitcnt vmcnt(24) lgkmcnt(0)
    s_barrier
    s_add_u32 s69, s66, 3145728
    s_add_u32 m0, s68, 131072
    s_nop 0
    buffer_load_dwordx4 v112, s[40:43], s69 offen nt lds
    s_add_u32 s69, s66, 3178496
    s_add_u32 m0, s68, 132096
    s_nop 0
    buffer_load_dwordx4 v113, s[40:43], s69 offen nt lds
    s_add_u32 s69, s66, 3211264
    s_add_u32 m0, s68, 133120
    s_nop 0
    buffer_load_dwordx4 v112, s[40:43], s69 offen nt lds
    s_add_u32 s69, s66, 3244032
    s_add_u32 m0, s68, 134144
    s_nop 0
    buffer_load_dwordx4 v113, s[40:43], s69 offen nt lds
    v_add_u32 v12, 147456, v116
    v_add_u32 v13, 147456, v117
    s_cmp_eq_u32 s3, 1
    s_cbranch_scc1 L_wv_103
    s_cmp_eq_u32 s3, 2
    s_cbranch_scc1 L_wv_104
    s_cmp_eq_u32 s3, 3
    s_cbranch_scc1 L_wv_105
    ds_read_b64_tr_b16 v[24:25], v12 offset:0
    ds_read_b64_tr_b16 v[26:27], v12 offset:512
    ds_read_b64_tr_b16 v[28:29], v12 offset:8192
    ds_read_b64_tr_b16 v[30:31], v12 offset:8704
    ds_read_b64_tr_b16 a[72:73], v13 offset:0
    ds_read_b64_tr_b16 a[74:75], v13 offset:512
    ds_read_b64_tr_b16 a[76:77], v13 offset:8192
    ds_read_b64_tr_b16 a[78:79], v13 offset:8704
    s_branch L_wve_106
L_wv_103:
    ds_read_b64_tr_b16 v[120:121], v12 offset:0
    ds_read_b64_tr_b16 v[122:123], v12 offset:512
    ds_read_b64_tr_b16 v[124:125], v12 offset:8192
    ds_read_b64_tr_b16 v[126:127], v12 offset:8704
    s_waitcnt lgkmcnt(0)
    v_add_u32 v10, 24576, v7
    ds_write_b128 v10, v[120:123]
    ds_write_b128 v10, v[124:127] offset:1024
    s_waitcnt lgkmcnt(0)
    ds_read_b64_tr_b16 a[56:57], v13 offset:0
    ds_read_b64_tr_b16 a[58:59], v13 offset:512
    ds_read_b64_tr_b16 a[60:61], v13 offset:8192
    ds_read_b64_tr_b16 a[62:63], v13 offset:8704
    s_branch L_wve_106
L_wv_104:
    ds_read_b64_tr_b16 v[120:121], v12 offset:0
    ds_read_b64_tr_b16 v[122:123], v12 offset:512
    ds_read_b64_tr_b16 v[124:125], v12 offset:8192
    ds_read_b64_tr_b16 v[126:127], v12 offset:8704
    s_waitcnt lgkmcnt(0)
    v_add_u32 v10, 8192, v7
    ds_write_b128 v10, v[120:123]
    ds_write_b128 v10, v[124:127] offset:1024
    s_waitcnt lgkmcnt(0)
    ds_read_b64_tr_b16 a[40:41], v13 offset:0
    ds_read_b64_tr_b16 a[42:43], v13 offset:512
    ds_read_b64_tr_b16 a[44:45], v13 offset:8192
    ds_read_b64_tr_b16 a[46:47], v13 offset:8704
    s_branch L_wve_106
L_wv_105:
    ds_read_b64_tr_b16 a[8:9], v12 offset:0
    ds_read_b64_tr_b16 a[10:11], v12 offset:512
    ds_read_b64_tr_b16 a[12:13], v12 offset:8192
    ds_read_b64_tr_b16 a[14:15], v12 offset:8704
    ds_read_b64_tr_b16 a[24:25], v13 offset:0
    ds_read_b64_tr_b16 a[26:27], v13 offset:512
    ds_read_b64_tr_b16 a[28:29], v13 offset:8192
    ds_read_b64_tr_b16 a[30:31], v13 offset:8704
L_wve_106:
    s_waitcnt vmcnt(24) lgkmcnt(0)
    s_barrier
    s_add_u32 s69, s66, 3670016
    s_add_u32 m0, s68, 147456
    s_nop 0
    buffer_load_dwordx4 v112, s[40:43], s69 offen nt lds
    s_add_u32 s69, s66, 3702784
    s_add_u32 m0, s68, 148480
    s_nop 0
    buffer_load_dwordx4 v113, s[40:43], s69 offen nt lds
    s_add_u32 s69, s66, 3735552
    s_add_u32 m0, s68, 149504
    s_nop 0
    buffer_load_dwordx4 v112, s[40:43], s69 offen nt lds
    s_add_u32 s69, s66, 3768320
    s_add_u32 m0, s68, 150528
    s_nop 0
    buffer_load_dwordx4 v113, s[40:43], s69 offen nt lds
    v_add_u32 v12, 32768, v116
    v_add_u32 v13, 32768, v117
    s_cmp_eq_u32 s3, 1
    s_cbranch_scc1 L_wv_108
    s_cmp_eq_u32 s3, 2
    s_cbranch_scc1 L_wv_109
    s_cmp_eq_u32 s3, 3
    s_cbranch_scc1 L_wv_110
    ds_read_b64_tr_b16 a[80:81], v12 offset:0
    ds_read_b64_tr_b16 a[82:83], v12 offset:512
    ds_read_b64_tr_b16 a[84:85], v12 offset:8192
    ds_read_b64_tr_b16 a[86:87], v12 offset:8704
    ds_read_b64_tr_b16 a[96:97], v13 offset:0
    ds_read_b64_tr_b16 a[98:99], v13 offset:512
    ds_read_b64_tr_b16 a[100:101], v13 offset:8192
    ds_read_b64_tr_b16 a[102:103], v13 offset:8704
    s_branch L_wve_111
L_wv_108:
    ds_read_b64_tr_b16 v[64:65], v12 offset:0
    ds_read_b64_tr_b16 v[66:67], v12 offset:512
    ds_read_b64_tr_b16 v[68:69], v12 offset:8192
    ds_read_b64_tr_b16 v[70:71], v12 offset:8704
    ds_read_b64_tr_b16 a[144:145], v13 offset:0
    ds_read_b64_tr_b16 a[146:147], v13 offset:512
    ds_read_b64_tr_b16 a[148:149], v13 offset:8192
    ds_read_b64_tr_b16 a[150:151], v13 offset:8704
    s_branch L_wve_111
L_wv_109:
    ds_read_b64_tr_b16 v[48:49], v12 offset:0
    ds_read_b64_tr_b16 v[50:51], v12 offset:512
    ds_read_b64_tr_b16 v[52:53], v12 offset:8192
    ds_read_b64_tr_b16 v[54:55], v12 offset:8704
    ds_read_b64_tr_b16 a[128:129], v13 offset:0
    ds_read_b64_tr_b16 a[130:131], v13 offset:512
    ds_read_b64_tr_b16 a[132:133], v13 offset:8192
    ds_read_b64_tr_b16 a[134:135], v13 offset:8704
    s_branch L_wve_111
L_wv_110:
    ds_read_b64_tr_b16 v[32:33], v12 offset:0
    ds_read_b64_tr_b16 v[34:35], v12 offset:512
    ds_read_b64_tr_b16 v[36:37], v12 offset:8192
    ds_read_b64_tr_b16 v[38:39], v12 offset:8704
    ds_read_b64_tr_b16 a[112:113], v13 offset:0
    ds_read_b64_tr_b16 a[114:115], v13 offset:512
    ds_read_b64_tr_b16 a[116:117], v13 offset:8192
    ds_read_b64_tr_b16 a[118:119], v13 offset:8704
L_wve_111:
    s_waitcnt vmcnt(24) lgkmcnt(0)
    s_barrier
    s_add_u32 s69, s66, 0
    s_add_u32 m0, s68, 32768
    s_nop 0
    buffer_load_dwordx4 v112, s[44:47], s69 offen nt lds
    s_add_u32 s69, s66, 32768
    s_add_u32 m0, s68, 33792
    s_nop 0
    buffer_load_dwordx4 v113, s[44:47], s69 offen nt lds
    s_add_u32 s69, s66, 65536
    s_add_u32 m0, s68, 34816
    s_nop 0
    buffer_load_dwordx4 v112, s[44:47], s69 offen nt lds
    s_add_u32 s69, s66, 98304
    s_add_u32 m0, s68, 35840
    s_nop 0
    buffer_load_dwordx4 v113, s[44:47], s69 offen nt lds
    v_add_u32 v12, 49152, v116
    v_add_u32 v13, 49152, v117
    s_cmp_eq_u32 s3, 1
    s_cbranch_scc1 L_wv_113
    s_cmp_eq_u32 s3, 2
    s_cbranch_scc1 L_wv_114
    s_cmp_eq_u32 s3, 3
    s_cbranch_scc1 L_wv_115
    ds_read_b64_tr_b16 a[88:89], v12 offset:0
    ds_read_b64_tr_b16 a[90:91], v12 offset:512
    ds_read_b64_tr_b16 a[92:93], v12 offset:8192
    ds_read_b64_tr_b16 a[94:95], v12 offset:8704
    ds_read_b64_tr_b16 a[104:105], v13 offset:0
    ds_read_b64_tr_b16 a[106:107], v13 offset:512
    ds_read_b64_tr_b16 a[108:109], v13 offset:8192
    ds_read_b64_tr_b16 a[110:111], v13 offset:8704
    s_branch L_wve_116
L_wv_113:
    ds_read_b64_tr_b16 v[72:73], v12 offset:0
    ds_read_b64_tr_b16 v[74:75], v12 offset:512
    ds_read_b64_tr_b16 v[76:77], v12 offset:8192
    ds_read_b64_tr_b16 v[78:79], v12 offset:8704
    ds_read_b64_tr_b16 a[152:153], v13 offset:0
    ds_read_b64_tr_b16 a[154:155], v13 offset:512
    ds_read_b64_tr_b16 a[156:157], v13 offset:8192
    ds_read_b64_tr_b16 a[158:159], v13 offset:8704
    s_branch L_wve_116
L_wv_114:
    ds_read_b64_tr_b16 v[56:57], v12 offset:0
    ds_read_b64_tr_b16 v[58:59], v12 offset:512
    ds_read_b64_tr_b16 v[60:61], v12 offset:8192
    ds_read_b64_tr_b16 v[62:63], v12 offset:8704
    ds_read_b64_tr_b16 a[136:137], v13 offset:0
    ds_read_b64_tr_b16 a[138:139], v13 offset:512
    ds_read_b64_tr_b16 a[140:141], v13 offset:8192
    ds_read_b64_tr_b16 a[142:143], v13 offset:8704
    s_branch L_wve_116
L_wv_115:
    ds_read_b64_tr_b16 v[40:41], v12 offset:0
    ds_read_b64_tr_b16 v[42:43], v12 offset:512
    ds_read_b64_tr_b16 v[44:45], v12 offset:8192
    ds_read_b64_tr_b16 v[46:47], v12 offset:8704
    ds_read_b64_tr_b16 a[120:121], v13 offset:0
    ds_read_b64_tr_b16 a[122:123], v13 offset:512
    ds_read_b64_tr_b16 a[124:125], v13 offset:8192
    ds_read_b64_tr_b16 a[126:127], v13 offset:8704
L_wve_116:
    s_waitcnt vmcnt(24) lgkmcnt(0)
    s_barrier
    s_add_u32 s69, s66, 524288
    s_add_u32 m0, s68, 49152
    s_nop 0
    buffer_load_dwordx4 v112, s[44:47], s69 offen nt lds
    s_add_u32 s69, s66, 557056
    s_add_u32 m0, s68, 50176
    s_nop 0
    buffer_load_dwordx4 v113, s[44:47], s69 offen nt lds
    s_add_u32 s69, s66, 589824
    s_add_u32 m0, s68, 51200
    s_nop 0
    buffer_load_dwordx4 v112, s[44:47], s69 offen nt lds
    s_add_u32 s69, s66, 622592
    s_add_u32 m0, s68, 52224
    s_nop 0
    buffer_load_dwordx4 v113, s[44:47], s69 offen nt lds
    v_add_u32 v12, 65536, v116
    v_add_u32 v13, 65536, v117
    s_cmp_eq_u32 s3, 1
    s_cbranch_scc1 L_wv_118
    s_cmp_eq_u32 s3, 2
    s_cbranch_scc1 L_wv_119
    s_cmp_eq_u32 s3, 3
    s_cbranch_scc1 L_wv_120
    ds_read_b64_tr_b16 v[32:33], v12 offset:0
    ds_read_b64_tr_b16 v[34:35], v12 offset:512
    ds_read_b64_tr_b16 v[36:37], v12 offset:8192
    ds_read_b64_tr_b16 v[38:39], v12 offset:8704
    ds_read_b64_tr_b16 a[112:113], v13 offset:0
    ds_read_b64_tr_b16 a[114:115], v13 offset:512
    ds_read_b64_tr_b16 a[116:117], v13 offset:8192
    ds_read_b64_tr_b16 a[118:119], v13 offset:8704
    s_branch L_wve_121
L_wv_118:
    ds_read_b64_tr_b16 a[80:81], v12 offset:0
    ds_read_b64_tr_b16 a[82:83], v12 offset:512
    ds_read_b64_tr_b16 a[84:85], v12 offset:8192
    ds_read_b64_tr_b16 a[86:87], v12 offset:8704
    ds_read_b64_tr_b16 a[96:97], v13 offset:0
    ds_read_b64_tr_b16 a[98:99], v13 offset:512
    ds_read_b64_tr_b16 a[100:101], v13 offset:8192
    ds_read_b64_tr_b16 a[102:103], v13 offset:8704
    s_branch L_wve_121
L_wv_119:
    ds_read_b64_tr_b16 v[64:65], v12 offset:0
    ds_read_b64_tr_b16 v[66:67], v12 offset:512
    ds_read_b64_tr_b16 v[68:69], v12 offset:8192
    ds_read_b64_tr_b16 v[70:71], v12 offset:8704
    ds_read_b64_tr_b16 a[144:145], v13 offset:0
    ds_read_b64_tr_b16 a[146:147], v13 offset:512
    ds_read_b64_tr_b16 a[148:149], v13 offset:8192
    ds_read_b64_tr_b16 a[150:151], v13 offset:8704
    s_branch L_wve_121
L_wv_120:
    ds_read_b64_tr_b16 v[48:49], v12 offset:0
    ds_read_b64_tr_b16 v[50:51], v12 offset:512
    ds_read_b64_tr_b16 v[52:53], v12 offset:8192
    ds_read_b64_tr_b16 v[54:55], v12 offset:8704
    ds_read_b64_tr_b16 a[128:129], v13 offset:0
    ds_read_b64_tr_b16 a[130:131], v13 offset:512
    ds_read_b64_tr_b16 a[132:133], v13 offset:8192
    ds_read_b64_tr_b16 a[134:135], v13 offset:8704
L_wve_121:
    s_waitcnt vmcnt(24) lgkmcnt(0)
    s_barrier
    s_add_u32 s69, s66, 1048576
    s_add_u32 m0, s68, 65536
    s_nop 0
    buffer_load_dwordx4 v112, s[44:47], s69 offen nt lds
    s_add_u32 s69, s66, 1081344
    s_add_u32 m0, s68, 66560
    s_nop 0
    buffer_load_dwordx4 v113, s[44:47], s69 offen nt lds
    s_add_u32 s69, s66, 1114112
    s_add_u32 m0, s68, 67584
    s_nop 0
    buffer_load_dwordx4 v112, s[44:47], s69 offen nt lds
    s_add_u32 s69, s66, 1146880
    s_add_u32 m0, s68, 68608
    s_nop 0
    buffer_load_dwordx4 v113, s[44:47], s69 offen nt lds
    v_add_u32 v12, 81920, v116
    v_add_u32 v13, 81920, v117
    s_cmp_eq_u32 s3, 1
    s_cbranch_scc1 L_wv_123
    s_cmp_eq_u32 s3, 2
    s_cbranch_scc1 L_wv_124
    s_cmp_eq_u32 s3, 3
    s_cbranch_scc1 L_wv_125
    ds_read_b64_tr_b16 v[40:41], v12 offset:0
    ds_read_b64_tr_b16 v[42:43], v12 offset:512
    ds_read_b64_tr_b16 v[44:45], v12 offset:8192
    ds_read_b64_tr_b16 v[46:47], v12 offset:8704
    ds_read_b64_tr_b16 a[120:121], v13 offset:0
    ds_read_b64_tr_b16 a[122:123], v13 offset:512
    ds_read_b64_tr_b16 a[124:125], v13 offset:8192
    ds_read_b64_tr_b16 a[126:127], v13 offset:8704
    s_branch L_wve_126
L_wv_123:
    ds_read_b64_tr_b16 a[88:89], v12 offset:0
    ds_read_b64_tr_b16 a[90:91], v12 offset:512
    ds_read_b64_tr_b16 a[92:93], v12 offset:8192
    ds_read_b64_tr_b16 a[94:95], v12 offset:8704
    ds_read_b64_tr_b16 a[104:105], v13 offset:0
    ds_read_b64_tr_b16 a[106:107], v13 offset:512
    ds_read_b64_tr_b16 a[108:109], v13 offset:8192
    ds_read_b64_tr_b16 a[110:111], v13 offset:8704
    s_branch L_wve_126
L_wv_124:
    ds_read_b64_tr_b16 v[72:73], v12 offset:0
    ds_read_b64_tr_b16 v[74:75], v12 offset:512
    ds_read_b64_tr_b16 v[76:77], v12 offset:8192
    ds_read_b64_tr_b16 v[78:79], v12 offset:8704
    ds_read_b64_tr_b16 a[152:153], v13 offset:0
    ds_read_b64_tr_b16 a[154:155], v13 offset:512
    ds_read_b64_tr_b16 a[156:157], v13 offset:8192
    ds_read_b64_tr_b16 a[158:159], v13 offset:8704
    s_branch L_wve_126
L_wv_125:
    ds_read_b64_tr_b16 v[56:57], v12 offset:0
    ds_read_b64_tr_b16 v[58:59], v12 offset:512
    ds_read_b64_tr_b16 v[60:61], v12 offset:8192
    ds_read_b64_tr_b16 v[62:63], v12 offset:8704
    ds_read_b64_tr_b16 a[136:137], v13 offset:0
    ds_read_b64_tr_b16 a[138:139], v13 offset:512
    ds_read_b64_tr_b16 a[140:141], v13 offset:8192
    ds_read_b64_tr_b16 a[142:143], v13 offset:8704
L_wve_126:
    s_waitcnt vmcnt(24) lgkmcnt(0)
    s_barrier
    s_add_u32 s69, s66, 1572864
    s_add_u32 m0, s68, 81920
    s_nop 0
    buffer_load_dwordx4 v112, s[44:47], s69 offen nt lds
    s_add_u32 s69, s66, 1605632
    s_add_u32 m0, s68, 82944
    s_nop 0
    buffer_load_dwordx4 v113, s[44:47], s69 offen nt lds
    s_add_u32 s69, s66, 1638400
    s_add_u32 m0, s68, 83968
    s_nop 0
    buffer_load_dwordx4 v112, s[44:47], s69 offen nt lds
    s_add_u32 s69, s66, 1671168
    s_add_u32 m0, s68, 84992
    s_nop 0
    buffer_load_dwordx4 v113, s[44:47], s69 offen nt lds
    v_add_u32 v12, 98304, v116
    v_add_u32 v13, 98304, v117
    s_cmp_eq_u32 s3, 1
    s_cbranch_scc1 L_wv_128
    s_cmp_eq_u32 s3, 2
    s_cbranch_scc1 L_wv_129
    s_cmp_eq_u32 s3, 3
    s_cbranch_scc1 L_wv_130
    ds_read_b64_tr_b16 v[48:49], v12 offset:0
    ds_read_b64_tr_b16 v[50:51], v12 offset:512
    ds_read_b64_tr_b16 v[52:53], v12 offset:8192
    ds_read_b64_tr_b16 v[54:55], v12 offset:8704
    ds_read_b64_tr_b16 a[128:129], v13 offset:0
    ds_read_b64_tr_b16 a[130:131], v13 offset:512
    ds_read_b64_tr_b16 a[132:133], v13 offset:8192
    ds_read_b64_tr_b16 a[134:135], v13 offset:8704
    s_branch L_wve_131
L_wv_128:
    ds_read_b64_tr_b16 v[32:33], v12 offset:0
    ds_read_b64_tr_b16 v[34:35], v12 offset:512
    ds_read_b64_tr_b16 v[36:37], v12 offset:8192
    ds_read_b64_tr_b16 v[38:39], v12 offset:8704
    ds_read_b64_tr_b16 a[112:113], v13 offset:0
    ds_read_b64_tr_b16 a[114:115], v13 offset:512
    ds_read_b64_tr_b16 a[116:117], v13 offset:8192
    ds_read_b64_tr_b16 a[118:119], v13 offset:8704
    s_branch L_wve_131
L_wv_129:
    ds_read_b64_tr_b16 a[80:81], v12 offset:0
    ds_read_b64_tr_b16 a[82:83], v12 offset:512
    ds_read_b64_tr_b16 a[84:85], v12 offset:8192
    ds_read_b64_tr_b16 a[86:87], v12 offset:8704
    ds_read_b64_tr_b16 a[96:97], v13 offset:0
    ds_read_b64_tr_b16 a[98:99], v13 offset:512
    ds_read_b64_tr_b16 a[100:101], v13 offset:8192
    ds_read_b64_tr_b16 a[102:103], v13 offset:8704
    s_branch L_wve_131
L_wv_130:
    ds_read_b64_tr_b16 v[64:65], v12 offset:0
    ds_read_b64_tr_b16 v[66:67], v12 offset:512
    ds_read_b64_tr_b16 v[68:69], v12 offset:8192
    ds_read_b64_tr_b16 v[70:71], v12 offset:8704
    ds_read_b64_tr_b16 a[144:145], v13 offset:0
    ds_read_b64_tr_b16 a[146:147], v13 offset:512
    ds_read_b64_tr_b16 a[148:149], v13 offset:8192
    ds_read_b64_tr_b16 a[150:151], v13 offset:8704
L_wve_131:
    s_waitcnt vmcnt(24) lgkmcnt(0)
    s_barrier
    s_add_u32 s69, s66, 2097152
    s_add_u32 m0, s68, 98304
    s_nop 0
    buffer_load_dwordx4 v112, s[44:47], s69 offen nt lds
    s_add_u32 s69, s66, 2129920
    s_add_u32 m0, s68, 99328
    s_nop 0
    buffer_load_dwordx4 v113, s[44:47], s69 offen nt lds
    s_add_u32 s69, s66, 2162688
    s_add_u32 m0, s68, 100352
    s_nop 0
    buffer_load_dwordx4 v112, s[44:47], s69 offen nt lds
    s_add_u32 s69, s66, 2195456
    s_add_u32 m0, s68, 101376
    s_nop 0
    buffer_load_dwordx4 v113, s[44:47], s69 offen nt lds
    v_add_u32 v12, 114688, v116
    v_add_u32 v13, 114688, v117
    s_cmp_eq_u32 s3, 1
    s_cbranch_scc1 L_wv_133
    s_cmp_eq_u32 s3, 2
    s_cbranch_scc1 L_wv_134
    s_cmp_eq_u32 s3, 3
    s_cbranch_scc1 L_wv_135
    ds_read_b64_tr_b16 v[56:57], v12 offset:0
    ds_read_b64_tr_b16 v[58:59], v12 offset:512
    ds_read_b64_tr_b16 v[60:61], v12 offset:8192
    ds_read_b64_tr_b16 v[62:63], v12 offset:8704
    ds_read_b64_tr_b16 a[136:137], v13 offset:0
    ds_read_b64_tr_b16 a[138:139], v13 offset:512
    ds_read_b64_tr_b16 a[140:141], v13 offset:8192
    ds_read_b64_tr_b16 a[142:143], v13 offset:8704
    s_branch L_wve_136
L_wv_133:
    ds_read_b64_tr_b16 v[40:41], v12 offset:0
    ds_read_b64_tr_b16 v[42:43], v12 offset:512
    ds_read_b64_tr_b16 v[44:45], v12 offset:8192
    ds_read_b64_tr_b16 v[46:47], v12 offset:8704
    ds_read_b64_tr_b16 a[120:121], v13 offset:0
    ds_read_b64_tr_b16 a[122:123], v13 offset:512
    ds_read_b64_tr_b16 a[124:125], v13 offset:8192
    ds_read_b64_tr_b16 a[126:127], v13 offset:8704
    s_branch L_wve_136
L_wv_134:
    ds_read_b64_tr_b16 a[88:89], v12 offset:0
    ds_read_b64_tr_b16 a[90:91], v12 offset:512
    ds_read_b64_tr_b16 a[92:93], v12 offset:8192
    ds_read_b64_tr_b16 a[94:95], v12 offset:8704
    ds_read_b64_tr_b16 a[104:105], v13 offset:0
    ds_read_b64_tr_b16 a[106:107], v13 offset:512
    ds_read_b64_tr_b16 a[108:109], v13 offset:8192
    ds_read_b64_tr_b16 a[110:111], v13 offset:8704
    s_branch L_wve_136
L_wv_135:
    ds_read_b64_tr_b16 v[72:73], v12 offset:0
    ds_read_b64_tr_b16 v[74:75], v12 offset:512
    ds_read_b64_tr_b16 v[76:77], v12 offset:8192
    ds_read_b64_tr_b16 v[78:79], v12 offset:8704
    ds_read_b64_tr_b16 a[152:153], v13 offset:0
    ds_read_b64_tr_b16 a[154:155], v13 offset:512
    ds_read_b64_tr_b16 a[156:157], v13 offset:8192
    ds_read_b64_tr_b16 a[158:159], v13 offset:8704
L_wve_136:
    s_waitcnt vmcnt(24) lgkmcnt(0)
    s_barrier
    s_add_u32 s69, s66, 2621440
    s_add_u32 m0, s68, 114688
    s_nop 0
    buffer_load_dwordx4 v112, s[44:47], s69 offen nt lds
    s_add_u32 s69, s66, 2654208
    s_add_u32 m0, s68, 115712
    s_nop 0
    buffer_load_dwordx4 v113, s[44:47], s69 offen nt lds
    s_add_u32 s69, s66, 2686976
    s_add_u32 m0, s68, 116736
    s_nop 0
    buffer_load_dwordx4 v112, s[44:47], s69 offen nt lds
    s_add_u32 s69, s66, 2719744
    s_add_u32 m0, s68, 117760
    s_nop 0
    buffer_load_dwordx4 v113, s[44:47], s69 offen nt lds
    v_add_u32 v12, 131072, v116
    v_add_u32 v13, 131072, v117
    s_cmp_eq_u32 s3, 1
    s_cbranch_scc1 L_wv_138
    s_cmp_eq_u32 s3, 2
    s_cbranch_scc1 L_wv_139
    s_cmp_eq_u32 s3, 3
    s_cbranch_scc1 L_wv_140
    ds_read_b64_tr_b16 v[64:65], v12 offset:0
    ds_read_b64_tr_b16 v[66:67], v12 offset:512
    ds_read_b64_tr_b16 v[68:69], v12 offset:8192
    ds_read_b64_tr_b16 v[70:71], v12 offset:8704
    ds_read_b64_tr_b16 a[144:145], v13 offset:0
    ds_read_b64_tr_b16 a[146:147], v13 offset:512
    ds_read_b64_tr_b16 a[148:149], v13 offset:8192
    ds_read_b64_tr_b16 a[150:151], v13 offset:8704
    s_branch L_wve_141
L_wv_138:
    ds_read_b64_tr_b16 v[48:49], v12 offset:0
    ds_read_b64_tr_b16 v[50:51], v12 offset:512
    ds_read_b64_tr_b16 v[52:53], v12 offset:8192
    ds_read_b64_tr_b16 v[54:55], v12 offset:8704
    ds_read_b64_tr_b16 a[128:129], v13 offset:0
    ds_read_b64_tr_b16 a[130:131], v13 offset:512
    ds_read_b64_tr_b16 a[132:133], v13 offset:8192
    ds_read_b64_tr_b16 a[134:135], v13 offset:8704
    s_branch L_wve_141
L_wv_139:
    ds_read_b64_tr_b16 v[32:33], v12 offset:0
    ds_read_b64_tr_b16 v[34:35], v12 offset:512
    ds_read_b64_tr_b16 v[36:37], v12 offset:8192
    ds_read_b64_tr_b16 v[38:39], v12 offset:8704
    ds_read_b64_tr_b16 a[112:113], v13 offset:0
    ds_read_b64_tr_b16 a[114:115], v13 offset:512
    ds_read_b64_tr_b16 a[116:117], v13 offset:8192
    ds_read_b64_tr_b16 a[118:119], v13 offset:8704
    s_branch L_wve_141
L_wv_140:
    ds_read_b64_tr_b16 a[80:81], v12 offset:0
    ds_read_b64_tr_b16 a[82:83], v12 offset:512
    ds_read_b64_tr_b16 a[84:85], v12 offset:8192
    ds_read_b64_tr_b16 a[86:87], v12 offset:8704
    ds_read_b64_tr_b16 a[96:97], v13 offset:0
    ds_read_b64_tr_b16 a[98:99], v13 offset:512
    ds_read_b64_tr_b16 a[100:101], v13 offset:8192
    ds_read_b64_tr_b16 a[102:103], v13 offset:8704
L_wve_141:
    s_waitcnt vmcnt(24) lgkmcnt(0)
    s_barrier
    s_add_u32 s69, s66, 3145728
    s_add_u32 m0, s68, 131072
    s_nop 0
    buffer_load_dwordx4 v112, s[44:47], s69 offen nt lds
    s_add_u32 s69, s66, 3178496
    s_add_u32 m0, s68, 132096
    s_nop 0
    buffer_load_dwordx4 v113, s[44:47], s69 offen nt lds
    s_add_u32 s69, s66, 3211264
    s_add_u32 m0, s68, 133120
    s_nop 0
    buffer_load_dwordx4 v112, s[44:47], s69 offen nt lds
    s_add_u32 s69, s66, 3244032
    s_add_u32 m0, s68, 134144
    s_nop 0
    buffer_load_dwordx4 v113, s[44:47], s69 offen nt lds
    v_add_u32 v12, 147456, v116
    v_add_u32 v13, 147456, v117
    s_cmp_eq_u32 s3, 1
    s_cbranch_scc1 L_wv_143
    s_cmp_eq_u32 s3, 2
    s_cbranch_scc1 L_wv_144
    s_cmp_eq_u32 s3, 3
    s_cbranch_scc1 L_wv_145
    ds_read_b64_tr_b16 v[72:73], v12 offset:0
    ds_read_b64_tr_b16 v[74:75], v12 offset:512
    ds_read_b64_tr_b16 v[76:77], v12 offset:8192
    ds_read_b64_tr_b16 v[78:79], v12 offset:8704
    ds_read_b64_tr_b16 a[152:153], v13 offset:0
    ds_read_b64_tr_b16 a[154:155], v13 offset:512
    ds_read_b64_tr_b16 a[156:157], v13 offset:8192
    ds_read_b64_tr_b16 a[158:159], v13 offset:8704
    s_branch L_wve_146
L_wv_143:
    ds_read_b64_tr_b16 v[56:57], v12 offset:0
    ds_read_b64_tr_b16 v[58:59], v12 offset:512
    ds_read_b64_tr_b16 v[60:61], v12 offset:8192
    ds_read_b64_tr_b16 v[62:63], v12 offset:8704
    ds_read_b64_tr_b16 a[136:137], v13 offset:0
    ds_read_b64_tr_b16 a[138:139], v13 offset:512
    ds_read_b64_tr_b16 a[140:141], v13 offset:8192
    ds_read_b64_tr_b16 a[142:143], v13 offset:8704
    s_branch L_wve_146
L_wv_144:
    ds_read_b64_tr_b16 v[40:41], v12 offset:0
    ds_read_b64_tr_b16 v[42:43], v12 offset:512
    ds_read_b64_tr_b16 v[44:45], v12 offset:8192
    ds_read_b64_tr_b16 v[46:47], v12 offset:8704
    ds_read_b64_tr_b16 a[120:121], v13 offset:0
    ds_read_b64_tr_b16 a[122:123], v13 offset:512
    ds_read_b64_tr_b16 a[124:125], v13 offset:8192
    ds_read_b64_tr_b16 a[126:127], v13 offset:8704
    s_branch L_wve_146
L_wv_145:
    ds_read_b64_tr_b16 a[88:89], v12 offset:0
    ds_read_b64_tr_b16 a[90:91], v12 offset:512
    ds_read_b64_tr_b16 a[92:93], v12 offset:8192
    ds_read_b64_tr_b16 a[94:95], v12 offset:8704
    ds_read_b64_tr_b16 a[104:105], v13 offset:0
    ds_read_b64_tr_b16 a[106:107], v13 offset:512
    ds_read_b64_tr_b16 a[108:109], v13 offset:8192
    ds_read_b64_tr_b16 a[110:111], v13 offset:8704
L_wve_146:
    s_waitcnt vmcnt(24) lgkmcnt(0)
    s_barrier
    s_add_u32 s69, s66, 3670016
    s_add_u32 m0, s68, 147456
    s_nop 0
    buffer_load_dwordx4 v112, s[44:47], s69 offen nt lds
    s_add_u32 s69, s66, 3702784
    s_add_u32 m0, s68, 148480
    s_nop 0
    buffer_load_dwordx4 v113, s[44:47], s69 offen nt lds
    s_add_u32 s69, s66, 3735552
    s_add_u32 m0, s68, 149504
    s_nop 0
    buffer_load_dwordx4 v112, s[44:47], s69 offen nt lds
    s_add_u32 s69, s66, 3768320
    s_add_u32 m0, s68, 150528
    s_nop 0
    buffer_load_dwordx4 v113, s[44:47], s69 offen nt lds
    v_add_u32 v12, 32768, v116
    v_add_u32 v13, 32768, v117
    s_cmp_eq_u32 s3, 1
    s_cbranch_scc1 L_wv_148
    s_cmp_eq_u32 s3, 2
    s_cbranch_scc1 L_wv_149
    s_cmp_eq_u32 s3, 3
    s_cbranch_scc1 L_wv_150
    ds_read_b64_tr_b16 a[160:161], v12 offset:0
    ds_read_b64_tr_b16 a[162:163], v12 offset:512
    ds_read_b64_tr_b16 a[164:165], v12 offset:8192
    ds_read_b64_tr_b16 a[166:167], v12 offset:8704
    ds_read_b64_tr_b16 a[192:193], v13 offset:0
    ds_read_b64_tr_b16 a[194:195], v13 offset:512
    ds_read_b64_tr_b16 a[196:197], v13 offset:8192
    ds_read_b64_tr_b16 a[198:199], v13 offset:8704
    s_branch L_wve_151
L_wv_148:
    ds_read_b64_tr_b16 a[176:177], v12 offset:0
    ds_read_b64_tr_b16 a[178:179], v12 offset:512
    ds_read_b64_tr_b16 a[180:181], v12 offset:8192
    ds_read_b64_tr_b16 a[182:183], v12 offset:8704
    ds_read_b64_tr_b16 a[240:241], v13 offset:0
    ds_read_b64_tr_b16 a[242:243], v13 offset:512
    ds_read_b64_tr_b16 a[244:245], v13 offset:8192
    ds_read_b64_tr_b16 a[246:247], v13 offset:8704
    s_branch L_wve_151
L_wv_149:
    ds_read_b64_tr_b16 v[96:97], v12 offset:0
    ds_read_b64_tr_b16 v[98:99], v12 offset:512
    ds_read_b64_tr_b16 v[100:101], v12 offset:8192
    ds_read_b64_tr_b16 v[102:103], v12 offset:8704
    ds_read_b64_tr_b16 a[224:225], v13 offset:0
    ds_read_b64_tr_b16 a[226:227], v13 offset:512
    ds_read_b64_tr_b16 a[228:229], v13 offset:8192
    ds_read_b64_tr_b16 a[230:231], v13 offset:8704
    s_branch L_wve_151
L_wv_150:
    ds_read_b64_tr_b16 v[80:81], v12 offset:0
    ds_read_b64_tr_b16 v[82:83], v12 offset:512
    ds_read_b64_tr_b16 v[84:85], v12 offset:8192
    ds_read_b64_tr_b16 v[86:87], v12 offset:8704
    ds_read_b64_tr_b16 a[208:209], v13 offset:0
    ds_read_b64_tr_b16 a[210:211], v13 offset:512
    ds_read_b64_tr_b16 a[212:213], v13 offset:8192
    ds_read_b64_tr_b16 a[214:215], v13 offset:8704
L_wve_151:
    s_waitcnt vmcnt(24) lgkmcnt(0)
    s_barrier
    v_add_u32 v12, 49152, v116
    v_add_u32 v13, 49152, v117
    s_cmp_eq_u32 s3, 1
    s_cbranch_scc1 L_wv_153
    s_cmp_eq_u32 s3, 2
    s_cbranch_scc1 L_wv_154
    s_cmp_eq_u32 s3, 3
    s_cbranch_scc1 L_wv_155
    ds_read_b64_tr_b16 a[168:169], v12 offset:0
    ds_read_b64_tr_b16 a[170:171], v12 offset:512
    ds_read_b64_tr_b16 a[172:173], v12 offset:8192
    ds_read_b64_tr_b16 a[174:175], v12 offset:8704
    ds_read_b64_tr_b16 a[200:201], v13 offset:0
    ds_read_b64_tr_b16 a[202:203], v13 offset:512
    ds_read_b64_tr_b16 a[204:205], v13 offset:8192
    ds_read_b64_tr_b16 a[206:207], v13 offset:8704
    s_branch L_wve_156
L_wv_153:
    ds_read_b64_tr_b16 a[184:185], v12 offset:0
    ds_read_b64_tr_b16 a[186:187], v12 offset:512
    ds_read_b64_tr_b16 a[188:189], v12 offset:8192
    ds_read_b64_tr_b16 a[190:191], v12 offset:8704
    ds_read_b64_tr_b16 a[248:249], v13 offset:0
    ds_read_b64_tr_b16 a[250:251], v13 offset:512
    ds_read_b64_tr_b16 a[252:253], v13 offset:8192
    ds_read_b64_tr_b16 a[254:255], v13 offset:8704
    s_branch L_wve_156
L_wv_154:
    ds_read_b64_tr_b16 v[104:105], v12 offset:0
    ds_read_b64_tr_b16 v[106:107], v12 offset:512
    ds_read_b64_tr_b16 v[108:109], v12 offset:8192
    ds_read_b64_tr_b16 v[110:111], v12 offset:8704
    ds_read_b64_tr_b16 a[232:233], v13 offset:0
    ds_read_b64_tr_b16 a[234:235], v13 offset:512
    ds_read_b64_tr_b16 a[236:237], v13 offset:8192
    ds_read_b64_tr_b16 a[238:239], v13 offset:8704
    s_branch L_wve_156
L_wv_155:
    ds_read_b64_tr_b16 v[88:89], v12 offset:0
    ds_read_b64_tr_b16 v[90:91], v12 offset:512
    ds_read_b64_tr_b16 v[92:93], v12 offset:8192
    ds_read_b64_tr_b16 v[94:95], v12 offset:8704
    ds_read_b64_tr_b16 a[216:217], v13 offset:0
    ds_read_b64_tr_b16 a[218:219], v13 offset:512
    ds_read_b64_tr_b16 a[220:221], v13 offset:8192
    ds_read_b64_tr_b16 a[222:223], v13 offset:8704
L_wve_156:
    s_waitcnt vmcnt(20) lgkmcnt(0)
    s_barrier
    v_add_u32 v12, 65536, v116
    v_add_u32 v13, 65536, v117
    s_cmp_eq_u32 s3, 1
    s_cbranch_scc1 L_wv_158
    s_cmp_eq_u32 s3, 2
    s_cbranch_scc1 L_wv_159
    s_cmp_eq_u32 s3, 3
    s_cbranch_scc1 L_wv_160
    ds_read_b64_tr_b16 v[80:81], v12 offset:0
    ds_read_b64_tr_b16 v[82:83], v12 offset:512
    ds_read_b64_tr_b16 v[84:85], v12 offset:8192
    ds_read_b64_tr_b16 v[86:87], v12 offset:8704
    ds_read_b64_tr_b16 a[208:209], v13 offset:0
    ds_read_b64_tr_b16 a[210:211], v13 offset:512
    ds_read_b64_tr_b16 a[212:213], v13 offset:8192
    ds_read_b64_tr_b16 a[214:215], v13 offset:8704
    s_branch L_wve_161
L_wv_158:
    ds_read_b64_tr_b16 a[160:161], v12 offset:0
    ds_read_b64_tr_b16 a[162:163], v12 offset:512
    ds_read_b64_tr_b16 a[164:165], v12 offset:8192
    ds_read_b64_tr_b16 a[166:167], v12 offset:8704
    ds_read_b64_tr_b16 a[192:193], v13 offset:0
    ds_read_b64_tr_b16 a[194:195], v13 offset:512
    ds_read_b64_tr_b16 a[196:197], v13 offset:8192
    ds_read_b64_tr_b16 a[198:199], v13 offset:8704
    s_branch L_wve_161
L_wv_159:
    ds_read_b64_tr_b16 a[176:177], v12 offset:0
    ds_read_b64_tr_b16 a[178:179], v12 offset:512
    ds_read_b64_tr_b16 a[180:181], v12 offset:8192
    ds_read_b64_tr_b16 a[182:183], v12 offset:8704
    ds_read_b64_tr_b16 a[240:241], v13 offset:0
    ds_read_b64_tr_b16 a[242:243], v13 offset:512
    ds_read_b64_tr_b16 a[244:245], v13 offset:8192
    ds_read_b64_tr_b16 a[246:247], v13 offset:8704
    s_branch L_wve_161
L_wv_160:
    ds_read_b64_tr_b16 v[96:97], v12 offset:0
    ds_read_b64_tr_b16 v[98:99], v12 offset:512
    ds_read_b64_tr_b16 v[100:101], v12 offset:8192
    ds_read_b64_tr_b16 v[102:103], v12 offset:8704
    ds_read_b64_tr_b16 a[224:225], v13 offset:0
    ds_read_b64_tr_b16 a[226:227], v13 offset:512
    ds_read_b64_tr_b16 a[228:229], v13 offset:8192
    ds_read_b64_tr_b16 a[230:231], v13 offset:8704
L_wve_161:
    s_waitcnt vmcnt(16) lgkmcnt(0)
    s_barrier
    v_add_u32 v12, 81920, v116
    v_add_u32 v13, 81920, v117
    s_cmp_eq_u32 s3, 1
    s_cbranch_scc1 L_wv_163
    s_cmp_eq_u32 s3, 2
    s_cbranch_scc1 L_wv_164
    s_cmp_eq_u32 s3, 3
    s_cbranch_scc1 L_wv_165
    ds_read_b64_tr_b16 v[88:89], v12 offset:0
    ds_read_b64_tr_b16 v[90:91], v12 offset:512
    ds_read_b64_tr_b16 v[92:93], v12 offset:8192
    ds_read_b64_tr_b16 v[94:95], v12 offset:8704
    ds_read_b64_tr_b16 a[216:217], v13 offset:0
    ds_read_b64_tr_b16 a[218:219], v13 offset:512
    ds_read_b64_tr_b16 a[220:221], v13 offset:8192
    ds_read_b64_tr_b16 a[222:223], v13 offset:8704
    s_branch L_wve_166
L_wv_163:
    ds_read_b64_tr_b16 a[168:169], v12 offset:0
    ds_read_b64_tr_b16 a[170:171], v12 offset:512
    ds_read_b64_tr_b16 a[172:173], v12 offset:8192
    ds_read_b64_tr_b16 a[174:175], v12 offset:8704
    ds_read_b64_tr_b16 a[200:201], v13 offset:0
    ds_read_b64_tr_b16 a[202:203], v13 offset:512
    ds_read_b64_tr_b16 a[204:205], v13 offset:8192
    ds_read_b64_tr_b16 a[206:207], v13 offset:8704
    s_branch L_wve_166
L_wv_164:
    ds_read_b64_tr_b16 a[184:185], v12 offset:0
    ds_read_b64_tr_b16 a[186:187], v12 offset:512
    ds_read_b64_tr_b16 a[188:189], v12 offset:8192
    ds_read_b64_tr_b16 a[190:191], v12 offset:8704
    ds_read_b64_tr_b16 a[248:249], v13 offset:0
    ds_read_b64_tr_b16 a[250:251], v13 offset:512
    ds_read_b64_tr_b16 a[252:253], v13 offset:8192
    ds_read_b64_tr_b16 a[254:255], v13 offset:8704
    s_branch L_wve_166
L_wv_165:
    ds_read_b64_tr_b16 v[104:105], v12 offset:0
    ds_read_b64_tr_b16 v[106:107], v12 offset:512
    ds_read_b64_tr_b16 v[108:109], v12 offset:8192
    ds_read_b64_tr_b16 v[110:111], v12 offset:8704
    ds_read_b64_tr_b16 a[232:233], v13 offset:0
    ds_read_b64_tr_b16 a[234:235], v13 offset:512
    ds_read_b64_tr_b16 a[236:237], v13 offset:8192
    ds_read_b64_tr_b16 a[238:239], v13 offset:8704
L_wve_166:
    s_waitcnt vmcnt(12) lgkmcnt(0)
    s_barrier
    v_add_u32 v12, 98304, v116
    v_add_u32 v13, 98304, v117
    s_cmp_eq_u32 s3, 1
    s_cbranch_scc1 L_wv_168
    s_cmp_eq_u32 s3, 2
    s_cbranch_scc1 L_wv_169
    s_cmp_eq_u32 s3, 3
    s_cbranch_scc1 L_wv_170
    ds_read_b64_tr_b16 v[96:97], v12 offset:0
    ds_read_b64_tr_b16 v[98:99], v12 offset:512
    ds_read_b64_tr_b16 v[100:101], v12 offset:8192
    ds_read_b64_tr_b16 v[102:103], v12 offset:8704
    ds_read_b64_tr_b16 a[224:225], v13 offset:0
    ds_read_b64_tr_b16 a[226:227], v13 offset:512
    ds_read_b64_tr_b16 a[228:229], v13 offset:8192
    ds_read_b64_tr_b16 a[230:231], v13 offset:8704
    s_branch L_wve_171
L_wv_168:
    ds_read_b64_tr_b16 v[80:81], v12 offset:0
    ds_read_b64_tr_b16 v[82:83], v12 offset:512
    ds_read_b64_tr_b16 v[84:85], v12 offset:8192
    ds_read_b64_tr_b16 v[86:87], v12 offset:8704
    ds_read_b64_tr_b16 a[208:209], v13 offset:0
    ds_read_b64_tr_b16 a[210:211], v13 offset:512
    ds_read_b64_tr_b16 a[212:213], v13 offset:8192
    ds_read_b64_tr_b16 a[214:215], v13 offset:8704
    s_branch L_wve_171
L_wv_169:
    ds_read_b64_tr_b16 a[160:161], v12 offset:0
    ds_read_b64_tr_b16 a[162:163], v12 offset:512
    ds_read_b64_tr_b16 a[164:165], v12 offset:8192
    ds_read_b64_tr_b16 a[166:167], v12 offset:8704
    ds_read_b64_tr_b16 a[192:193], v13 offset:0
    ds_read_b64_tr_b16 a[194:195], v13 offset:512
    ds_read_b64_tr_b16 a[196:197], v13 offset:8192
    ds_read_b64_tr_b16 a[198:199], v13 offset:8704
    s_branch L_wve_171
L_wv_170:
    ds_read_b64_tr_b16 a[176:177], v12 offset:0
    ds_read_b64_tr_b16 a[178:179], v12 offset:512
    ds_read_b64_tr_b16 a[180:181], v12 offset:8192
    ds_read_b64_tr_b16 a[182:183], v12 offset:8704
    ds_read_b64_tr_b16 a[240:241], v13 offset:0
    ds_read_b64_tr_b16 a[242:243], v13 offset:512
    ds_read_b64_tr_b16 a[244:245], v13 offset:8192
    ds_read_b64_tr_b16 a[246:247], v13 offset:8704
L_wve_171:
    s_waitcnt vmcnt(8) lgkmcnt(0)
    s_barrier
    v_add_u32 v12, 114688, v116
    v_add_u32 v13, 114688, v117
    s_cmp_eq_u32 s3, 1
    s_cbranch_scc1 L_wv_173
    s_cmp_eq_u32 s3, 2
    s_cbranch_scc1 L_wv_174
    s_cmp_eq_u32 s3, 3
    s_cbranch_scc1 L_wv_175
    ds_read_b64_tr_b16 v[104:105], v12 offset:0
    ds_read_b64_tr_b16 v[106:107], v12 offset:512
    ds_read_b64_tr_b16 v[108:109], v12 offset:8192
    ds_read_b64_tr_b16 v[110:111], v12 offset:8704
    ds_read_b64_tr_b16 a[232:233], v13 offset:0
    ds_read_b64_tr_b16 a[234:235], v13 offset:512
    ds_read_b64_tr_b16 a[236:237], v13 offset:8192
    ds_read_b64_tr_b16 a[238:239], v13 offset:8704
    s_branch L_wve_176
L_wv_173:
    ds_read_b64_tr_b16 v[88:89], v12 offset:0
    ds_read_b64_tr_b16 v[90:91], v12 offset:512
    ds_read_b64_tr_b16 v[92:93], v12 offset:8192
    ds_read_b64_tr_b16 v[94:95], v12 offset:8704
    ds_read_b64_tr_b16 a[216:217], v13 offset:0
    ds_read_b64_tr_b16 a[218:219], v13 offset:512
    ds_read_b64_tr_b16 a[220:221], v13 offset:8192
    ds_read_b64_tr_b16 a[222:223], v13 offset:8704
    s_branch L_wve_176
L_wv_174:
    ds_read_b64_tr_b16 a[168:169], v12 offset:0
    ds_read_b64_tr_b16 a[170:171], v12 offset:512
    ds_read_b64_tr_b16 a[172:173], v12 offset:8192
    ds_read_b64_tr_b16 a[174:175], v12 offset:8704
    ds_read_b64_tr_b16 a[200:201], v13 offset:0
    ds_read_b64_tr_b16 a[202:203], v13 offset:512
    ds_read_b64_tr_b16 a[204:205], v13 offset:8192
    ds_read_b64_tr_b16 a[206:207], v13 offset:8704
    s_branch L_wve_176
L_wv_175:
    ds_read_b64_tr_b16 a[184:185], v12 offset:0
    ds_read_b64_tr_b16 a[186:187], v12 offset:512
    ds_read_b64_tr_b16 a[188:189], v12 offset:8192
    ds_read_b64_tr_b16 a[190:191], v12 offset:8704
    ds_read_b64_tr_b16 a[248:249], v13 offset:0
    ds_read_b64_tr_b16 a[250:251], v13 offset:512
    ds_read_b64_tr_b16 a[252:253], v13 offset:8192
    ds_read_b64_tr_b16 a[254:255], v13 offset:8704
L_wve_176:
    s_waitcnt vmcnt(4) lgkmcnt(0)
    s_barrier
    v_add_u32 v12, 131072, v116
    v_add_u32 v13, 131072, v117
    s_cmp_eq_u32 s3, 1
    s_cbranch_scc1 L_wv_178
    s_cmp_eq_u32 s3, 2
    s_cbranch_scc1 L_wv_179
    s_cmp_eq_u32 s3, 3
    s_cbranch_scc1 L_wv_180
    ds_read_b64_tr_b16 a[176:177], v12 offset:0
    ds_read_b64_tr_b16 a[178:179], v12 offset:512
    ds_read_b64_tr_b16 a[180:181], v12 offset:8192
    ds_read_b64_tr_b16 a[182:183], v12 offset:8704
    ds_read_b64_tr_b16 a[240:241], v13 offset:0
    ds_read_b64_tr_b16 a[242:243], v13 offset:512
    ds_read_b64_tr_b16 a[244:245], v13 offset:8192
    ds_read_b64_tr_b16 a[246:247], v13 offset:8704
    s_branch L_wve_181
L_wv_178:
    ds_read_b64_tr_b16 v[96:97], v12 offset:0
    ds_read_b64_tr_b16 v[98:99], v12 offset:512
    ds_read_b64_tr_b16 v[100:101], v12 offset:8192
    ds_read_b64_tr_b16 v[102:103], v12 offset:8704
    ds_read_b64_tr_b16 a[224:225], v13 offset:0
    ds_read_b64_tr_b16 a[226:227], v13 offset:512
    ds_read_b64_tr_b16 a[228:229], v13 offset:8192
    ds_read_b64_tr_b16 a[230:231], v13 offset:8704
    s_branch L_wve_181
L_wv_179:
    ds_read_b64_tr_b16 v[80:81], v12 offset:0
    ds_read_b64_tr_b16 v[82:83], v12 offset:512
    ds_read_b64_tr_b16 v[84:85], v12 offset:8192
    ds_read_b64_tr_b16 v[86:87], v12 offset:8704
    ds_read_b64_tr_b16 a[208:209], v13 offset:0
    ds_read_b64_tr_b16 a[210:211], v13 offset:512
    ds_read_b64_tr_b16 a[212:213], v13 offset:8192
    ds_read_b64_tr_b16 a[214:215], v13 offset:8704
    s_branch L_wve_181
L_wv_180:
    ds_read_b64_tr_b16 a[160:161], v12 offset:0
    ds_read_b64_tr_b16 a[162:163], v12 offset:512
    ds_read_b64_tr_b16 a[164:165], v12 offset:8192
    ds_read_b64_tr_b16 a[166:167], v12 offset:8704
    ds_read_b64_tr_b16 a[192:193], v13 offset:0
    ds_read_b64_tr_b16 a[194:195], v13 offset:512
    ds_read_b64_tr_b16 a[196:197], v13 offset:8192
    ds_read_b64_tr_b16 a[198:199], v13 offset:8704
L_wve_181:
    s_waitcnt vmcnt(0) lgkmcnt(0)
    s_barrier
    v_add_u32 v12, 147456, v116
    v_add_u32 v13, 147456, v117
    s_cmp_eq_u32 s3, 1
    s_cbranch_scc1 L_wv_183
    s_cmp_eq_u32 s3, 2
    s_cbranch_scc1 L_wv_184
    s_cmp_eq_u32 s3, 3
    s_cbranch_scc1 L_wv_185
    ds_read_b64_tr_b16 a[184:185], v12 offset:0
    ds_read_b64_tr_b16 a[186:187], v12 offset:512
    ds_read_b64_tr_b16 a[188:189], v12 offset:8192
    ds_read_b64_tr_b16 a[190:191], v12 offset:8704
    ds_read_b64_tr_b16 a[248:249], v13 offset:0
    ds_read_b64_tr_b16 a[250:251], v13 offset:512
    ds_read_b64_tr_b16 a[252:253], v13 offset:8192
    ds_read_b64_tr_b16 a[254:255], v13 offset:8704
    s_branch L_wve_186
L_wv_183:
    ds_read_b64_tr_b16 v[104:105], v12 offset:0
    ds_read_b64_tr_b16 v[106:107], v12 offset:512
    ds_read_b64_tr_b16 v[108:109], v12 offset:8192
    ds_read_b64_tr_b16 v[110:111], v12 offset:8704
    ds_read_b64_tr_b16 a[232:233], v13 offset:0
    ds_read_b64_tr_b16 a[234:235], v13 offset:512
    ds_read_b64_tr_b16 a[236:237], v13 offset:8192
    ds_read_b64_tr_b16 a[238:239], v13 offset:8704
    s_branch L_wve_186
L_wv_184:
    ds_read_b64_tr_b16 v[88:89], v12 offset:0
    ds_read_b64_tr_b16 v[90:91], v12 offset:512
    ds_read_b64_tr_b16 v[92:93], v12 offset:8192
    ds_read_b64_tr_b16 v[94:95], v12 offset:8704
    ds_read_b64_tr_b16 a[216:217], v13 offset:0
    ds_read_b64_tr_b16 a[218:219], v13 offset:512
    ds_read_b64_tr_b16 a[220:221], v13 offset:8192
    ds_read_b64_tr_b16 a[222:223], v13 offset:8704
    s_branch L_wve_186
L_wv_185:
    ds_read_b64_tr_b16 a[168:169], v12 offset:0
    ds_read_b64_tr_b16 a[170:171], v12 offset:512
    ds_read_b64_tr_b16 a[172:173], v12 offset:8192
    ds_read_b64_tr_b16 a[174:175], v12 offset:8704
    ds_read_b64_tr_b16 a[200:201], v13 offset:0
    ds_read_b64_tr_b16 a[202:203], v13 offset:512
    ds_read_b64_tr_b16 a[204:205], v13 offset:8192
    ds_read_b64_tr_b16 a[206:207], v13 offset:8704
L_wve_186:
    s_waitcnt lgkmcnt(0)
    s_barrier
    v_add_u32 v10, 32768, v7
    ds_write_b128 v10, v[16:19]
    ds_write_b128 v10, v[20:23] offset:1024
    v_add_u32 v10, 40960, v7
    ds_write_b128 v10, v[24:27]
    ds_write_b128 v10, v[28:31] offset:1024
    v_add_u32 v10, 49152, v7
    ds_write_b128 v10, v[32:35]
    ds_write_b128 v10, v[36:39] offset:1024
    v_add_u32 v10, 57344, v7
    ds_write_b128 v10, v[40:43]
    ds_write_b128 v10, v[44:47] offset:1024
    v_add_u32 v10, 65536, v7
    ds_write_b128 v10, v[48:51]
    ds_write_b128 v10, v[52:55] offset:1024
    v_add_u32 v10, 73728, v7
    ds_write_b128 v10, v[56:59]
    ds_write_b128 v10, v[60:63] offset:1024
    v_add_u32 v10, 81920, v7
    ds_write_b128 v10, v[64:67]
    ds_write_b128 v10, v[68:71] offset:1024
    v_add_u32 v10, 90112, v7
    ds_write_b128 v10, v[72:75]
    ds_write_b128 v10, v[76:79] offset:1024
    v_add_u32 v10, 98304, v7
    ds_write_b128 v10, v[80:83]
    ds_write_b128 v10, v[84:87] offset:1024
    v_add_u32 v10, 106496, v7
    ds_write_b128 v10, v[88:91]
    ds_write_b128 v10, v[92:95] offset:1024
    v_add_u32 v10, 114688, v7
    ds_write_b128 v10, v[96:99]
    ds_write_b128 v10, v[100:103] offset:1024
    v_add_u32 v10, 122880, v7
    ds_write_b128 v10, v[104:107]
    ds_write_b128 v10, v[108:111] offset:1024
    s_waitcnt lgkmcnt(0)
    s_barrier
    v_lshrrev_b32 v8, 4, v1
    v_lshlrev_b32 v1, 4, v8
    v_bfe_u32 v9, v8, 1, 1
    v_cmp_eq_u32 vcc, 1, v9
    v_mov_b32 v10, 0x4444
    v_mov_b32 v11, 0xeeee
    v_cndmask_b32 v0, v10, v11, vcc
    v_and_b32 v10, 15, v8
    v_cmp_le_u32 vcc, 8, v10
    s_nop 0
    s_mov_b64 s[62:63], vcc
    v_lshrrev_b32 v11, 4, v8
    v_lshrrev_b32 v12, 3, v10
    v_lshlrev_b32 v12, 13, v12
    v_lshl_add_u32 v12, v11, 11, v12
    v_and_b32 v13, 7, v10
    v_lshl_add_u32 v2, v13, 3, v12
    s_lshl_b32 s66, s3, 9
    s_add_u32 s66, s66, 155648
    v_lshlrev_b32 v12, 4, v10
    v_lshl_add_u32 v12, v11, 2, v12
    v_add_u32 v3, s66, v12
    s_lshl_b32 s66, s3, 10
    s_add_u32 s66, s66, 147456
    v_lshlrev_b32 v12, 5, v10
    v_lshl_add_u32 v12, v11, 3, v12
    v_add_u32 v4, s66, v12
    v_lshrrev_b32 v12, 5, v8
    v_lshlrev_b32 v12, 4, v12
    v_bfe_u32 v13, v8, 4, 1
    v_lshl_add_u32 v12, v13, 2, v12
    v_bfe_u32 v13, v8, 2, 2
    v_add_u32 v12, v12, v13
    v_and_b32 v13, 1, v8
    v_lshlrev_b32 v13, 3, v13
    v_lshl_add_u32 v13, v12, 4, v13
    v_add_u32 v5, 155648, v13
    v_and_b32 v13, 3, v8
    v_lshlrev_b32 v13, 3, v13
    v_lshl_add_u32 v13, v12, 5, v13
    v_add_u32 v6, 147456, v13
    v_add_u32 v7, s57, v1
    v_and_b32 v12, 7, v10
    v_mul_u32_u24 v12, 272, v12
    v_lshrrev_b32 v13, 3, v10
    v_lshl_add_u32 v12, v13, 5, v12
    v_lshl_add_u32 v12, v11, 2, v12
    s_lshl_b32 s66, s3, 6
    s_add_u32 s66, s66, 151552
    v_add_u32 v16, s66, v12
    v_lshrrev_b32 v12, 2, v10
    v_and_b32 v13, 1, v10
    v_lshl_add_u32 v12, v12, 1, v13
    v_mul_u32_u24 v12, 272, v12
    v_lshl_add_u32 v12, v11, 5, v12
    v_lshl_add_u32 v12, v9, 4, v12
    v_add_u32 v17, 151552, v12
    v_lshrrev_b32 v12, 2, v10
    v_lshlrev_b32 v12, 6, v12
    v_lshl_add_u32 v12, v11, 5, v12
    v_and_b32 v13, 3, v10
    v_lshl_add_u32 v18, v13, 2, v12
    v_lshlrev_b32 v12, 13, v11
    v_lshl_add_u32 v19, v10, 4, v12
    v_lshlrev_b32 v12, 5, v11
    v_bfe_u32 v13, v10, 2, 1
    v_lshl_add_u32 v12, v13, 4, v12
    v_and_b32 v13, 3, v10
    v_lshl_add_u32 v28, v13, 2, v12
    v_lshlrev_b32 v29, 4, v8
    v_bfe_u32 v13, v10, 2, 1
    v_cmp_eq_u32 vcc, 1, v13
    s_nop 0
    s_mov_b64 s[76:77], vcc
    v_and_b32 v12, 1, v10
    v_cmp_eq_u32 vcc, 1, v12
    v_mov_b32 v12, 0x3f80
    v_mov_b32 v13, 0x3f800000
    v_cndmask_b32 v12, v12, v13, vcc
    v_lshrrev_b32 v13, 2, v10
    v_cmp_eq_u32 vcc, 0, v13
    s_nop 1
    v_cndmask_b32 v20, 0, v12, vcc
    v_cmp_eq_u32 vcc, 1, v13
    s_nop 1
    v_cndmask_b32 v21, 0, v12, vcc
    v_cmp_eq_u32 vcc, 0, v13
    s_nop 1
    v_cndmask_b32 v22, 0, v12, vcc
    v_cmp_eq_u32 vcc, 1, v13
    s_nop 1
    v_cndmask_b32 v23, 0, v12, vcc
    s_lshl_b32 s66, s3, 10
    s_add_u32 s66, s66, 158720
    v_add_u32 v12, s66, v1
    v_mov_b32 v18, v28
    v_mov_b32 v19, v29
    ds_write_b128 v12, v[16:19]
    v_add_u32 v12, 157696, v1
    ds_write_b128 v12, v[20:23]
    s_waitcnt lgkmcnt(0)
    v_mov_b32 v8, 44
L_cg0_187:
    global_load_dword v10, v8, s[28:29] sc1
    s_waitcnt vmcnt(0)
    v_readfirstlane_b32 s61, v10
    s_add_u32 s65, s65, 1
    s_cmp_gt_u32 s65, 4000000
    s_cbranch_scc1 L_exit
    s_cmp_lt_u32 s61, 33
    s_cbranch_scc1 L_cg0_187
L_cg1_188:
    s_lshl_b32 s66, s48, 13
    s_add_u32 s66, s66, s57
    s_add_u32 s58, s66, 2097152
    s_add_u32 s60, s66, 35651584
    s_add_u32 s61, s57, 131072
    s_add_u32 s82, s57, 139264
    s_mov_b32 s42, 0
    s_mov_b32 s69, 0
    s_lshl_b32 s66, s48, 13
    s_add_u32 s66, s66, s57
    s_add_u32 s67, s66, 132120576
    buffer_load_dwordx4 v[8:11], v1, s[32:35], s67 offen offset:0 sc1
    buffer_load_dwordx4 v[12:15], v1, s[32:35], s67 offen offset:1024 sc1
    s_add_u32 s67, s66, 132382720
    buffer_load_dwordx4 v[16:19], v1, s[32:35], s67 offen offset:0 sc1
    buffer_load_dwordx4 v[20:23], v1, s[32:35], s67 offen offset:1024 sc1
    s_add_u32 s67, s57, 132915200
    buffer_load_dwordx4 v[24:27], v1, s[32:35], s67 offen offset:0 sc1
    buffer_load_dwordx4 v[28:31], v1, s[32:35], s67 offen offset:1024 sc1
    s_add_u32 s67, s57, 132923392
    buffer_load_dwordx4 v[32:35], v1, s[32:35], s67 offen offset:0 sc1
    buffer_load_dwordx4 v[36:39], v1, s[32:35], s67 offen offset:1024 sc1
L_kvw_189:
    v_lshlrev_b32 v116, 3, v1
    s_mov_b32 s68, 133171200
    s_mov_b64 exec, 0xffff
    buffer_load_dword v117, v116, s[32:35], s68 offen sc1
    s_waitcnt vmcnt(0)
    v_cmp_le_u32 vcc, 64, v117
    s_mov_b64 exec, -1
    s_not_b32 s68, vcc_lo
    s_or_b32 s68, s68, 0x10000
    s_ff1_i32_b32 s42, s68
    s_add_u32 s65, s65, 1
    s_cmp_gt_u32 s65, 4000000
    s_cbranch_scc1 L_exit
    s_cmp_le_u32 s42, s69
    s_cbranch_scc1 L_kvw_189
    s_mov_b32 m0, s61
    s_nop 0
    buffer_load_dwordx4 v1, s[32:35], s58 offen offset:0 sc1 lds
    buffer_load_dwordx4 v1, s[32:35], s58 offen offset:1024 sc1 lds
    s_mov_b32 m0, s82
    s_nop 0
    buffer_load_dwordx4 v1, s[32:35], s60 offen offset:0 sc1 lds
    buffer_load_dwordx4 v1, s[32:35], s60 offen offset:1024 sc1 lds
    s_waitcnt lgkmcnt(0)
    s_barrier
    v_lshrrev_b32 v8, 2, v1
L_cm_190:
    s_mov_b64 exec, 0xff
    global_load_dword v9, v8, s[28:29] sc1
    s_waitcnt vmcnt(0)
    s_mov_b64 exec, -1
    v_readlane_b32 s61, v9, 0
    s_mov_b32 s60, 0
    s_cmp_ge_u32 s61, 32
    s_cbranch_scc1 L_cmo_191
    v_readlane_b32 s84, v9, 1
    s_nop 0
    s_add_u32 s61, s61, s84
    v_readlane_b32 s84, v9, 2
    s_nop 0
    s_add_u32 s61, s61, s84
    v_readlane_b32 s84, v9, 3
    s_nop 0
    s_add_u32 s61, s61, s84
    v_readlane_b32 s84, v9, 4
    s_nop 0
    s_add_u32 s61, s61, s84
    v_readlane_b32 s84, v9, 5
    s_nop 0
    s_add_u32 s61, s61, s84
    v_readlane_b32 s84, v9, 6
    s_nop 0
    s_add_u32 s61, s61, s84
    v_readlane_b32 s84, v9, 7
    s_nop 0
    s_add_u32 s61, s61, s84
    s_add_u32 s65, s65, 1
    s_cmp_gt_u32 s65, 4000000
    s_cbranch_scc1 L_exit
    s_cmp_lt_u32 s61, 256
    s_cbranch_scc1 L_cm_190
    s_mov_b32 s60, 1
L_cmo_191:
    s_cmp_lg_u32 s60, 0
    s_cbranch_scc1 L_chain_mixed
    s_mov_b32 s49, 0
    s_mov_b32 s50, 132120576
    s_mov_b32 s51, 132907008
    s_mov_b32 s52, 132915200
    s_mov_b32 s53, 132923392
    s_lshl_b32 s59, s48, 12
    s_lshl_b32 s66, s3, 10
    s_add_u32 s59, s59, s66
    s_add_u32 s79, s66, 158720
    s_mov_b32 s83, s66
    s_lshl_b32 s66, s3, 6
    s_add_u32 s100, s56, s66
    s_add_u32 s101, s57, 139264
    s_lshl_b32 s66, s48, 13
    s_add_u32 s66, s66, s57
    s_add_u32 s58, s66, 2097152
    s_add_u32 s60, s66, 35651584
    s_add_u32 s61, s57, 131072
    s_add_u32 s82, s57, 139264
    s_add_u32 s81, s57, 147456
    s_lshl_b32 s66, s3, 1
    s_add_u32 s66, s66, 2
    s_and_b32 s66, s66, 7
    s_lshl_b32 s66, s66, 10
    s_add_u32 s36, s66, 147456
    s_lshl_b32 s66, s3, 1
    s_add_u32 s66, s66, 3
    s_and_b32 s66, s66, 7
    s_lshl_b32 s66, s66, 10
    s_add_u32 s37, s66, 147456
    s_lshl_b32 s66, s3, 1
    s_add_u32 s66, s66, 4
    s_and_b32 s66, s66, 7
    s_lshl_b32 s66, s66, 10
    s_add_u32 s38, s66, 147456
    s_lshl_b32 s66, s3, 1
    s_add_u32 s66, s66, 5
    s_and_b32 s66, s66, 7
    s_lshl_b32 s66, s66, 10
    s_add_u32 s39, s66, 147456
    s_lshl_b32 s66, s3, 1
    s_add_u32 s66, s66, 6
    s_and_b32 s66, s66, 7
    s_lshl_b32 s66, s66, 10
    s_add_u32 s40, s66, 147456
    s_lshl_b32 s66, s3, 1
    s_add_u32 s66, s66, 7
    s_and_b32 s66, s66, 7
    s_lshl_b32 s66, s66, 10
    s_add_u32 s41, s66, 147456
    s_mov_b32 s43, 133185536
    s_add_u32 s58, s58, 262144
    s_add_u32 s60, s60, 262144
    s_add_u32 s80, s58, 262144
    s_mov_b32 s46, 0
    s_mov_b32 s99, 0
    s_lshl_b32 s55, s48, 13
    s_add_u32 s55, s55, s57
    s_add_u32 s97, s83, 133562368
    s_mov_b32 s98, s97
    s_mov_b32 s78, 0
    s_mov_b32 s47, 33552384
    s_mov_b32 s44, s64
    s_mov_b32 s45, s64
    v_add_u32 v114, s79, v1
    ds_read_b128 v[124:127], v114
    ds_read_b128 v[64:67], v7 offset:0
    ds_read_b128 v[68:71], v7 offset:1024
    ds_read_b128 v[72:75], v7 offset:8192
    ds_read_b128 v[76:79], v7 offset:9216
    ds_read_b128 v[80:83], v7 offset:16384
    ds_read_b128 v[84:87], v7 offset:17408
    ds_read_b128 v[88:91], v7 offset:24576
    ds_read_b128 v[92:95], v7 offset:25600
    ds_read_b128 v[96:99], v7 offset:32768
    ds_read_b128 v[100:103], v7 offset:33792
    ds_read_b128 v[104:107], v7 offset:40960
    ds_read_b128 v[108:111], v7 offset:41984
    v_pk_mov_b32 v[40:41], 0, 0
    v_pk_mov_b32 v[42:43], 0, 0
    v_pk_mov_b32 v[44:45], 0, 0
    v_pk_mov_b32 v[46:47], 0, 0
    v_pk_mov_b32 v[48:49], 0, 0
    v_pk_mov_b32 v[50:51], 0, 0
    v_pk_mov_b32 v[52:53], 0, 0
    v_pk_mov_b32 v[54:55], 0, 0
    v_pk_mov_b32 v[56:57], 0, 0
    v_pk_mov_b32 v[58:59], 0, 0
    v_pk_mov_b32 v[60:61], 0, 0
    v_pk_mov_b32 v[62:63], 0, 0
    s_waitcnt lgkmcnt(0)
.p2align 8
L_cstep:
    v_add_u32 v113, s81, v1
    s_cmp_lt_u32 s99, s42
    s_cbranch_scc1 L_kvok_192
    s_mov_b32 s69, s99
L_kvw_193:
    v_lshlrev_b32 v116, 3, v1
    s_mov_b32 s68, 133171200
    s_mov_b64 exec, 0xffff
    buffer_load_dword v117, v116, s[32:35], s68 offen sc1
    s_waitcnt vmcnt(0)
    v_cmp_le_u32 vcc, 64, v117
    s_mov_b64 exec, -1
    s_not_b32 s68, vcc_lo
    s_or_b32 s68, s68, 0x10000
    s_ff1_i32_b32 s42, s68
    s_add_u32 s65, s65, 1
    s_cmp_gt_u32 s65, 4000000
    s_cbranch_scc1 L_exit
    s_cmp_le_u32 s42, s69
    s_cbranch_scc1 L_kvw_193
L_kvok_192:
    s_add_u32 s66, s51, s57
L_poll2:
    buffer_load_dwordx4 v[8:11], v1, s[32:35], s66 offen sc1
    buffer_load_dwordx4 v[12:15], v1, s[32:35], s66 offen offset:1024 sc1
    s_sleep 1
L_pl:
    buffer_load_dwordx4 v[24:27], v1, s[32:35], s66 offen sc1
    buffer_load_dwordx4 v[28:31], v1, s[32:35], s66 offen offset:1024 sc1
    s_add_u32 s65, s65, 1
    s_cmp_gt_u32 s65, 4000000
    s_cbranch_scc1 L_exit
    s_waitcnt vmcnt(2)
    v_max_u32 v112, v8, v12
    v_cmp_eq_u32 vcc, -1, v112
    s_cbranch_vccz L_gotA
    buffer_load_dwordx4 v[8:11], v1, s[32:35], s66 offen sc1
    buffer_load_dwordx4 v[12:15], v1, s[32:35], s66 offen offset:1024 sc1
    s_waitcnt vmcnt(2)
    v_max_u32 v112, v24, v28
    v_cmp_eq_u32 vcc, -1, v112
    s_cbranch_vccnz L_pl
    v_pk_mov_b32 v[8:9], v[24:25], v[24:25] op_sel:[0,1]
    v_pk_mov_b32 v[10:11], v[26:27], v[26:27] op_sel:[0,1]
    v_pk_mov_b32 v[12:13], v[28:29], v[28:29] op_sel:[0,1]
    v_pk_mov_b32 v[14:15], v[30:31], v[30:31] op_sel:[0,1]
L_gotA:
    s_nop 0
    ds_write_b128 v113, v[8:11]
    ds_write_b128 v113, v[12:15] offset:1024
    v_smfmac_f32_16x16x64_bf16 v[40:43], v[8:11], a[0:7], v0
    v_add_u32 v112, s36, v1
    v_smfmac_f32_16x16x64_bf16 v[44:47], v[8:11], a[16:23], v0
    v_add_u32 v113, s37, v1
    v_smfmac_f32_16x16x64_bf16 v[48:51], v[8:11], a[80:87], v0
    v_add_u32 v114, s38, v1
    v_smfmac_f32_16x16x64_bf16 v[52:55], v[8:11], a[96:103], v0
    v_smfmac_f32_16x16x64_bf16 v[56:59], v[8:11], a[160:167], v0
    v_smfmac_f32_16x16x64_bf16 v[60:63], v[8:11], a[192:199], v0
    s_waitcnt lgkmcnt(0)
    s_barrier
    ds_read_b128 v[16:19], v112
    v_add_u32 v115, s39, v1
    v_smfmac_f32_16x16x64_bf16 v[40:43], v[12:15], a[8:15], v0
    s_waitcnt vmcnt(0)
    ds_read_b128 v[20:23], v113
    v_add_u32 v116, s40, v1
    v_smfmac_f32_16x16x64_bf16 v[44:47], v[12:15], a[24:31], v0
    ds_read_b128 v[24:27], v114
    v_add_u32 v117, s41, v1
    v_smfmac_f32_16x16x64_bf16 v[48:51], v[12:15], a[88:95], v0
    ds_read_b128 v[28:31], v115
    buffer_store_dwordx4 v[32:35], v1, s[32:35], s98 offen sc1
    v_smfmac_f32_16x16x64_bf16 v[52:55], v[12:15], a[104:111], v0
    s_cmp_eq_u32 s78, 0
    s_cbranch_scc1 L_nofl_194
    v_mov_b32 v119, 1
    s_mov_b64 exec, 1
    buffer_store_dword v119, off, s[32:35], s43 sc1
    s_mov_b64 exec, -1
L_nofl_194:
    v_smfmac_f32_16x16x64_bf16 v[56:59], v[12:15], a[168:175], v0
    v_add_u32 v115, 65536, v7
    v_smfmac_f32_16x16x64_bf16 v[60:63], v[12:15], a[200:207], v0
    s_waitcnt lgkmcnt(3)
    buffer_store_dwordx4 v[36:39], v1, s[32:35], s97 offen sc1
    ds_read_b128 v[32:35], v116
    v_smfmac_f32_16x16x64_bf16 v[40:43], v[16:19], v[64:71], v0
    ds_read_b128 v[64:67], v7 offset:49152
    v_smfmac_f32_16x16x64_bf16 v[44:47], v[16:19], a[32:39], v0
    s_waitcnt lgkmcnt(4)
    ds_read_b128 v[68:71], v7 offset:50176
    v_smfmac_f32_16x16x64_bf16 v[40:43], v[20:23], v[72:79], v0
    ds_read_b128 v[36:39], v117
    v_add_u32 v114, s101, v1
    v_smfmac_f32_16x16x64_bf16 v[44:47], v[20:23], a[40:47], v0
    s_waitcnt lgkmcnt(5)
    ds_read_b128 v[72:75], v7 offset:57344
    s_add_u32 s68, s49, 2
    v_smfmac_f32_16x16x64_bf16 v[40:43], v[24:27], v[80:87], v0
    ds_read_b128 v[76:79], v7 offset:58368
    s_lshr_b32 s99, s68, 2
    v_smfmac_f32_16x16x64_bf16 v[44:47], v[24:27], a[48:55], v0
    s_waitcnt lgkmcnt(6)
    ds_read_b128 v[80:83], v115 offset:0
    s_min_u32 s99, s99, 15
    v_smfmac_f32_16x16x64_bf16 v[40:43], v[28:31], v[88:95], v0
    ds_read_b128 v[84:87], v115 offset:1024
    s_add_u32 s68, s49, 1
    v_smfmac_f32_16x16x64_bf16 v[44:47], v[28:31], a[56:63], v0
    s_waitcnt lgkmcnt(7)
    ds_read_b128 v[88:91], v115 offset:8192
    s_and_b32 s69, s68, 3
    v_smfmac_f32_16x16x64_bf16 v[40:43], v[32:35], v[96:103], v0
    ds_read_b128 v[92:95], v115 offset:9216
    s_xor_b32 s69, s69, 1
    v_smfmac_f32_16x16x64_bf16 v[44:47], v[32:35], a[64:71], v0
    s_waitcnt lgkmcnt(6)
    ds_read_b128 v[96:99], v115 offset:16384
    s_xor_b32 s78, s3, 3
    v_smfmac_f32_16x16x64_bf16 v[40:43], v[36:39], v[104:111], v0
    ds_read_b128 v[100:103], v115 offset:17408
    s_or_b32 s69, s69, s78
    v_smfmac_f32_16x16x64_bf16 v[44:47], v[36:39], a[72:79], v0
    s_waitcnt lgkmcnt(6)
    ds_read_b128 v[104:107], v115 offset:24576
    s_cmp_eq_u32 s69, 0
    v_smfmac_f32_16x16x64_bf16 v[48:51], v[16:19], v[64:71], v0
    ds_read_b128 v[108:111], v115 offset:25600
    s_cselect_b32 s78, s68, 0
    v_smfmac_f32_16x16x64_bf16 v[52:55], v[16:19], a[112:119], v0
    ds_read_b128 v[64:67], v115 offset:32768
    s_lshr_b32 s78, s78, 2
    v_smfmac_f32_16x16x64_bf16 v[48:51], v[20:23], v[72:79], v0
    ds_read_b128 v[120:123], v114
    v_add_f32 v40, v40, v42
    v_smfmac_f32_16x16x64_bf16 v[52:55], v[20:23], a[120:127], v0
    s_waitcnt lgkmcnt(6)
    ds_read_b128 v[68:71], v115 offset:33792
    v_add_f32 v41, v41, v43
    v_smfmac_f32_16x16x64_bf16 v[48:51], v[24:27], v[80:87], v0
    ds_read_b128 v[116:119], v114 offset:1024
    v_add_f32 v44, v44, v46
    v_smfmac_f32_16x16x64_bf16 v[52:55], v[24:27], a[128:135], v0
    ds_read_b128 v[72:75], v115 offset:40960
    v_add_u32 v114, 131072, v1
    v_smfmac_f32_16x16x64_bf16 v[48:51], v[28:31], v[88:95], v0
    ds_read_b128 v[76:79], v115 offset:41984
    v_add_f32 v45, v45, v47
    v_smfmac_f32_16x16x64_bf16 v[52:55], v[28:31], a[136:143], v0
    s_waitcnt lgkmcnt(6)
    ds_read_b128 v[80:83], v115 offset:49152
    v_cvt_pk_bf16_f32 v112, v40, v41
    v_smfmac_f32_16x16x64_bf16 v[48:51], v[32:35], v[96:103], v0
    ds_read_b128 v[84:87], v115 offset:50176
    v_cvt_pk_bf16_f32 v113, v44, v45
    v_smfmac_f32_16x16x64_bf16 v[52:55], v[32:35], a[144:151], v0
    ds_read_b128 v[88:91], v115 offset:57344
    s_lshr_b32 s69, s68, 2
    v_smfmac_f32_16x16x64_bf16 v[48:51], v[36:39], v[104:111], v0
    ds_write2_b32 v3, v112, v113 offset0:0 offset1:64
    s_sub_u32 s69, s69, 1
    v_smfmac_f32_16x16x64_bf16 v[52:55], v[36:39], a[152:159], v0
    s_waitcnt lgkmcnt(4)
    ds_read_b128 v[92:95], v115 offset:58368
    s_lshl_b32 s69, s69, 5
    v_smfmac_f32_16x16x64_bf16 v[56:59], v[16:19], v[64:71], v0
    ds_read_b128 v[96:99], v114 offset:0
    s_add_u32 s69, s69, s48
    v_smfmac_f32_16x16x64_bf16 v[60:63], v[16:19], a[208:215], v0
    ds_read_b128 v[100:103], v114 offset:1024
    s_lshl_b32 s69, s69, 7
    v_smfmac_f32_16x16x64_bf16 v[56:59], v[20:23], v[72:79], v0
    ds_read_b128 v[104:107], v114 offset:2048
    v_add_f32 v48, v48, v50
    v_smfmac_f32_16x16x64_bf16 v[60:63], v[20:23], a[216:223], v0
    s_waitcnt lgkmcnt(3)
    ds_read_b128 v[108:111], v114 offset:3072
    v_add_f32_e64 v49, v49, v51
    v_smfmac_f32_16x16x64_bf16 v[56:59], v[24:27], v[80:87], v0
    ds_read_b128 v[64:67], v114 offset:4096
    v_cvt_pk_bf16_f32 v112, v48, v49
    v_smfmac_f32_16x16x64_bf16 v[60:63], v[24:27], a[224:231], v0
    s_waitcnt lgkmcnt(6)
    s_barrier
    ds_read_b64_tr_b16 v[80:81], v5 offset:0
    v_add_f32 v52, v52, v54
    v_smfmac_f32_16x16x64_bf16 v[56:59], v[28:31], v[88:95], v0
    ds_read_b64_tr_b16 v[82:83], v5 offset:128
    v_add_f32 v53, v53, v55
    v_smfmac_f32_16x16x64_bf16 v[60:63], v[28:31], a[232:239], v0
    s_mov_b32 m0, s82
    s_nop 0
    buffer_load_dwordx4 v1, s[32:35], s60 offen offset:0 sc1 lds
    v_smfmac_f32_16x16x64_bf16 v[56:59], v[32:35], a[176:183], v0
    ds_read_b64_tr_b16 v[84:85], v5 offset:512
    v_cvt_pk_bf16_f32 v113, v52, v53
    v_smfmac_f32_16x16x64_bf16 v[60:63], v[32:35], a[240:247], v0
    ds_read_b64_tr_b16 v[86:87], v5 offset:640
    s_add_u32 s43, s69, 133300224
    v_smfmac_f32_16x16x64_bf16 v[56:59], v[36:39], a[184:191], v0
    ds_read_b128 v[68:71], v114 offset:5120
    ds_write2_b32 v4, v112, v112 offset0:0 offset1:1
    ds_read_b64_tr_b16 v[88:89], v5 offset:1024
    ds_read_b64_tr_b16 v[90:91], v5 offset:1152
    v_smfmac_f32_16x16x64_bf16 v[60:63], v[36:39], a[248:255], v0
    s_waitcnt lgkmcnt(6)
    ds_read_b128 v[72:75], v114 offset:6144
    ds_write2_b32 v4, v113, v113 offset0:128 offset1:129
    ds_read_b64_tr_b16 v[92:93], v5 offset:1536
    ds_read_b64_tr_b16 v[94:95], v5 offset:1664
    s_add_u32 s70, s55, s50
    s_add_u32 s79, s70, 1024
    s_add_u32 s71, s100, s52
    s_add_u32 s72, s54, s50
    s_add_u32 s73, s72, 16384
    s_add_u32 s74, s73, 16384
    s_add_u32 s75, s74, 16384
    v_mfma_f32_16x16x32_bf16 v[40:43], v[96:99], v[80:83], 0
    s_waitcnt lgkmcnt(8)
    ds_read_b128 v[76:79], v114 offset:7168
    buffer_load_dwordx4 v1, s[32:35], s60 offen offset:1024 sc1 lds
    v_mfma_f32_16x16x32_bf16 v[40:43], v[100:103], v[84:87], v[40:43]
    s_waitcnt lgkmcnt(5)
    v_mfma_f32_16x16x32_bf16 v[40:43], v[104:107], v[88:91], v[40:43]
    s_waitcnt lgkmcnt(1)
    v_add_u32 v114, s83, v6
    v_mfma_f32_16x16x32_bf16 v[40:43], v[108:111], v[92:95], v[40:43]
    s_waitcnt lgkmcnt(0)
    s_barrier
    ds_read_b64_tr_b16 v[8:9], v6 offset:0
    v_mfma_f32_16x16x32_bf16 v[44:47], v[64:67], v[80:83], 0
    ds_read_b64_tr_b16 v[10:11], v6 offset:256
    v_mov_b32 v96, 0x3f803f80
    v_mfma_f32_16x16x32_bf16 v[44:47], v[68:71], v[84:87], v[44:47]
    ds_read_b64_tr_b16 v[12:13], v6 offset:1024
    ds_read_b64_tr_b16 v[14:15], v6 offset:1280
    v_mfma_f32_16x16x32_bf16 v[44:47], v[72:75], v[88:91], v[44:47]
    ds_read_b64_tr_b16 v[16:17], v6 offset:2048
    ds_read_b64_tr_b16 v[18:19], v6 offset:2304
    v_mfma_f32_16x16x32_bf16 v[44:47], v[76:79], v[92:95], v[44:47]
    s_waitcnt lgkmcnt(4)
    ds_read_b64_tr_b16 v[20:21], v6 offset:3072
    ds_read_b64_tr_b16 v[22:23], v6 offset:3328
    v_mov_b32 v97, 0x3f803f80
    v_mfma_f32_16x16x32_bf16 v[48:51], v[8:11], v[80:83], 0
    s_waitcnt lgkmcnt(4)
    s_mov_b32 m0, s61
    s_nop 0
    buffer_load_dwordx4 v1, s[32:35], s58 offen offset:0 sc1 lds
    v_mov_b32 v98, 0x3f803f80
    v_mfma_f32_16x16x32_bf16 v[48:51], v[12:15], v[84:87], v[48:51]
    s_waitcnt lgkmcnt(2)
    ds_read_b64_tr_b16 v[36:37], v114
    v_mov_b32 v99, 0x3f803f80
    v_mfma_f32_16x16x32_bf16 v[48:51], v[16:19], v[88:91], v[48:51]
    s_waitcnt lgkmcnt(1)
    ds_read_b64_tr_b16 v[38:39], v114 offset:256
    v_mov_b32 v100, 0x3f803f80
    v_mfma_f32_16x16x32_bf16 v[48:51], v[20:23], v[92:95], v[48:51]
    buffer_load_dwordx4 v1, s[32:35], s58 offen offset:1024 sc1 lds
    v_mov_b32_e64 v101, 0
    v_max3_f32 v112, v40, v41, v42
    v_max3_f32 v112, v112, v43, v44
    v_max3_f32 v112, v112, v45, v46
    v_max_f32 v112, v112, v47
    s_nop 1
    v_max3_f32 v112, v112, v48, v49
    v_mov_b32 v113, v112
    s_nop 1
    v_permlane16_swap_b32 v112, v113
    v_max_f32 v112, v112, v113
    v_mov_b32 v113, v112
    s_nop 1
    v_permlane32_swap_b32 v112, v113
    v_max_f32 v112, v112, v113
    v_mul_f32_e64 v112, s64, v112
    v_pk_fma_f32 v[40:41], v[40:41], s[44:45], v[112:113] op_sel_hi:[1,1,0] neg_lo:[0,0,1] neg_hi:[0,0,1]
    v_pk_fma_f32 v[42:43], v[42:43], s[44:45], v[112:113] op_sel_hi:[1,1,0] neg_lo:[0,0,1] neg_hi:[0,0,1]
    v_pk_fma_f32 v[44:45], v[44:45], s[44:45], v[112:113] op_sel_hi:[1,1,0] neg_lo:[0,0,1] neg_hi:[0,0,1]
    v_pk_fma_f32 v[46:47], v[46:47], s[44:45], v[112:113] op_sel_hi:[1,1,0] neg_lo:[0,0,1] neg_hi:[0,0,1]
    v_pk_fma_f32 v[48:49], v[48:49], s[44:45], v[112:113] op_sel_hi:[1,1,0] neg_lo:[0,0,1] neg_hi:[0,0,1]
    v_exp_f32 v40, v40
    v_exp_f32 v41, v41
    v_exp_f32 v42, v42
    v_exp_f32 v43, v43
    v_exp_f32 v44, v44
    v_exp_f32 v45, v45
    v_exp_f32 v46, v46
    v_exp_f32 v47, v47
    v_exp_f32 v48, v48
    v_exp_f32 v49, v49
    v_cvt_pk_bf16_f32 v52, v40, v41
    v_cvt_pk_bf16_f32 v53, v42, v43
    v_cvt_pk_bf16_f32 v54, v44, v45
    v_cvt_pk_bf16_f32 v55, v46, v47
    v_cvt_pk_bf16_f32 v114, v48, v49
    v_cvt_pk_bf16_f32 v115, v48, v49
    v_mfma_f32_16x16x32_bf16 v[104:107], v[96:99], v[52:55], 0
    v_cvt_pk_bf16_f32 v32, v56, v57
    v_cvt_pk_bf16_f32 v33, v58, v59
    v_mfma_f32_16x16x32_bf16 v[40:43], v[120:123], v[52:55], 0
    v_cvt_pk_bf16_f32 v34, v60, v61
    v_cvt_pk_bf16_f32 v35, v62, v63
    v_mfma_f32_16x16x32_bf16 v[44:47], v[116:119], v[52:55], 0
    s_cmp_eq_u32 s49, 63
    s_cbranch_scc1 L_cdone
    v_mfma_f32_16x16x16_bf16 v[104:107], v[100:101], v[114:115], v[104:107]
    v_mfma_f32_16x16x16_bf16 v[40:43], v[32:33], v[114:115], v[40:43]
    s_nop 1
    v_mfma_f32_16x16x16_bf16 v[44:47], v[34:35], v[114:115], v[44:47]
    s_add_u32 s58, s58, 262144
    s_add_u32 s60, s60, 262144
    s_add_u32 s97, s59, 52428800
    s_add_u32 s98, s59, 60817408
    s_add_u32 s59, s59, 131072
    s_add_u32 s80, s80, 262144
    v_pk_mov_b32 v[24:25], 0, 0
    v_pk_mov_b32 v[26:27], 0, 0
    v_pk_mov_b32 v[28:29], 0, 0
    v_pk_mov_b32 v[30:31], 0, 0
    v_rcp_f32 v112, v104
    v_cndmask_b32 v40, v40, v44, s[62:63]
    v_cndmask_b32 v41, v41, v45, s[62:63]
    v_cndmask_b32 v42, v42, v46, s[62:63]
    v_cndmask_b32 v43, v43, v47, s[62:63]
    v_pk_mul_f32 v[40:41], v[40:41], v[112:113] op_sel_hi:[1,0]
    v_pk_mul_f32 v[42:43], v[42:43], v[112:113] op_sel_hi:[1,0]
    v_cvt_pk_bf16_f32 v114, v40, v41
    v_cvt_pk_bf16_f32 v115, v42, v43
    ds_write2_b32 v124, v114, v115 offset0:0 offset1:4
    v_pk_mov_b32 v[48:49], 0, 0
    v_pk_mov_b32 v[50:51], 0, 0
    v_pk_mov_b32 v[52:53], 0, 0
    v_pk_mov_b32 v[54:55], 0, 0
    v_pk_mov_b32 v[56:57], 0, 0
    v_pk_mov_b32 v[58:59], 0, 0
    v_pk_mov_b32 v[60:61], 0, 0
    v_pk_mov_b32 v[62:63], 0, 0
    v_pk_mov_b32 v[40:41], 0, 0
    v_pk_mov_b32 v[42:43], 0, 0
    v_pk_mov_b32 v[44:45], 0, 0
    v_pk_mov_b32 v[46:47], 0, 0
    s_waitcnt lgkmcnt(0)
    s_barrier
    ds_read_b128 v[112:115], v125
    ds_read_b128 v[116:119], v125 offset:128
    v_add_u32 v120, 157696, v1
    ds_read_b128 v[120:123], v120
    s_waitcnt lgkmcnt(1)
    v_smfmac_f32_16x16x64_bf16 v[40:43], v[112:115], v[128:135], v0
    v_smfmac_f32_16x16x64_bf16 v[44:47], v[112:115], v[136:143], v0
    v_smfmac_f32_16x16x64_bf16 v[40:43], v[116:119], v[144:151], v0
    v_smfmac_f32_16x16x64_bf16 v[44:47], v[116:119], v[152:159], v0
    v_smfmac_f32_16x16x64_bf16 v[48:51], v[112:115], v[160:167], v0
    v_smfmac_f32_16x16x64_bf16 v[52:55], v[112:115], v[168:175], v0
    s_nop 4
    v_add_f32 v40, v40, v42
    v_smfmac_f32_16x16x64_bf16 v[48:51], v[116:119], v[176:183], v0
    v_add_f32 v41, v41, v43
    v_add_f32 v44, v44, v46
    v_smfmac_f32_16x16x64_bf16 v[52:55], v[116:119], v[184:191], v0
    v_add_f32 v45, v45, v47
    v_cvt_pk_bf16_f32 v40, v40, v41
    v_smfmac_f32_16x16x64_bf16 v[56:59], v[112:115], v[192:199], v0
    v_bfi_b32 v40, 1, s46, v40
    v_cvt_pk_bf16_f32 v41, v44, v45
    v_smfmac_f32_16x16x64_bf16 v[60:63], v[112:115], v[200:207], v0
    buffer_store_dwordx2 v[40:41], v2, s[32:35], s72 offen
    v_add_f32 v48, v48, v50
    v_smfmac_f32_16x16x64_bf16 v[56:59], v[116:119], v[208:215], v0
    v_add_f32 v49, v49, v51
    v_add_f32 v52, v52, v54
    v_smfmac_f32_16x16x64_bf16 v[60:63], v[116:119], v[216:223], v0
    v_add_f32 v53, v53, v55
    v_cvt_pk_bf16_f32 v48, v48, v49
    v_smfmac_f32_16x16x64_bf16 v[24:27], v[112:115], v[224:231], v0
    v_bfi_b32 v48, 1, s46, v48
    v_cvt_pk_bf16_f32 v49, v52, v53
    v_smfmac_f32_16x16x64_bf16 v[28:31], v[112:115], v[232:239], v0
    buffer_store_dwordx2 v[48:49], v2, s[32:35], s73 offen
    v_add_f32 v56, v56, v58
    v_smfmac_f32_16x16x64_bf16 v[24:27], v[116:119], v[240:247], v0
    v_add_f32 v57, v57, v59
    v_add_f32 v60, v60, v62
    v_smfmac_f32_16x16x64_bf16 v[28:31], v[116:119], v[248:255], v0
    v_add_f32 v61, v61, v63
    v_cvt_pk_bf16_f32 v56, v56, v57
    v_bfi_b32 v56, 1, s46, v56
    v_cvt_pk_bf16_f32 v57, v60, v61
    buffer_store_dwordx2 v[56:57], v2, s[32:35], s74 offen
    v_add_f32 v24, v24, v26
    v_add_f32 v25, v25, v27
    s_nop 0
    v_add_f32 v28, v28, v30
    v_add_f32_e64 v29, v29, v31
    v_cvt_pk_bf16_f32 v24, v24, v25
    v_bfi_b32 v24, 1, s46, v24
    v_cvt_pk_bf16_f32 v25, v28, v29
    buffer_store_dwordx2 v[24:25], v2, s[32:35], s75 offen
    s_add_u32 s67, s56, s53
    s_cmp_lg_u32 s3, 3
    s_cbranch_scc1 L_rs3_195
    v_pk_mov_b32 v[116:117], -1, -1
    v_pk_mov_b32 v[118:119], -1, -1
    s_mov_b64 exec, 0xffff
    buffer_store_dwordx4 v[116:119], v1, s[32:35], s67 offen
    s_mov_b64 exec, -1
L_rs3_195:
    v_pk_mov_b32 v[40:41], 0, 0
    v_pk_mov_b32 v[42:43], 0, 0
    v_pk_mov_b32 v[44:45], 0, 0
    v_pk_mov_b32 v[46:47], 0, 0
    v_pk_mov_b32 v[48:49], 0, 0
    v_pk_mov_b32 v[50:51], 0, 0
    v_pk_mov_b32 v[52:53], 0, 0
    v_pk_mov_b32 v[54:55], 0, 0
    v_pk_mov_b32 v[56:57], 0, 0
    v_pk_mov_b32 v[58:59], 0, 0
    v_pk_mov_b32 v[60:61], 0, 0
    v_pk_mov_b32 v[62:63], 0, 0
    v_pk_mov_b32 v[112:113], 0, 0
    v_pk_mov_b32 v[114:115], 0, 0
    s_sleep 1
    buffer_load_dwordx4 v[16:19], v127, s[32:35], s70 offen sc1
    buffer_load_dwordx4 v[20:23], v127, s[32:35], s79 offen sc1
    ds_read_b128 v[64:67], v7 offset:0
    ds_read_b128 v[68:71], v7 offset:1024
    ds_read_b128 v[72:75], v7 offset:8192
    ds_read_b128 v[76:79], v7 offset:9216
    ds_read_b128 v[80:83], v7 offset:16384
    ds_read_b128 v[84:87], v7 offset:17408
    ds_read_b128 v[88:91], v7 offset:24576
    ds_read_b128 v[92:95], v7 offset:25600
    ds_read_b128 v[96:99], v7 offset:32768
    ds_read_b128 v[100:103], v7 offset:33792
    ds_read_b128 v[104:107], v7 offset:40960
    ds_read_b128 v[108:111], v7 offset:41984
L_p1l:
    buffer_load_dwordx4 v[24:27], v127, s[32:35], s70 offen sc1
    buffer_load_dwordx4 v[28:31], v127, s[32:35], s79 offen sc1
    s_waitcnt vmcnt(2) lgkmcnt(0)
    v_bitop3_b32 v116, v16, v20, s46 bitop3:0x7e
    v_and_b32 v116, 1, v116
    v_cmp_ne_u32 vcc, 0, v116
    s_cbranch_vccz L_p1A
    s_add_u32 s65, s65, 1
    s_cmp_gt_u32 s65, 4000000
    s_cbranch_scc1 L_exit
    buffer_load_dwordx4 v[16:19], v127, s[32:35], s70 offen sc1
    buffer_load_dwordx4 v[20:23], v127, s[32:35], s79 offen sc1
    s_waitcnt vmcnt(2)
    v_bitop3_b32 v116, v24, v28, s46 bitop3:0x7e
    v_and_b32 v116, 1, v116
    v_cmp_ne_u32 vcc, 0, v116
    s_cbranch_vccnz L_p1l
    v_smfmac_f32_16x16x64_bf16 v[112:115], v[120:123], v[24:31], v0
    s_branch L_p1J
L_p1A:
    v_smfmac_f32_16x16x64_bf16 v[112:115], v[120:123], v[16:23], v0
L_p1J:
    s_nop 7
    v_add_f32_dpp v112, v112, v112 row_ror:4 row_mask:0xf bank_mask:0xf
    v_add_f32_dpp v113, v113, v113 row_ror:4 row_mask:0xf bank_mask:0xf
    v_add_f32_dpp v114, v114, v114 row_ror:4 row_mask:0xf bank_mask:0xf
    v_add_f32_dpp v115, v115, v115 row_ror:4 row_mask:0xf bank_mask:0xf
    v_add_f32_dpp v112, v112, v112 row_ror:8 row_mask:0xf bank_mask:0xf
    v_add_f32_dpp v113, v113, v113 row_ror:8 row_mask:0xf bank_mask:0xf
    v_add_f32_dpp v114, v114, v114 row_ror:8 row_mask:0xf bank_mask:0xf
    v_add_f32_dpp v115, v115, v115 row_ror:8 row_mask:0xf bank_mask:0xf
    v_cvt_pk_bf16_f32 v116, v112, v114
    v_cvt_pk_bf16_f32 v117, v113, v115
    v_cndmask_b32 v116, v116, v117, s[76:77]
    s_mov_b32 exec_lo, 0x00ff00ff
    s_mov_b32 exec_hi, 0
    buffer_store_dword v116, v126, s[32:35], s71 offen
    s_mov_b64 exec, -1
    s_xor_b32 s50, s50, 0x40000
    s_mov_b32 s66, s51
    s_mov_b32 s51, s52
    s_mov_b32 s52, s53
    s_mov_b32 s53, s66
    s_add_u32 s49, s49, 1
    s_bfe_u32 s46, s49, 0x10001
    s_barrier
    s_sleep 1
    s_branch L_cstep
L_cdone:
    s_add_u32 s67, s59, 52428800
    s_waitcnt lgkmcnt(0)
    buffer_store_dwordx4 v[36:39], v1, s[32:35], s67 offen sc1
    s_add_u32 s67, s59, 60817408
    buffer_store_dwordx4 v[32:35], v1, s[32:35], s67 offen sc1
    s_waitcnt vmcnt(0)
    s_barrier
    s_cmp_lg_u32 s3, 3
    s_cbranch_scc1 L_nofl2_196
    s_add_u32 s69, s48, 480
    s_lshl_b32 s69, s69, 7
    s_add_u32 s43, s69, 133300224
    v_mov_b32 v121, 1
    s_mov_b64 exec, 1
    buffer_store_dword v121, off, s[32:35], s43 sc1
    s_mov_b64 exec, -1
L_nofl2_196:
    s_branch L_exit0
L_chain_mixed:
    s_mov_b32 s49, 0
    s_mov_b32 s50, 132120576
    s_mov_b32 s51, 132907008
    s_mov_b32 s52, 132915200
    s_mov_b32 s53, 132923392
    s_lshl_b32 s59, s48, 12
    s_lshl_b32 s66, s3, 10
    s_add_u32 s59, s59, s66
    s_add_u32 s79, s66, 158720
    s_mov_b32 s83, s66
    s_lshl_b32 s66, s3, 6
    s_add_u32 s100, s56, s66
    s_add_u32 s101, s57, 139264
    s_lshl_b32 s66, s48, 13
    s_add_u32 s66, s66, s57
    s_add_u32 s58, s66, 2097152
    s_add_u32 s60, s66, 35651584
    s_add_u32 s61, s57, 131072
    s_add_u32 s82, s57, 139264
    s_add_u32 s81, s57, 147456
    s_lshl_b32 s66, s3, 1
    s_add_u32 s66, s66, 2
    s_and_b32 s66, s66, 7
    s_lshl_b32 s66, s66, 10
    s_add_u32 s36, s66, 147456
    s_lshl_b32 s66, s3, 1
    s_add_u32 s66, s66, 3
    s_and_b32 s66, s66, 7
    s_lshl_b32 s66, s66, 10
    s_add_u32 s37, s66, 147456
    s_lshl_b32 s66, s3, 1
    s_add_u32 s66, s66, 4
    s_and_b32 s66, s66, 7
    s_lshl_b32 s66, s66, 10
    s_add_u32 s38, s66, 147456
    s_lshl_b32 s66, s3, 1
    s_add_u32 s66, s66, 5
    s_and_b32 s66, s66, 7
    s_lshl_b32 s66, s66, 10
    s_add_u32 s39, s66, 147456
    s_lshl_b32 s66, s3, 1
    s_add_u32 s66, s66, 6
    s_and_b32 s66, s66, 7
    s_lshl_b32 s66, s66, 10
    s_add_u32 s40, s66, 147456
    s_lshl_b32 s66, s3, 1
    s_add_u32 s66, s66, 7
    s_and_b32 s66, s66, 7
    s_lshl_b32 s66, s66, 10
    s_add_u32 s41, s66, 147456
    s_mov_b32 s43, 133185536
    s_add_u32 s58, s58, 262144
    s_add_u32 s60, s60, 262144
    s_add_u32 s80, s58, 262144
    s_mov_b32 s46, 0
    s_mov_b32 s99, 0
    s_lshl_b32 s55, s48, 13
    s_add_u32 s55, s55, s57
    s_add_u32 s97, s83, 133562368
    s_mov_b32 s98, s97
    s_mov_b32 s78, 0
    s_mov_b32 s47, 33552384
    s_mov_b32 s44, s64
    s_mov_b32 s45, s64
    v_add_u32 v114, s79, v1
    ds_read_b128 v[124:127], v114
    ds_read_b128 v[64:67], v7 offset:0
    ds_read_b128 v[68:71], v7 offset:1024
    ds_read_b128 v[72:75], v7 offset:8192
    ds_read_b128 v[76:79], v7 offset:9216
    ds_read_b128 v[80:83], v7 offset:16384
    ds_read_b128 v[84:87], v7 offset:17408
    ds_read_b128 v[88:91], v7 offset:24576
    ds_read_b128 v[92:95], v7 offset:25600
    ds_read_b128 v[96:99], v7 offset:32768
    ds_read_b128 v[100:103], v7 offset:33792
    ds_read_b128 v[104:107], v7 offset:40960
    ds_read_b128 v[108:111], v7 offset:41984
    v_pk_mov_b32 v[40:41], 0, 0
    v_pk_mov_b32 v[42:43], 0, 0
    v_pk_mov_b32 v[44:45], 0, 0
    v_pk_mov_b32 v[46:47], 0, 0
    v_pk_mov_b32 v[48:49], 0, 0
    v_pk_mov_b32 v[50:51], 0, 0
    v_pk_mov_b32 v[52:53], 0, 0
    v_pk_mov_b32 v[54:55], 0, 0
    v_pk_mov_b32 v[56:57], 0, 0
    v_pk_mov_b32 v[58:59], 0, 0
    v_pk_mov_b32 v[60:61], 0, 0
    v_pk_mov_b32 v[62:63], 0, 0
    s_waitcnt lgkmcnt(0)
.p2align 8
L_cstep_m:
    v_add_u32 v113, s81, v1
    s_cmp_lt_u32 s99, s42
    s_cbranch_scc1 L_kvok_197
    s_mov_b32 s69, s99
L_kvw_198:
    v_lshlrev_b32 v116, 3, v1
    s_mov_b32 s68, 133171200
    s_mov_b64 exec, 0xffff
    buffer_load_dword v117, v116, s[32:35], s68 offen sc1
    s_waitcnt vmcnt(0)
    v_cmp_le_u32 vcc, 64, v117
    s_mov_b64 exec, -1
    s_not_b32 s68, vcc_lo
    s_or_b32 s68, s68, 0x10000
    s_ff1_i32_b32 s42, s68
    s_add_u32 s65, s65, 1
    s_cmp_gt_u32 s65, 4000000
    s_cbranch_scc1 L_exit
    s_cmp_le_u32 s42, s69
    s_cbranch_scc1 L_kvw_198
L_kvok_197:
    s_add_u32 s66, s51, s57
L_poll2_m:
    buffer_load_dwordx4 v[8:11], v1, s[32:35], s66 offen sc1
    buffer_load_dwordx4 v[12:15], v1, s[32:35], s66 offen offset:1024 sc1
    s_sleep 1
L_pl_m:
    buffer_load_dwordx4 v[24:27], v1, s[32:35], s66 offen sc1
    buffer_load_dwordx4 v[28:31], v1, s[32:35], s66 offen offset:1024 sc1
    s_add_u32 s65, s65, 1
    s_cmp_gt_u32 s65, 4000000
    s_cbranch_scc1 L_exit
    s_waitcnt vmcnt(2)
    v_max_u32 v112, v8, v12
    v_cmp_eq_u32 vcc, -1, v112
    s_cbranch_vccz L_gotA_m
    buffer_load_dwordx4 v[8:11], v1, s[32:35], s66 offen sc1
    buffer_load_dwordx4 v[12:15], v1, s[32:35], s66 offen offset:1024 sc1
    s_waitcnt vmcnt(2)
    v_max_u32 v112, v24, v28
    v_cmp_eq_u32 vcc, -1, v112
    s_cbranch_vccnz L_pl_m
    v_pk_mov_b32 v[8:9], v[24:25], v[24:25] op_sel:[0,1]
    v_pk_mov_b32 v[10:11], v[26:27], v[26:27] op_sel:[0,1]
    v_pk_mov_b32 v[12:13], v[28:29], v[28:29] op_sel:[0,1]
    v_pk_mov_b32 v[14:15], v[30:31], v[30:31] op_sel:[0,1]
L_gotA_m:
    s_nop 0
    ds_write_b128 v113, v[8:11]
    ds_write_b128 v113, v[12:15] offset:1024
    v_smfmac_f32_16x16x64_bf16 v[40:43], v[8:11], a[0:7], v0
    v_add_u32 v112, s36, v1
    v_smfmac_f32_16x16x64_bf16 v[44:47], v[8:11], a[16:23], v0
    v_add_u32 v113, s37, v1
    v_smfmac_f32_16x16x64_bf16 v[48:51], v[8:11], a[80:87], v0
    v_add_u32 v114, s38, v1
    v_smfmac_f32_16x16x64_bf16 v[52:55], v[8:11], a[96:103], v0
    v_smfmac_f32_16x16x64_bf16 v[56:59], v[8:11], a[160:167], v0
    v_smfmac_f32_16x16x64_bf16 v[60:63], v[8:11], a[192:199], v0
    s_waitcnt lgkmcnt(0)
    s_barrier
    ds_read_b128 v[16:19], v112
    v_add_u32 v115, s39, v1
    v_smfmac_f32_16x16x64_bf16 v[40:43], v[12:15], a[8:15], v0
    s_waitcnt vmcnt(0)
    ds_read_b128 v[20:23], v113
    v_add_u32 v116, s40, v1
    v_smfmac_f32_16x16x64_bf16 v[44:47], v[12:15], a[24:31], v0
    ds_read_b128 v[24:27], v114
    v_add_u32 v117, s41, v1
    v_smfmac_f32_16x16x64_bf16 v[48:51], v[12:15], a[88:95], v0
    ds_read_b128 v[28:31], v115
    buffer_store_dwordx4 v[32:35], v1, s[32:35], s98 offen sc1
    v_smfmac_f32_16x16x64_bf16 v[52:55], v[12:15], a[104:111], v0
    s_cmp_eq_u32 s78, 0
    s_cbranch_scc1 L_nofl_199
    v_mov_b32 v119, 1
    s_mov_b64 exec, 1
    buffer_store_dword v119, off, s[32:35], s43 sc1
    s_mov_b64 exec, -1
L_nofl_199:
    v_smfmac_f32_16x16x64_bf16 v[56:59], v[12:15], a[168:175], v0
    v_add_u32 v115, 65536, v7
    v_smfmac_f32_16x16x64_bf16 v[60:63], v[12:15], a[200:207], v0
    s_waitcnt lgkmcnt(3)
    buffer_store_dwordx4 v[36:39], v1, s[32:35], s97 offen sc1
    ds_read_b128 v[32:35], v116
    v_smfmac_f32_16x16x64_bf16 v[40:43], v[16:19], v[64:71], v0
    ds_read_b128 v[64:67], v7 offset:49152
    v_smfmac_f32_16x16x64_bf16 v[44:47], v[16:19], a[32:39], v0
    s_waitcnt lgkmcnt(4)
    ds_read_b128 v[68:71], v7 offset:50176
    v_smfmac_f32_16x16x64_bf16 v[40:43], v[20:23], v[72:79], v0
    ds_read_b128 v[36:39], v117
    v_add_u32 v114, s101, v1
    v_smfmac_f32_16x16x64_bf16 v[44:47], v[20:23], a[40:47], v0
    s_waitcnt lgkmcnt(5)
    ds_read_b128 v[72:75], v7 offset:57344
    s_add_u32 s68, s49, 2
    v_smfmac_f32_16x16x64_bf16 v[40:43], v[24:27], v[80:87], v0
    ds_read_b128 v[76:79], v7 offset:58368
    s_lshr_b32 s99, s68, 2
    v_smfmac_f32_16x16x64_bf16 v[44:47], v[24:27], a[48:55], v0
    s_waitcnt lgkmcnt(6)
    ds_read_b128 v[80:83], v115 offset:0
    s_min_u32 s99, s99, 15
    v_smfmac_f32_16x16x64_bf16 v[40:43], v[28:31], v[88:95], v0
    ds_read_b128 v[84:87], v115 offset:1024
    s_add_u32 s68, s49, 1
    v_smfmac_f32_16x16x64_bf16 v[44:47], v[28:31], a[56:63], v0
    s_waitcnt lgkmcnt(7)
    ds_read_b128 v[88:91], v115 offset:8192
    s_and_b32 s69, s68, 3
    v_smfmac_f32_16x16x64_bf16 v[40:43], v[32:35], v[96:103], v0
    ds_read_b128 v[92:95], v115 offset:9216
    s_xor_b32 s69, s69, 1
    v_smfmac_f32_16x16x64_bf16 v[44:47], v[32:35], a[64:71], v0
    s_waitcnt lgkmcnt(6)
    ds_read_b128 v[96:99], v115 offset:16384
    s_xor_b32 s78, s3, 3
    v_smfmac_f32_16x16x64_bf16 v[40:43], v[36:39], v[104:111], v0
    ds_read_b128 v[100:103], v115 offset:17408
    s_or_b32 s69, s69, s78
    v_smfmac_f32_16x16x64_bf16 v[44:47], v[36:39], a[72:79], v0
    s_waitcnt lgkmcnt(6)
    ds_read_b128 v[104:107], v115 offset:24576
    s_cmp_eq_u32 s69, 0
    v_smfmac_f32_16x16x64_bf16 v[48:51], v[16:19], v[64:71], v0
    ds_read_b128 v[108:111], v115 offset:25600
    s_cselect_b32 s78, s68, 0
    v_smfmac_f32_16x16x64_bf16 v[52:55], v[16:19], a[112:119], v0
    ds_read_b128 v[64:67], v115 offset:32768
    s_lshr_b32 s78, s78, 2
    v_smfmac_f32_16x16x64_bf16 v[48:51], v[20:23], v[72:79], v0
    ds_read_b128 v[120:123], v114
    v_add_f32 v40, v40, v42
    v_smfmac_f32_16x16x64_bf16 v[52:55], v[20:23], a[120:127], v0
    s_waitcnt lgkmcnt(6)
    ds_read_b128 v[68:71], v115 offset:33792
    v_add_f32 v41, v41, v43
    v_smfmac_f32_16x16x64_bf16 v[48:51], v[24:27], v[80:87], v0
    ds_read_b128 v[116:119], v114 offset:1024
    v_add_f32 v44, v44, v46
    v_smfmac_f32_16x16x64_bf16 v[52:55], v[24:27], a[128:135], v0
    ds_read_b128 v[72:75], v115 offset:40960
    v_add_u32 v114, 131072, v1
    v_smfmac_f32_16x16x64_bf16 v[48:51], v[28:31], v[88:95], v0
    ds_read_b128 v[76:79], v115 offset:41984
    v_add_f32 v45, v45, v47
    v_smfmac_f32_16x16x64_bf16 v[52:55], v[28:31], a[136:143], v0
    s_waitcnt lgkmcnt(6)
    ds_read_b128 v[80:83], v115 offset:49152
    v_cvt_pk_bf16_f32 v112, v40, v41
    v_smfmac_f32_16x16x64_bf16 v[48:51], v[32:35], v[96:103], v0
    ds_read_b128 v[84:87], v115 offset:50176
    v_cvt_pk_bf16_f32 v113, v44, v45
    v_smfmac_f32_16x16x64_bf16 v[52:55], v[32:35], a[144:151], v0
    ds_read_b128 v[88:91], v115 offset:57344
    s_lshr_b32 s69, s68, 2
    v_smfmac_f32_16x16x64_bf16 v[48:51], v[36:39], v[104:111], v0
    ds_write2_b32 v3, v112, v113 offset0:0 offset1:64
    s_sub_u32 s69, s69, 1
    v_smfmac_f32_16x16x64_bf16 v[52:55], v[36:39], a[152:159], v0
    s_waitcnt lgkmcnt(4)
    ds_read_b128 v[92:95], v115 offset:58368
    s_lshl_b32 s69, s69, 5
    v_smfmac_f32_16x16x64_bf16 v[56:59], v[16:19], v[64:71], v0
    ds_read_b128 v[96:99], v114 offset:0
    s_add_u32 s69, s69, s48
    v_smfmac_f32_16x16x64_bf16 v[60:63], v[16:19], a[208:215], v0
    ds_read_b128 v[100:103], v114 offset:1024
    s_lshl_b32 s69, s69, 7
    v_smfmac_f32_16x16x64_bf16 v[56:59], v[20:23], v[72:79], v0
    ds_read_b128 v[104:107], v114 offset:2048
    v_add_f32 v48, v48, v50
    v_smfmac_f32_16x16x64_bf16 v[60:63], v[20:23], a[216:223], v0
    s_waitcnt lgkmcnt(3)
    ds_read_b128 v[108:111], v114 offset:3072
    v_add_f32 v49, v49, v51
    v_smfmac_f32_16x16x64_bf16 v[56:59], v[24:27], v[80:87], v0
    ds_read_b128 v[64:67], v114 offset:4096
    v_cvt_pk_bf16_f32 v112, v48, v49
    v_smfmac_f32_16x16x64_bf16 v[60:63], v[24:27], a[224:231], v0
    s_waitcnt lgkmcnt(6)
    s_barrier
    ds_read_b64_tr_b16 v[80:81], v5 offset:0
    v_add_f32 v52, v52, v54
    v_smfmac_f32_16x16x64_bf16 v[56:59], v[28:31], v[88:95], v0
    ds_read_b64_tr_b16 v[82:83], v5 offset:128
    v_add_f32 v53, v53, v55
    v_smfmac_f32_16x16x64_bf16 v[60:63], v[28:31], a[232:239], v0
    s_mov_b32 m0, s82
    s_nop 0
    buffer_load_dwordx4 v1, s[32:35], s60 offen offset:0 sc1 lds
    v_smfmac_f32_16x16x64_bf16 v[56:59], v[32:35], a[176:183], v0
    ds_read_b64_tr_b16 v[84:85], v5 offset:512
    v_cvt_pk_bf16_f32 v113, v52, v53
    v_smfmac_f32_16x16x64_bf16 v[60:63], v[32:35], a[240:247], v0
    ds_read_b64_tr_b16 v[86:87], v5 offset:640
    s_add_u32 s43, s69, 133300224
    v_smfmac_f32_16x16x64_bf16 v[56:59], v[36:39], a[184:191], v0
    ds_read_b128 v[68:71], v114 offset:5120
    ds_write2_b32 v4, v112, v112 offset0:0 offset1:1
    ds_read_b64_tr_b16 v[88:89], v5 offset:1024
    ds_read_b64_tr_b16 v[90:91], v5 offset:1152
    v_smfmac_f32_16x16x64_bf16 v[60:63], v[36:39], a[248:255], v0
    s_waitcnt lgkmcnt(6)
    ds_read_b128 v[72:75], v114 offset:6144
    ds_write2_b32 v4, v113, v113 offset0:128 offset1:129
    ds_read_b64_tr_b16 v[92:93], v5 offset:1536
    ds_read_b64_tr_b16 v[94:95], v5 offset:1664
    s_add_u32 s70, s55, s50
    s_add_u32 s79, s70, 1024
    s_add_u32 s71, s100, s52
    s_add_u32 s72, s54, s50
    s_add_u32 s73, s72, 16384
    s_add_u32 s74, s73, 16384
    s_add_u32 s75, s74, 16384
    v_mfma_f32_16x16x32_bf16 v[40:43], v[96:99], v[80:83], 0
    s_waitcnt lgkmcnt(8)
    ds_read_b128 v[76:79], v114 offset:7168
    buffer_load_dwordx4 v1, s[32:35], s60 offen offset:1024 sc1 lds
    v_mfma_f32_16x16x32_bf16 v[40:43], v[100:103], v[84:87], v[40:43]
    s_waitcnt lgkmcnt(5)
    v_mfma_f32_16x16x32_bf16 v[40:43], v[104:107], v[88:91], v[40:43]
    s_waitcnt lgkmcnt(1)
    v_add_u32 v114, s83, v6
    v_mfma_f32_16x16x32_bf16 v[40:43], v[108:111], v[92:95], v[40:43]
    s_waitcnt lgkmcnt(0)
    s_barrier
    ds_read_b64_tr_b16 v[8:9], v6 offset:0
    v_mfma_f32_16x16x32_bf16 v[44:47], v[64:67], v[80:83], 0
    ds_read_b64_tr_b16 v[10:11], v6 offset:256
    v_mov_b32 v96, 0x3f803f80
    v_mfma_f32_16x16x32_bf16 v[44:47], v[68:71], v[84:87], v[44:47]
    ds_read_b64_tr_b16 v[12:13], v6 offset:1024
    ds_read_b64_tr_b16 v[14:15], v6 offset:1280
    v_mfma_f32_16x16x32_bf16 v[44:47], v[72:75], v[88:91], v[44:47]
    ds_read_b64_tr_b16 v[16:17], v6 offset:2048
    ds_read_b64_tr_b16 v[18:19], v6 offset:2304
    v_mfma_f32_16x16x32_bf16 v[44:47], v[76:79], v[92:95], v[44:47]
    s_waitcnt lgkmcnt(4)
    ds_read_b64_tr_b16 v[20:21], v6 offset:3072
    ds_read_b64_tr_b16 v[22:23], v6 offset:3328
    v_mov_b32 v97, 0x3f803f80
    v_mfma_f32_16x16x32_bf16 v[48:51], v[8:11], v[80:83], 0
    s_waitcnt lgkmcnt(4)
    s_mov_b32 m0, s61
    s_nop 0
    buffer_load_dwordx4 v1, s[32:35], s58 offen offset:0 sc1 lds
    v_mov_b32 v98, 0x3f803f80
    v_mfma_f32_16x16x32_bf16 v[48:51], v[12:15], v[84:87], v[48:51]
    s_waitcnt lgkmcnt(2)
    ds_read_b64_tr_b16 v[36:37], v114
    v_mov_b32 v99, 0x3f803f80
    v_mfma_f32_16x16x32_bf16 v[48:51], v[16:19], v[88:91], v[48:51]
    s_waitcnt lgkmcnt(1)
    ds_read_b64_tr_b16 v[38:39], v114 offset:256
    v_mov_b32 v100, 0x3f803f80
    v_mfma_f32_16x16x32_bf16 v[48:51], v[20:23], v[92:95], v[48:51]
    buffer_load_dwordx4 v1, s[32:35], s58 offen offset:1024 sc1 lds
    v_mov_b32 v101, 0
    v_max3_f32 v112, v40, v41, v42
    v_max3_f32 v112, v112, v43, v44
    v_max3_f32 v112, v112, v45, v46
    v_max_f32 v112, v112, v47
    s_nop 1
    v_max3_f32 v112, v112, v48, v49
    v_mov_b32 v113, v112
    s_nop 1
    v_permlane16_swap_b32 v112, v113
    v_max_f32 v112, v112, v113
    v_mov_b32 v113, v112
    s_nop 1
    v_permlane32_swap_b32 v112, v113
    v_max_f32 v112, v112, v113
    v_mul_f32 v112, s64, v112
    v_pk_fma_f32 v[40:41], v[40:41], s[44:45], v[112:113] op_sel_hi:[1,1,0] neg_lo:[0,0,1] neg_hi:[0,0,1]
    v_pk_fma_f32 v[42:43], v[42:43], s[44:45], v[112:113] op_sel_hi:[1,1,0] neg_lo:[0,0,1] neg_hi:[0,0,1]
    v_pk_fma_f32 v[44:45], v[44:45], s[44:45], v[112:113] op_sel_hi:[1,1,0] neg_lo:[0,0,1] neg_hi:[0,0,1]
    v_pk_fma_f32 v[46:47], v[46:47], s[44:45], v[112:113] op_sel_hi:[1,1,0] neg_lo:[0,0,1] neg_hi:[0,0,1]
    v_pk_fma_f32 v[48:49], v[48:49], s[44:45], v[112:113] op_sel_hi:[1,1,0] neg_lo:[0,0,1] neg_hi:[0,0,1]
    v_exp_f32 v40, v40
    v_exp_f32 v41, v41
    v_exp_f32 v42, v42
    v_exp_f32 v43, v43
    v_exp_f32 v44, v44
    v_exp_f32 v45, v45
    v_exp_f32 v46, v46
    v_exp_f32 v47, v47
    v_exp_f32 v48, v48
    v_exp_f32 v49, v49
    v_cvt_pk_bf16_f32 v52, v40, v41
    v_cvt_pk_bf16_f32 v53, v42, v43
    v_cvt_pk_bf16_f32 v54, v44, v45
    v_cvt_pk_bf16_f32 v55, v46, v47
    v_cvt_pk_bf16_f32 v114, v48, v49
    v_cvt_pk_bf16_f32 v115, v48, v49
    v_mfma_f32_16x16x32_bf16 v[104:107], v[96:99], v[52:55], 0
    v_cvt_pk_bf16_f32 v32, v56, v57
    v_cvt_pk_bf16_f32 v33, v58, v59
    v_mfma_f32_16x16x32_bf16 v[40:43], v[120:123], v[52:55], 0
    v_cvt_pk_bf16_f32 v34, v60, v61
    v_cvt_pk_bf16_f32 v35, v62, v63
    v_mfma_f32_16x16x32_bf16 v[44:47], v[116:119], v[52:55], 0
    s_cmp_eq_u32 s49, 63
    s_cbranch_scc1 L_cdone_m
    v_mfma_f32_16x16x16_bf16 v[104:107], v[100:101], v[114:115], v[104:107]
    v_mfma_f32_16x16x16_bf16 v[40:43], v[32:33], v[114:115], v[40:43]
    s_nop 1
    v_mfma_f32_16x16x16_bf16 v[44:47], v[34:35], v[114:115], v[44:47]
    s_add_u32 s58, s58, 262144
    s_add_u32 s60, s60, 262144
    s_add_u32 s97, s59, 52428800
    s_add_u32 s98, s59, 60817408
    s_add_u32 s59, s59, 131072
    s_add_u32 s80, s80, 262144
    v_pk_mov_b32 v[24:25], 0, 0
    v_pk_mov_b32 v[26:27], 0, 0
    v_pk_mov_b32 v[28:29], 0, 0
    v_pk_mov_b32 v[30:31], 0, 0
    v_rcp_f32 v112, v104
    v_cndmask_b32 v40, v40, v44, s[62:63]
    v_cndmask_b32 v41, v41, v45, s[62:63]
    v_cndmask_b32 v42, v42, v46, s[62:63]
    v_cndmask_b32 v43, v43, v47, s[62:63]
    v_pk_mul_f32 v[40:41], v[40:41], v[112:113] op_sel_hi:[1,0]
    v_pk_mul_f32 v[42:43], v[42:43], v[112:113] op_sel_hi:[1,0]
    v_cvt_pk_bf16_f32 v114, v40, v41
    v_cvt_pk_bf16_f32 v115, v42, v43
    ds_write2_b32 v124, v114, v115 offset0:0 offset1:4
    v_pk_mov_b32 v[48:49], 0, 0
    v_pk_mov_b32 v[50:51], 0, 0
    v_pk_mov_b32 v[52:53], 0, 0
    v_pk_mov_b32 v[54:55], 0, 0
    v_pk_mov_b32 v[56:57], 0, 0
    v_pk_mov_b32 v[58:59], 0, 0
    v_pk_mov_b32 v[60:61], 0, 0
    v_pk_mov_b32 v[62:63], 0, 0
    v_pk_mov_b32 v[40:41], 0, 0
    v_pk_mov_b32 v[42:43], 0, 0
    v_pk_mov_b32 v[44:45], 0, 0
    v_pk_mov_b32 v[46:47], 0, 0
    s_waitcnt lgkmcnt(0)
    s_barrier
    ds_read_b128 v[112:115], v125
    ds_read_b128 v[116:119], v125 offset:128
    v_add_u32 v120, 157696, v1
    ds_read_b128 v[120:123], v120
    s_waitcnt lgkmcnt(1)
    v_smfmac_f32_16x16x64_bf16 v[40:43], v[112:115], v[128:135], v0
    v_smfmac_f32_16x16x64_bf16 v[44:47], v[112:115], v[136:143], v0
    v_smfmac_f32_16x16x64_bf16 v[40:43], v[116:119], v[144:151], v0
    v_smfmac_f32_16x16x64_bf16 v[44:47], v[116:119], v[152:159], v0
    v_smfmac_f32_16x16x64_bf16 v[48:51], v[112:115], v[160:167], v0
    v_smfmac_f32_16x16x64_bf16 v[52:55], v[112:115], v[168:175], v0
    s_nop 4
    v_add_f32 v40, v40, v42
    v_smfmac_f32_16x16x64_bf16 v[48:51], v[116:119], v[176:183], v0
    v_add_f32 v41, v41, v43
    v_add_f32 v44, v44, v46
    v_smfmac_f32_16x16x64_bf16 v[52:55], v[116:119], v[184:191], v0
    v_add_f32 v45, v45, v47
    v_cvt_pk_bf16_f32 v40, v40, v41
    v_smfmac_f32_16x16x64_bf16 v[56:59], v[112:115], v[192:199], v0
    v_bfi_b32 v40, 1, s46, v40
    v_cvt_pk_bf16_f32 v41, v44, v45
    v_smfmac_f32_16x16x64_bf16 v[60:63], v[112:115], v[200:207], v0
    buffer_store_dwordx2 v[40:41], v2, s[32:35], s72 offen sc1
    v_add_f32 v48, v48, v50
    v_smfmac_f32_16x16x64_bf16 v[56:59], v[116:119], v[208:215], v0
    v_add_f32 v49, v49, v51
    v_add_f32 v52, v52, v54
    v_smfmac_f32_16x16x64_bf16 v[60:63], v[116:119], v[216:223], v0
    v_add_f32 v53, v53, v55
    v_cvt_pk_bf16_f32 v48, v48, v49
    v_smfmac_f32_16x16x64_bf16 v[24:27], v[112:115], v[224:231], v0
    v_bfi_b32 v48, 1, s46, v48
    v_cvt_pk_bf16_f32 v49, v52, v53
    v_smfmac_f32_16x16x64_bf16 v[28:31], v[112:115], v[232:239], v0
    buffer_store_dwordx2 v[48:49], v2, s[32:35], s73 offen sc1
    v_add_f32 v56, v56, v58
    v_smfmac_f32_16x16x64_bf16 v[24:27], v[116:119], v[240:247], v0
    v_add_f32 v57, v57, v59
    v_add_f32 v60, v60, v62
    v_smfmac_f32_16x16x64_bf16 v[28:31], v[116:119], v[248:255], v0
    v_add_f32 v61, v61, v63
    v_cvt_pk_bf16_f32 v56, v56, v57
    v_bfi_b32 v56, 1, s46, v56
    v_cvt_pk_bf16_f32 v57, v60, v61
    buffer_store_dwordx2 v[56:57], v2, s[32:35], s74 offen sc1
    v_add_f32 v24, v24, v26
    v_add_f32 v25, v25, v27
    s_nop 0
    v_add_f32 v28, v28, v30
    v_add_f32 v29, v29, v31
    v_cvt_pk_bf16_f32 v24, v24, v25
    v_bfi_b32 v24, 1, s46, v24
    v_cvt_pk_bf16_f32 v25, v28, v29
    buffer_store_dwordx2 v[24:25], v2, s[32:35], s75 offen sc1
    s_add_u32 s67, s56, s53
    s_cmp_lg_u32 s3, 3
    s_cbranch_scc1 L_rs3_200
    v_pk_mov_b32 v[116:117], -1, -1
    v_pk_mov_b32 v[118:119], -1, -1
    s_mov_b64 exec, 0xffff
    buffer_store_dwordx4 v[116:119], v1, s[32:35], s67 offen sc1
    s_mov_b64 exec, -1
L_rs3_200:
    v_pk_mov_b32 v[40:41], 0, 0
    v_pk_mov_b32 v[42:43], 0, 0
    v_pk_mov_b32 v[44:45], 0, 0
    v_pk_mov_b32 v[46:47], 0, 0
    v_pk_mov_b32 v[48:49], 0, 0
    v_pk_mov_b32 v[50:51], 0, 0
    v_pk_mov_b32 v[52:53], 0, 0
    v_pk_mov_b32 v[54:55], 0, 0
    v_pk_mov_b32 v[56:57], 0, 0
    v_pk_mov_b32 v[58:59], 0, 0
    v_pk_mov_b32 v[60:61], 0, 0
    v_pk_mov_b32 v[62:63], 0, 0
    v_pk_mov_b32 v[112:113], 0, 0
    v_pk_mov_b32 v[114:115], 0, 0
    s_sleep 1
    buffer_load_dwordx4 v[16:19], v127, s[32:35], s70 offen sc1
    buffer_load_dwordx4 v[20:23], v127, s[32:35], s79 offen sc1
    ds_read_b128 v[64:67], v7 offset:0
    ds_read_b128 v[68:71], v7 offset:1024
    ds_read_b128 v[72:75], v7 offset:8192
    ds_read_b128 v[76:79], v7 offset:9216
    ds_read_b128 v[80:83], v7 offset:16384
    ds_read_b128 v[84:87], v7 offset:17408
    ds_read_b128 v[88:91], v7 offset:24576
    ds_read_b128 v[92:95], v7 offset:25600
    ds_read_b128 v[96:99], v7 offset:32768
    ds_read_b128 v[100:103], v7 offset:33792
    ds_read_b128 v[104:107], v7 offset:40960
    ds_read_b128 v[108:111], v7 offset:41984
L_p1l_m:
    buffer_load_dwordx4 v[24:27], v127, s[32:35], s70 offen sc1
    buffer_load_dwordx4 v[28:31], v127, s[32:35], s79 offen sc1
    s_waitcnt vmcnt(2) lgkmcnt(0)
    v_bitop3_b32 v116, v16, v20, s46 bitop3:0x7e
    v_and_b32 v116, 1, v116
    v_cmp_ne_u32 vcc, 0, v116
    s_cbranch_vccz L_p1A_m
    s_add_u32 s65, s65, 1
    s_cmp_gt_u32 s65, 4000000
    s_cbranch_scc1 L_exit
    buffer_load_dwordx4 v[16:19], v127, s[32:35], s70 offen sc1
    buffer_load_dwordx4 v[20:23], v127, s[32:35], s79 offen sc1
    s_waitcnt vmcnt(2)
    v_bitop3_b32 v116, v24, v28, s46 bitop3:0x7e
    v_and_b32 v116, 1, v116
    v_cmp_ne_u32 vcc, 0, v116
    s_cbranch_vccnz L_p1l_m
    v_smfmac_f32_16x16x64_bf16 v[112:115], v[120:123], v[24:31], v0
    s_branch L_p1J_m
L_p1A_m:
    v_smfmac_f32_16x16x64_bf16 v[112:115], v[120:123], v[16:23], v0
L_p1J_m:
    s_nop 7
    v_add_f32_dpp v112, v112, v112 row_ror:4 row_mask:0xf bank_mask:0xf
    v_add_f32_dpp v113, v113, v113 row_ror:4 row_mask:0xf bank_mask:0xf
    v_add_f32_dpp v114, v114, v114 row_ror:4 row_mask:0xf bank_mask:0xf
    v_add_f32_dpp v115, v115, v115 row_ror:4 row_mask:0xf bank_mask:0xf
    v_add_f32_dpp v112, v112, v112 row_ror:8 row_mask:0xf bank_mask:0xf
    v_add_f32_dpp v113, v113, v113 row_ror:8 row_mask:0xf bank_mask:0xf
    v_add_f32_dpp v114, v114, v114 row_ror:8 row_mask:0xf bank_mask:0xf
    v_add_f32_dpp v115, v115, v115 row_ror:8 row_mask:0xf bank_mask:0xf
    v_cvt_pk_bf16_f32 v116, v112, v114
    v_cvt_pk_bf16_f32 v117, v113, v115
    v_cndmask_b32 v116, v116, v117, s[76:77]
    s_mov_b32 exec_lo, 0x00ff00ff
    s_mov_b32 exec_hi, 0
    buffer_store_dword v116, v126, s[32:35], s71 offen sc1
    s_mov_b64 exec, -1
    s_xor_b32 s50, s50, 0x40000
    s_mov_b32 s66, s51
    s_mov_b32 s51, s52
    s_mov_b32 s52, s53
    s_mov_b32 s53, s66
    s_add_u32 s49, s49, 1
    s_bfe_u32 s46, s49, 0x10001
    s_barrier
    s_sleep 1
    s_branch L_cstep_m
L_cdone_m:
    s_add_u32 s67, s59, 52428800
    s_waitcnt lgkmcnt(0)
    buffer_store_dwordx4 v[36:39], v1, s[32:35], s67 offen sc1
    s_add_u32 s67, s59, 60817408
    buffer_store_dwordx4 v[32:35], v1, s[32:35], s67 offen sc1
    s_waitcnt vmcnt(0)
    s_barrier
    s_cmp_lg_u32 s3, 3
    s_cbranch_scc1 L_nofl2_201
    s_add_u32 s69, s48, 480
    s_lshl_b32 s69, s69, 7
    s_add_u32 s43, s69, 133300224
    v_mov_b32 v121, 1
    s_mov_b64 exec, 1
    buffer_store_dword v121, off, s[32:35], s43 sc1
    s_mov_b64 exec, -1
L_nofl2_201:
L_exit0:
    s_waitcnt vmcnt(0)
    s_waitcnt vmcnt(0)
L_exit:
    s_endpgm
L_ovf:
    s_mov_b32 s61, 32
    s_cmp_lg_u32 s3, 0
    s_cbranch_scc1 L_tk_202
    v_mov_b32 v8, s61
    v_mov_b32 v9, 1
    v_mov_b32 v11, 162816
    s_mov_b64 exec, 1
    global_atomic_add v10, v8, v9, s[28:29] sc0
    s_waitcnt vmcnt(0)
    ds_write_b32 v11, v10
    s_waitcnt lgkmcnt(0)
    s_mov_b64 exec, -1
L_tk_202:
    s_barrier
    v_mov_b32 v11, 162816
    ds_read_b32 v10, v11
    s_waitcnt lgkmcnt(0)
    v_readfirstlane_b32 s48, v10
    s_barrier
    v_lshlrev_b32 v8, 2, v1
L_ovw_203:
    s_mov_b64 exec, 0xff
    global_load_dword v9, v8, s[28:29] sc1
    s_waitcnt vmcnt(0)
    s_mov_b64 exec, -1
    s_mov_b32 s60, 0
    v_readlane_b32 s62, v9, 0
    s_nop 0
    s_mov_b32 s70, s62
    s_add_u32 s60, s60, s62
    v_readlane_b32 s62, v9, 1
    s_nop 0
    s_mov_b32 s71, s62
    s_add_u32 s60, s60, s62
    v_readlane_b32 s62, v9, 2
    s_nop 0
    s_mov_b32 s72, s62
    s_add_u32 s60, s60, s62
    v_readlane_b32 s62, v9, 3
    s_nop 0
    s_mov_b32 s73, s62
    s_add_u32 s60, s60, s62
    v_readlane_b32 s62, v9, 4
    s_nop 0
    s_mov_b32 s74, s62
    s_add_u32 s60, s60, s62
    v_readlane_b32 s62, v9, 5
    s_nop 0
    s_mov_b32 s75, s62
    s_add_u32 s60, s60, s62
    v_readlane_b32 s62, v9, 6
    s_nop 0
    s_mov_b32 s76, s62
    s_add_u32 s60, s60, s62
    v_readlane_b32 s62, v9, 7
    s_nop 0
    s_mov_b32 s77, s62
    s_add_u32 s60, s60, s62
    s_add_u32 s94, s94, 1
    s_cmp_gt_u32 s94, 3000000
    s_cbranch_scc1 L_exit
    s_cmp_lt_u32 s60, 256
    s_cbranch_scc1 L_ovw_203
    s_min_u32 s60, s70, 32
    s_sub_u32 s61, 32, s60
    s_cmp_lt_u32 s48, s61
    s_cbranch_scc0 L_ovn_205
    s_add_u32 s48, s48, s60
    s_add_u32 s48, s48, 0
    s_branch L_ovfnd_204
L_ovn_205:
    s_sub_u32 s48, s48, s61
    s_min_u32 s60, s71, 32
    s_sub_u32 s61, 32, s60
    s_cmp_lt_u32 s48, s61
    s_cbranch_scc0 L_ovn_206
    s_add_u32 s48, s48, s60
    s_add_u32 s48, s48, 32
    s_branch L_ovfnd_204
L_ovn_206:
    s_sub_u32 s48, s48, s61
    s_min_u32 s60, s72, 32
    s_sub_u32 s61, 32, s60
    s_cmp_lt_u32 s48, s61
    s_cbranch_scc0 L_ovn_207
    s_add_u32 s48, s48, s60
    s_add_u32 s48, s48, 64
    s_branch L_ovfnd_204
L_ovn_207:
    s_sub_u32 s48, s48, s61
    s_min_u32 s60, s73, 32
    s_sub_u32 s61, 32, s60
    s_cmp_lt_u32 s48, s61
    s_cbranch_scc0 L_ovn_208
    s_add_u32 s48, s48, s60
    s_add_u32 s48, s48, 96
    s_branch L_ovfnd_204
L_ovn_208:
    s_sub_u32 s48, s48, s61
    s_min_u32 s60, s74, 32
    s_sub_u32 s61, 32, s60
    s_cmp_lt_u32 s48, s61
    s_cbranch_scc0 L_ovn_209
    s_add_u32 s48, s48, s60
    s_add_u32 s48, s48, 128
    s_branch L_ovfnd_204
L_ovn_209:
    s_sub_u32 s48, s48, s61
    s_min_u32 s60, s75, 32
    s_sub_u32 s61, 32, s60
    s_cmp_lt_u32 s48, s61
    s_cbranch_scc0 L_ovn_210
    s_add_u32 s48, s48, s60
    s_add_u32 s48, s48, 160
    s_branch L_ovfnd_204
L_ovn_210:
    s_sub_u32 s48, s48, s61
    s_min_u32 s60, s76, 32
    s_sub_u32 s61, 32, s60
    s_cmp_lt_u32 s48, s61
    s_cbranch_scc0 L_ovn_211
    s_add_u32 s48, s48, s60
    s_add_u32 s48, s48, 192
    s_branch L_ovfnd_204
L_ovn_211:
    s_sub_u32 s48, s48, s61
    s_min_u32 s60, s77, 32
    s_sub_u32 s61, 32, s60
    s_cmp_lt_u32 s48, s61
    s_cbranch_scc0 L_ovn_212
    s_add_u32 s48, s48, s60
    s_add_u32 s48, s48, 224
    s_branch L_ovfnd_204
L_ovn_212:
    s_sub_u32 s48, s48, s61
    s_branch L_exit
L_ovfnd_204:
    s_cmp_ge_u32 s48, 32
    s_cbranch_scc1 L_rdone
    v_mov_b32 v8, 40
    v_mov_b32 v9, 1
    s_mov_b64 exec, 1
    global_atomic_add v8, v9, s[28:29] sc1
    s_waitcnt vmcnt(0)
    s_mov_b64 exec, -1
    s_branch L_rdone
.section .rodata,"a"
.p2align 6
.amdhsa_kernel recurrent_scan__memory_aug_recurrent_mem_tr__swiglu_ffn__prompt_kernel
  .amdhsa_next_free_vgpr 512
  .amdhsa_next_free_sgpr 102
  .amdhsa_accum_offset 256
  .amdhsa_group_segment_fixed_size 0
  .amdhsa_kernarg_size 112
  .amdhsa_user_sgpr_count 2
  .amdhsa_user_sgpr_kernarg_segment_ptr 1
  .amdhsa_system_sgpr_workgroup_id_x 1
.end_amdhsa_kernel
```
